```python
import torch

def _softmax(x, axis=-1):
    return torch.softmax(x, dim=axis)
def _gelu(x):
    return torch.nn.functional.gelu(x, approximate="tanh")
def _silu(x):
    return torch.nn.functional.silu(x)
def _sigmoid(x):
    return torch.sigmoid(x)
def _layernorm(x, axis=-1, eps=1e-5):
    m = x.mean(dim=axis, keepdim=True)
    v = x.var(dim=axis, keepdim=True, unbiased=False)
    return (x - m) / torch.sqrt(v + eps)
def _scatter_add(tgt, idx, src, axis=0):
    return tgt.clone().index_add_(axis, idx, src)
def _segment_sum(src, seg, n):
    out = torch.zeros((n,) + src.shape[1:], dtype=src.dtype)
    return out.index_add_(0, seg, src)
def _pad(x, pw):
    flat = tuple(v for pair in reversed(pw) for v in pair)
    return torch.nn.functional.pad(x, flat)

kernel_name = 'recurrent_scan__sliding_block__dense_activation_relu__prompt'

def setup_inputs():

    _w = (lambda a: (lambda t: t.to(torch.bfloat16) if t.is_floating_point() else t)(torch.as_tensor(a)))
    def _A_setup():
        B, S, D = 1, 2048, 640
        return {
            "x": _w((lambda *s: torch.randn(*s, dtype=torch.bfloat16) * 0.05)(B, S, D)),
            "wqkv": _w((lambda *s: torch.randn(*s, dtype=torch.bfloat16) * 0.05)(D, 3 * D)),
            "wo": _w((lambda *s: torch.randn(*s, dtype=torch.bfloat16) * 0.05)(D, D)),
        }
    _A_in = _A_setup()

    def _B_setup():
        B, S, D, Dff = 1, 2048, 640, 1728
        return {
            "x": _w((lambda *s: torch.randn(*s, dtype=torch.bfloat16) * 0.05)(B, S, D)),
            "w1": _w((lambda *s: torch.randn(*s, dtype=torch.bfloat16) * 0.05)(D, Dff)),
            "w2": _w((lambda *s: torch.randn(*s, dtype=torch.bfloat16) * 0.05)(Dff, D)),
        }
    _B_in = _B_setup()

    return {
        "A_x": _A_in["x"],
        "A_wqkv": _A_in["wqkv"],
        "A_wo": _A_in["wo"],
        "B_x": _B_in["x"],
        "B_w1": _B_in["w1"],
        "B_w2": _B_in["w2"],
    }

def reference(A_x, A_wqkv, A_wo, B_x, B_w1, B_w2):
    def _A_ref(x, wqkv, wo):
        B, S, D = x.shape
        H = 32; Dh = D // H; W = 256
        qkv = (lambda x, *d: x.permute(*d))((x @ wqkv).reshape(B, S, 3, H, Dh), 2, 0, 3, 1, 4)
        q, k, v = qkv[0], qkv[1], qkv[2]
        scores = torch.einsum("bhqd,bhkd->bhqk", q, k) * (Dh ** -0.5)
        idx = torch.arange(S)
        mask = (idx[:, None] - idx[None, :] >= 0) & (idx[:, None] - idx[None, :] < W)
        scores = torch.where(mask[None, None], scores, -1e9)
        p = _softmax(scores, axis=-1)
        o = torch.einsum("bhqk,bhkd->bhqd", p, v)
        return (lambda x, *d: x.permute(*d))(o, 0, 2, 1, 3).reshape(B, S, D) @ wo

    def _B_ref(x, w1, w2):
        h = torch.einsum("bsd,df->bsf", x, w1)
        zero = torch.zeros_like(h)
        h = torch.maximum(h, zero)
        return torch.einsum("bsf,fd->bsd", h, w2)

    x = A_x
    xn = _layernorm(x, axis=-1)
    s = _A_ref(xn, A_wqkv, A_wo)
    g = _silu(_B_ref(xn, B_w1, B_w2))
    return x + s * g
```

```asm
; @launch grid=(256,1,1) block=(256,1,1) lds=163840
.amdgcn_target "amdgcn-amd-amdhsa--gfx950"
.text
.globl recurrent_scan__sliding_block__dense_activation_relu__prompt_kernel
.p2align 8
.type recurrent_scan__sliding_block__dense_activation_relu__prompt_kernel,@function
recurrent_scan__sliding_block__dense_activation_relu__prompt_kernel:
s_cmp_ge_u32 s2, 256
s_cbranch_scc1 L_end
s_load_dwordx16 s[4:19], s[0:1], 0
s_load_dwordx2 s[20:21], s[0:1], 64
s_memrealtime s[22:23]
v_lshrrev_b32 v1, 6, v0
v_and_b32 v0, 63, v0
v_readfirstlane_b32 s68, v1
s_and_b32 s80, s2, 7
s_lshr_b32 s81, s2, 3
s_getpc_b64 s[90:91]
L_pc:
s_lshl_b32 s88, s81, 2
s_add_u32 s88, s88, s68
s_and_b32 s88, s88, 7
s_lshl_b32 s88, s88, 13
v_lshl_add_u32 v38, v0, 7, s88
v_min_u32 v38, L_last-L_pc-4, v38
global_load_dword v63, v38, s[90:91]
s_and_b32 s88, s80, 1
s_lshl_b32 s88, s88, 3
s_and_b32 s89, s81, 7
s_add_u32 s69, s88, s89
s_lshr_b32 s88, s80, 1
s_lshl_b32 s88, s88, 2
s_lshr_b32 s89, s81, 3
s_add_u32 s70, s88, s89
s_mul_i32 s88, s70, 3
s_add_u32 s88, s88, s69
s_mul_i32 s89, s88, 205
s_lshr_b32 s89, s89, 11
s_mul_i32 s89, s89, 10
s_sub_u32 s71, s88, s89
s_mul_i32 s73, s71, 245760
s_lshl_b32 s74, s71, 7
s_mul_i32 s75, s71, 221184
s_lshl_b32 s76, s68, 12
s_lshl_b32 s88, s69, 7
s_lshl_b32 s89, s68, 5
s_add_u32 s82, s88, s89
v_lshrrev_b32 v38, 3, v0
v_add_u32 v39, s82, v38
v_mul_u32_u24 v39, 0x500, v39
v_lshrrev_b32 v38, 1, v38
v_and_b32 v40, 7, v0
v_xor_b32 v40, v40, v38
v_lshl_add_u32 v2, v40, 4, v39
v_xor_b32 v38, 64, v2
v_add_u32 v3, 0x2800, v38
v_add_u32 v4, 0x5000, v2
v_add_u32 v5, 0x5000, v3
s_lshl_b32 s88, s68, 4
s_lshl_b32 s89, s70, 8
v_lshrrev_b32 v38, 4, v0
v_lshlrev_b32 v39, 1, v38
v_and_b32 v40, 15, v0
v_xor_b32 v40, v40, v39
v_lshlrev_b32 v40, 4, v40
v_add_u32 v40, s89, v40
v_add_u32 v38, s88, v38
s_movk_i32 s90, 3840
v_mad_u32_u24 v10, v38, s90, v40
v_xor_b32 v39, 0x80, v10
v_add_u32 v11, 15360, v10
v_add_u32 v12, 30720, v39
v_add_u32 v13, 46080, v39
s_movk_i32 s90, 3456
v_mad_u32_u24 v14, v38, s90, v40
v_xor_b32 v40, 0x80, v40
v_mad_u32_u24 v16, v38, s90, v40
s_cmp_lt_u32 s70, 15
s_mov_b32 s26, 2621440
s_mov_b32 s27, 0x20000
s_cselect_b32 s30, 2457600, 0
s_mov_b32 s31, 0x20000
s_mul_i32 s3, s68, 40960
s_waitcnt lgkmcnt(0)
s_cselect_b32 s28, s6, s8
s_cselect_b32 s29, s7, s9
s_mov_b32 s24, s4
s_mov_b32 s25, s5
s_cbranch_scc0 L_h0
s_add_u32 m0, s76, 0
s_nop 0
buffer_load_dwordx4 v10, s[28:31], s73 offen lds
s_add_u32 m0, s76, 1024
s_nop 0
buffer_load_dwordx4 v11, s[28:31], s73 offen lds
s_add_u32 m0, s76, 2048
s_nop 0
buffer_load_dwordx4 v12, s[28:31], s73 offen lds
s_add_u32 m0, s76, 3072
s_nop 0
buffer_load_dwordx4 v13, s[28:31], s73 offen lds
s_add_u32 s73, s73, 245760
s_sub_u32 s85, s73, 2457600
s_min_u32 s73, s73, s85
s_add_u32 m0, s76, 81920
s_nop 0
buffer_load_dwordx4 v2, s[24:27], s74 offen lds
s_add_u32 m0, s76, 82944
s_nop 0
buffer_load_dwordx4 v3, s[24:27], s74 offen lds
s_add_u32 m0, s76, 83968
s_nop 0
buffer_load_dwordx4 v4, s[24:27], s74 offen lds
s_add_u32 m0, s76, 84992
s_nop 0
buffer_load_dwordx4 v5, s[24:27], s74 offen lds
s_add_u32 s74, s74, 128
s_sub_u32 s89, s74, 1280
s_min_u32 s74, s74, s89
L_h0b:
s_nop 4
s_mov_b32 s60, s18
s_mov_b32 s61, s19
s_mov_b32 s62, 256
s_mov_b32 s63, 0x20000
s_or_b32 s88, s2, s68
s_cmp_lg_u32 s88, 0
s_cbranch_scc1 L_lead_1
s_or_b32 s22, s22, 1
v_mov_b32 v38, s22
v_lshlrev_b32 v39, 16, v0
buffer_store_dword v38, v39, s[60:63], 0 offen sc1
L_lead_1:
s_cmp_eq_u32 s70, 15
s_cbranch_scc1 L_h1
s_add_u32 m0, s76, 16384
s_nop 0
buffer_load_dwordx4 v10, s[28:31], s73 offen lds
s_add_u32 m0, s76, 17408
s_nop 0
buffer_load_dwordx4 v11, s[28:31], s73 offen lds
s_add_u32 m0, s76, 18432
s_nop 0
buffer_load_dwordx4 v12, s[28:31], s73 offen lds
s_add_u32 m0, s76, 19456
s_nop 0
buffer_load_dwordx4 v13, s[28:31], s73 offen lds
s_add_u32 s73, s73, 245760
s_sub_u32 s85, s73, 2457600
s_min_u32 s73, s73, s85
L_h1:
s_nop 4
s_add_u32 s36, s20, 0
s_addc_u32 s37, s21, 0
s_mov_b32 s38, 7864320
s_mov_b32 s39, 0x20000
s_add_u32 s40, s20, 7864320
s_addc_u32 s41, s21, 0
s_mov_b32 s42, 7077888
s_mov_b32 s43, 0x20000
s_add_u32 s44, s20, 0
s_addc_u32 s45, s21, 0
s_mov_b32 s46, 2621440
s_mov_b32 s47, 0x20000
s_add_u32 s48, s20, 17563648
s_addc_u32 s49, s21, 0
s_mov_b32 s50, 3031040
s_mov_b32 s51, 0x20000
s_add_u32 s52, s20, 20594688
s_addc_u32 s53, s21, 0
s_mov_b32 s54, 991232
s_mov_b32 s55, 0x20000
s_mov_b32 s32, s12
s_mov_b32 s33, s13
s_cmp_lt_u32 s70, 14
s_cselect_b32 s34, 2211840, 0
s_mov_b32 s35, 0x20000
s_mov_b32 s56, s16
s_mov_b32 s57, s17
s_mov_b32 s58, 2621440
s_mov_b32 s59, 0x20000
s_mov_b32 s4, 0
s_mov_b32 s5, -1
s_lshl_b32 s83, s69, 4
s_add_u32 s83, s83, s70
v_add_u32 v15, 13824, v14
v_add_u32 v17, 41472, v16
v_add_u32 v16, 27648, v16
v_and_b32 v20, 31, v0
v_lshrrev_b32 v21, 5, v0
v_lshrrev_b32 v40, 4, v0
v_bfe_u32 v38, v0, 1, 3
v_xor_b32 v38, v38, v40
v_lshlrev_b32 v38, 4, v38
v_and_b32 v39, 15, v0
v_lshl_add_u32 v38, v39, 7, v38
s_add_u32 s88, s76, 81920
v_add_u32 v6, s88, v38
v_xor_b32 v7, 64, v6
v_lshl_add_u32 v43, v39, 3, s76
v_bfe_u32 v38, v0, 2, 2
v_lshl_add_u32 v39, v40, 3, v38
v_lshlrev_b32 v39, 8, v39
v_and_b32 v40, 1, v40
v_lshl_add_u32 v38, v40, 2, v38
s_lshl_b32 s88, s68, 1
v_xor_b32 v38, s88, v38
v_lshl_add_u32 v39, v38, 5, v39
v_and_b32 v38, 3, v0
v_lshl_add_u32 v44, v38, 3, v39
v_mov_b32 v36, 0x3f803f80
v_mov_b32 v37, 0x3f803f80
v_lshlrev_b32 v58, 4, v0
v_xor_b32 v45, 32, v44
v_xor_b32 v46, 64, v44
v_xor_b32 v47, 96, v44
v_xor_b32 v48, 128, v44
v_xor_b32 v49, 160, v44
v_xor_b32 v50, 192, v44
v_xor_b32 v51, 224, v44
v_add_u32 v232, 0x10000, v44
v_add_u32 v233, 0x10000, v45
v_add_u32 v234, 0x10000, v46
v_add_u32 v235, 0x10000, v47
v_add_u32 v236, 0x10000, v48
v_add_u32 v237, 0x10000, v49
v_add_u32 v238, 0x10000, v50
v_add_u32 v239, 0x10000, v51
s_lshl_b32 s88, s82, 4
v_lshl_add_u32 v42, v20, 4, s88
v_lshl_add_u32 v42, v21, 15, v42
v_add_u32 v61, 65536, v42
s_lshl_b32 s89, s70, 2
s_xor_b32 s88, s68, 0
s_add_u32 s88, s88, s89
s_lshl_b32 s92, s88, 17
s_xor_b32 s88, s68, 1
s_add_u32 s88, s88, s89
s_lshl_b32 s93, s88, 17
s_xor_b32 s88, s68, 2
s_add_u32 s88, s88, s89
s_lshl_b32 s94, s88, 17
s_xor_b32 s88, s68, 3
s_add_u32 s88, s88, s89
s_lshl_b32 s95, s88, 17
s_mul_i32 s17, s80, 24
s_add_u32 s17, s17, s81
s_cmp_lt_u32 s81, 24
s_cselect_b32 s17, s17, 255
s_mul_i32 s84, s17, 6554
s_lshr_b32 s84, s84, 16
s_mul_i32 s88, s84, 10
s_sub_u32 s85, s17, s88
s_lshl_b32 s84, s84, 2
s_add_u32 s84, s84, s68
s_mov_b32 s89, 819200
s_cmp_lt_u32 s84, 54
s_cselect_b32 s64, s14, s8
s_cselect_b32 s65, s15, s9
s_cselect_b32 s66, 2211840, s89
s_mov_b32 s67, 0x20000
s_cmp_lt_u32 s84, 74
s_cselect_b32 s66, s66, 0
v_lshrrev_b32 v24, 3, v0
v_and_b32 v38, 7, v0
v_lshlrev_b32 v38, 4, v38
s_lshl_b32 s88, s85, 7
v_add_u32 v38, s88, v38
s_movk_i32 s88, 1280
v_mad_u32_u24 v25, v24, s88, v38
v_lshrrev_b32 v24, 2, v24
s_lshl_b32 s88, s84, 2
s_add_u32 s88, s88, 40
s_and_b32 s88, s88, 0x7f
s_mul_i32 s89, s88, 205
s_lshr_b32 s89, s89, 10
s_mul_i32 s90, s89, 5
s_sub_u32 s88, s88, s90
s_mul_i32 s89, s89, 40
s_mul_i32 s90, s88, 5
s_lshr_b32 s90, 0x010e5100, s90
s_and_b32 s90, s90, 31
s_add_u32 s89, s89, s90
s_cmp_eq_u32 s88, 4
s_cselect_b32 s88, 20480, 0
s_lshl_b32 s90, s84, 5
s_add_u32 s90, s90, 0
s_cmp_lt_u32 s84, 54
s_cselect_b32 s89, s90, s89
s_cselect_b32 s88, 0, s88
s_mul_i32 s96, s89, 1280
v_mad_u32_u24 v22, v24, s88, v25
s_lshl_b32 s88, s85, 2
s_add_u32 s88, s88, 0
s_mul_i32 s89, s88, 205
s_lshr_b32 s89, s89, 10
s_mul_i32 s90, s89, 365
s_add_u32 s88, s88, s90
s_mul_i32 s89, s84, 5
s_add_u32 s88, s88, s89
s_lshl_b32 s88, s88, 10
s_cmp_lt_u32 s84, 74
s_cselect_b32 s100, s88, 2147483648
s_lshl_b32 s88, s84, 2
s_add_u32 s88, s88, 41
s_and_b32 s88, s88, 0x7f
s_mul_i32 s89, s88, 205
s_lshr_b32 s89, s89, 10
s_mul_i32 s90, s89, 5
s_sub_u32 s88, s88, s90
s_mul_i32 s89, s89, 40
s_mul_i32 s90, s88, 5
s_lshr_b32 s90, 0x010e5100, s90
s_and_b32 s90, s90, 31
s_add_u32 s89, s89, s90
s_cmp_eq_u32 s88, 4
s_cselect_b32 s88, 20480, 0
s_lshl_b32 s90, s84, 5
s_add_u32 s90, s90, 8
s_cmp_lt_u32 s84, 54
s_cselect_b32 s89, s90, s89
s_cselect_b32 s88, 0, s88
s_mul_i32 s97, s89, 1280
v_mad_u32_u24 v23, v24, s88, v25
s_lshl_b32 s88, s85, 2
s_add_u32 s88, s88, 1
s_mul_i32 s89, s88, 205
s_lshr_b32 s89, s89, 10
s_mul_i32 s90, s89, 365
s_add_u32 s88, s88, s90
s_mul_i32 s89, s84, 5
s_add_u32 s88, s88, s89
s_lshl_b32 s88, s88, 10
s_cmp_lt_u32 s84, 74
s_cselect_b32 s101, s88, 2147483648
s_lshl_b32 s88, s84, 2
s_add_u32 s88, s88, 42
s_and_b32 s88, s88, 0x7f
s_mul_i32 s89, s88, 205
s_lshr_b32 s89, s89, 10
s_mul_i32 s90, s89, 5
s_sub_u32 s88, s88, s90
s_mul_i32 s89, s89, 40
s_mul_i32 s90, s88, 5
s_lshr_b32 s90, 0x010e5100, s90
s_and_b32 s90, s90, 31
s_add_u32 s89, s89, s90
s_cmp_eq_u32 s88, 4
s_cselect_b32 s88, 20480, 0
s_lshl_b32 s90, s84, 5
s_add_u32 s90, s90, 16
s_cmp_lt_u32 s84, 54
s_cselect_b32 s89, s90, s89
s_cselect_b32 s88, 0, s88
s_mul_i32 s98, s89, 1280
v_mad_u32_u24 v40, v24, s88, v25
s_lshl_b32 s88, s85, 2
s_add_u32 s88, s88, 2
s_mul_i32 s89, s88, 205
s_lshr_b32 s89, s89, 10
s_mul_i32 s90, s89, 365
s_add_u32 s88, s88, s90
s_mul_i32 s89, s84, 5
s_add_u32 s88, s88, s89
s_lshl_b32 s88, s88, 10
s_cmp_lt_u32 s84, 74
s_cselect_b32 s0, s88, 2147483648
s_lshl_b32 s88, s84, 2
s_add_u32 s88, s88, 43
s_and_b32 s88, s88, 0x7f
s_mul_i32 s89, s88, 205
s_lshr_b32 s89, s89, 10
s_mul_i32 s90, s89, 5
s_sub_u32 s88, s88, s90
s_mul_i32 s89, s89, 40
s_mul_i32 s90, s88, 5
s_lshr_b32 s90, 0x010e5100, s90
s_and_b32 s90, s90, 31
s_add_u32 s89, s89, s90
s_cmp_eq_u32 s88, 4
s_cselect_b32 s88, 20480, 0
s_lshl_b32 s90, s84, 5
s_add_u32 s90, s90, 24
s_cmp_lt_u32 s84, 54
s_cselect_b32 s89, s90, s89
s_cselect_b32 s88, 0, s88
s_mul_i32 s99, s89, 1280
v_mad_u32_u24 v41, v24, s88, v25
s_lshl_b32 s88, s85, 2
s_add_u32 s88, s88, 3
s_mul_i32 s89, s88, 205
s_lshr_b32 s89, s89, 10
s_mul_i32 s90, s89, 365
s_add_u32 s88, s88, s90
s_mul_i32 s89, s84, 5
s_add_u32 s88, s88, s89
s_lshl_b32 s88, s88, 10
s_cmp_lt_u32 s84, 74
s_cselect_b32 s1, s88, 2147483648
v_lshrrev_b32 v38, 4, v0
v_bfe_u32 v39, v0, 2, 2
v_lshl_add_u32 v38, v38, 3, v39
v_lshlrev_b32 v38, 7, v38
v_and_b32 v39, 3, v0
v_lshl_add_u32 v38, v39, 3, v38
s_add_u32 s88, s76, 147456
v_add_u32 v19, s88, v38
s_lshl_b32 s88, s83, 7
s_lshl_b32 s17, s17, 7
s_add_u32 s17, s17, 688128
s_add_u32 s18, s88, 655360
s_lshl_b32 s89, s68, 2
s_add_u32 s18, s18, s89
s_lshl_b32 s88, s83, 4
s_lshl_b32 s89, s68, 2
s_add_u32 s88, s88, s89
s_add_u32 s19, s88, 720896
s_lshl_b32 s88, s70, 2
s_add_u32 s88, s88, s68
s_mul_i32 s88, s88, 2560
s_add_u32 s21, s88, 327680
s_lshl_b32 s88, s71, 8
s_add_u32 s88, s88, s21
s_cmp_lt_u32 s69, 10
s_cselect_b32 s86, s88, 2147483648
v_lshlrev_b32 v60, 2, v0
s_cmp_eq_u32 s70, 15
s_cbranch_scc1 L_helper
s_lshr_b32 s88, s80, 1
s_lshl_b32 s88, s88, 3
s_and_b32 s91, s81, 7
s_add_u32 s77, s88, s91
s_and_b32 s88, s80, 1
s_lshl_b32 s88, s88, 2
s_lshr_b32 s91, s81, 3
s_add_u32 s78, s88, s91
s_lshr_b32 s88, s81, 4
s_lshl_b32 s80, s80, 1
s_add_u32 s80, s80, s88
s_and_b32 s81, s81, 15
s_lshl_b32 s88, s81, 4
s_add_u32 s88, s88, s80
s_lshl_b32 s88, s88, 4
s_lshl_b32 s91, s68, 2
s_add_u32 s88, s88, s91
s_add_u32 s20, s88, 724992
v_min_u32 v243, 13, v0
v_lshrrev_b32 v240, 2, v243
s_lshl_b32 s88, s81, 2
s_mul_i32 s91, s68, 3
s_add_u32 s91, s91, s88
s_sub_u32 s91, s91, 8
v_add_u32 v240, s91, v240
v_max_i32 v240, 0, v240
v_bfe_u32 v241, v243, 1, 1
v_mad_u32_u24 v241, v241, 5, 5
s_add_u32 s88, s88, s68
v_mov_b32 v242, s88
v_cmp_gt_u32 vcc, 12, v243
s_nop 1
v_cndmask_b32 v240, v242, v240, vcc
v_cndmask_b32 v241, 0, v241, vcc
v_and_b32 v242, 1, v243
s_mul_i32 s88, s80, 40
v_mad_u32_u24 v242, v242, 39, s88
v_lshrrev_b32 v242, 7, v242
v_add_u32 v241, v241, v242
v_lshrrev_b32 v242, 2, v240
v_lshl_add_u32 v241, v242, 4, v241
v_lshlrev_b32 v241, 7, v241
v_and_b32 v240, 3, v240
v_lshl_add_u32 v241, v240, 2, v241
v_add_u32 v62, 655360, v241
v_min_u32 v241, 37, v0
v_lshrrev_b32 v242, 1, v241
v_and_b32 v241, 1, v241
v_mul_u32_u24 v241, 79, v241
s_mul_i32 s88, s78, 80
v_add_u32 v241, s88, v241
v_lshrrev_b32 v241, 6, v241
v_mad_u32_u24 v241, v242, 10, v241
v_lshlrev_b32 v241, 7, v241
v_add_u32 v55, 688128, v241
v_lshlrev_b32 v240, 4, v20
v_lshl_add_u32 v243, v21, 15, v240
v_accvgpr_write_b32 a224, v243
s_mov_b32 s88, 2490368
v_mad_u32_u24 v242, v21, s88, v240
v_accvgpr_write_b32 a225, v242
v_add_u32 v241, 1, v21
v_lshlrev_b32 v241, 6, v241
v_xor_b32 v242, v243, v241
v_accvgpr_write_b32 a226, v242
v_sub_u32 v241, 1, v21
v_mul_u32_u24 v241, 0xc0, v241
v_xor_b32 v242, v243, v241
v_accvgpr_write_b32 a227, v242
s_lshl_b32 s91, s81, 11
s_lshl_b32 s88, s68, 9
s_add_u32 s91, s91, s88
v_add_u32 v242, s91, v243
v_accvgpr_write_b32 a228, v242
s_mul_i32 s88, s68, 5632
s_add_u32 s88, s88, 81920
v_add_u32 v240, s88, v240
v_lshl_add_u32 v242, v21, 9, v240
v_accvgpr_write_b32 a229, v242
v_add_u32 v242, 1536, v242
v_accvgpr_write_b32 a230, v242
v_lshl_add_u32 v242, v21, 12, v240
v_add_u32 v242, 0x400, v242
v_accvgpr_write_b32 a231, v242
v_bfe_u32 v240, v0, 4, 1
v_and_b32 v241, 3, v0
v_lshl_add_u32 v240, v240, 2, v241
v_lshlrev_b32 v240, 2, v240
v_mov_b32 v242, 0xaaa76655
v_lshrrev_b32 v241, v240, v242
v_and_b32 v241, 15, v241
v_lshlrev_b32 v243, 9, v241
v_mov_b32 v242, 0x77743210
v_lshrrev_b32 v241, v240, v242
v_and_b32 v240, 1, v241
v_lshl_add_u32 v243, v240, 3, v243
v_bfe_u32 v241, v241, 1, 2
v_xor_b32 v241, v241, v21
v_lshl_add_u32 v243, v241, 6, v243
v_bfe_u32 v241, v0, 2, 2
v_lshl_add_u32 v243, v241, 4, v243
v_xor_b32 v242, 0x80, v243
v_add_u32 v243, s88, v243
v_add_u32 v242, s88, v242
v_accvgpr_write_b32 a232, v243
v_accvgpr_write_b32 a233, v242
v_bfe_u32 v240, v0, 4, 1
v_and_b32 v241, 3, v0
v_lshl_add_u32 v240, v240, 2, v241
v_lshlrev_b32 v240, 2, v240
v_mov_b32 v242, 0xaaa99887
v_lshrrev_b32 v241, v240, v242
v_and_b32 v241, 15, v241
v_lshlrev_b32 v243, 9, v241
v_mov_b32 v242, 0x33310765
v_lshrrev_b32 v241, v240, v242
v_and_b32 v240, 1, v241
v_lshl_add_u32 v243, v240, 3, v243
v_bfe_u32 v241, v241, 1, 2
v_xor_b32 v241, v241, v21
v_lshl_add_u32 v243, v241, 6, v243
v_bfe_u32 v241, v0, 2, 2
v_lshl_add_u32 v243, v241, 4, v243
v_xor_b32 v242, 0x80, v243
v_add_u32 v243, s88, v243
v_add_u32 v242, s88, v242
v_accvgpr_write_b32 a234, v243
v_accvgpr_write_b32 a235, v242
s_lshl_b32 s88, s81, 2
s_mul_i32 s91, s68, 3
s_add_u32 s87, s88, s91
s_mul_i32 s6, s80, 163840
s_mul_i32 s7, s68, 16896
s_add_u32 s88, s87, 0
s_sub_u32 s91, s88, 8
s_lshl_b32 s91, s91, 9
s_add_u32 s91, s91, s6
s_cmp_ge_u32 s88, 8
s_cselect_b32 s8, s91, 2147483648
s_add_u32 s88, s87, 1
s_sub_u32 s91, s88, 8
s_lshl_b32 s91, s91, 9
s_add_u32 s91, s91, s6
s_cmp_ge_u32 s88, 8
s_cselect_b32 s9, s91, 2147483648
s_add_u32 s88, s87, 2
s_sub_u32 s91, s88, 8
s_lshl_b32 s91, s91, 9
s_add_u32 s91, s91, s6
s_cmp_ge_u32 s88, 8
s_cselect_b32 s10, s91, 2147483648
s_mul_i32 s13, s78, 378880
s_add_u32 s14, s13, 286720
s_add_u32 s16, s13, 272384
s_mov_b32 s90, 0
s_mul_i32 s88, s90, 20480
s_add_u32 s12, s13, s88
s_add_u32 s11, s12, 163840
s_cmp_ge_u32 s11, s14
s_cselect_b32 s88, 286720, 0
s_sub_u32 s11, s11, s88
s_lshl_b32 s15, s90, 19
s_mul_i32 s88, s68, 5120
v_add_u32 v57, s88, v58
v_add_u32 v242, 0x1000, v57
v_accvgpr_write_b32 a236, v242
s_lshl_b32 s88, s68, 10
v_add_u32 v242, s88, v58
v_accvgpr_write_b32 a237, v242
v_and_b32 v240, 15, v0
v_lshrrev_b32 v241, 4, v0
v_lshlrev_b32 v241, 15, v241
v_lshl_add_u32 v240, v240, 4, v241
s_lshl_b32 s88, s77, 10
v_add_u32 v240, s88, v240
s_lshl_b32 s91, s68, 8
v_add_u32 v242, s91, v240
v_accvgpr_write_b32 a238, v242
s_lshr_b32 s88, s77, 1
s_lshl_b32 s88, s88, 8
v_lshl_add_u32 v59, v0, 2, s88
s_add_u32 s88, s68, 1
s_and_b32 s88, s88, 3
s_lshl_b32 s88, s88, 8
s_lshl_b32 s91, s68, 17
s_add_u32 s88, s88, s91
v_add_u32 v242, s88, v240
v_accvgpr_write_b32 a252, v242
s_add_u32 s88, s68, 2
s_and_b32 s88, s88, 3
s_lshl_b32 s88, s88, 8
s_lshl_b32 s91, s68, 17
s_add_u32 s88, s88, s91
v_add_u32 v242, s88, v240
v_accvgpr_write_b32 a253, v242
s_add_u32 s88, s68, 3
s_and_b32 s88, s88, 3
s_lshl_b32 s88, s88, 8
s_lshl_b32 s91, s68, 17
s_add_u32 s88, s88, s91
v_add_u32 v242, s88, v240
v_accvgpr_write_b32 a254, v242
s_add_u32 s88, s68, 4
s_and_b32 s88, s88, 3
s_lshl_b32 s88, s88, 8
s_lshl_b32 s91, s68, 17
s_add_u32 s88, s88, s91
v_add_u32 v242, s88, v240
v_accvgpr_write_b32 a255, v242
s_add_u32 m0, s76, 98304
s_nop 0
buffer_load_dwordx4 v2, s[24:27], s74 offen lds
s_add_u32 m0, s76, 99328
s_nop 0
buffer_load_dwordx4 v3, s[24:27], s74 offen lds
s_add_u32 m0, s76, 100352
s_nop 0
buffer_load_dwordx4 v4, s[24:27], s74 offen lds
s_add_u32 m0, s76, 101376
s_nop 0
buffer_load_dwordx4 v5, s[24:27], s74 offen lds
s_add_u32 s74, s74, 128
s_sub_u32 s89, s74, 1280
s_min_u32 s74, s74, s89
s_add_u32 m0, s76, 32768
s_nop 0
buffer_load_dwordx4 v10, s[28:31], s73 offen lds
s_add_u32 m0, s76, 33792
s_nop 0
buffer_load_dwordx4 v11, s[28:31], s73 offen lds
s_add_u32 m0, s76, 34816
s_nop 0
buffer_load_dwordx4 v12, s[28:31], s73 offen lds
s_add_u32 m0, s76, 35840
s_nop 0
buffer_load_dwordx4 v13, s[28:31], s73 offen lds
s_add_u32 s73, s73, 245760
s_sub_u32 s85, s73, 2457600
s_min_u32 s73, s73, s85
s_waitcnt vmcnt(12)
s_barrier
ds_read_b128 a[0:3], v6 offset:0
ds_read_b64_tr_b16 v[216:217], v44 offset:0
ds_read_b64_tr_b16 v[218:219], v44 offset:1024
ds_read_b128 a[4:7], v6 offset:2048
ds_read_b64_tr_b16 v[220:221], v45 offset:0
ds_read_b64_tr_b16 v[222:223], v45 offset:1024
ds_read_b64_tr_b16 v[192:193], v46 offset:0
ds_read_b64_tr_b16 v[194:195], v46 offset:1024
ds_read_b64_tr_b16 v[196:197], v47 offset:0
ds_read_b64_tr_b16 v[198:199], v47 offset:1024
ds_read_b64_tr_b16 v[200:201], v48 offset:0
ds_read_b64_tr_b16 v[202:203], v48 offset:1024
ds_read_b64_tr_b16 v[204:205], v49 offset:0
ds_read_b64_tr_b16 v[206:207], v49 offset:1024
ds_read_b64_tr_b16 v[208:209], v50 offset:0
ds_read_b64_tr_b16 v[210:211], v50 offset:1024
ds_read_b64_tr_b16 v[212:213], v51 offset:0
ds_read_b64_tr_b16 v[214:215], v51 offset:1024
ds_read_b128 a[8:11], v7 offset:0
ds_read_b128 a[12:15], v7 offset:2048
ds_read_b64_tr_b16 v[224:225], v44 offset:8192
ds_read_b64_tr_b16 v[226:227], v44 offset:9216
ds_read_b64_tr_b16 v[228:229], v45 offset:8192
ds_read_b64_tr_b16 v[230:231], v45 offset:9216
s_waitcnt lgkmcnt(15)
v_mfma_f32_16x16x32_bf16 v[64:67], v[216:219], a[0:3], 0
s_add_u32 m0, s76, 114688
s_nop 0
buffer_load_dwordx4 v2, s[24:27], s74 offen lds
v_mfma_f32_16x16x32_bf16 v[68:71], v[216:219], a[4:7], 0
v_mfma_f32_16x16x32_bf16 v[72:75], v[220:223], a[0:3], 0
v_mfma_f32_16x16x32_bf16 v[76:79], v[220:223], a[4:7], 0
v_mfma_f32_4x4x4bf16_1k v[32:35], v[36:37], v[216:217], 0
s_add_u32 m0, s76, 115712
v_mfma_f32_4x4x4bf16_1k v[252:255], v[36:37], v[220:221], 0
buffer_load_dwordx4 v3, s[24:27], s74 offen lds
v_mfma_f32_4x4x4bf16_1k v[32:35], v[36:37], v[218:219], v[32:35]
v_mfma_f32_4x4x4bf16_1k v[252:255], v[36:37], v[222:223], v[252:255]
s_waitcnt lgkmcnt(3)
v_mfma_f32_4x4x4bf16_1k v[32:35], v[36:37], v[224:225], v[32:35]
s_waitcnt lgkmcnt(1)
v_mfma_f32_4x4x4bf16_1k v[252:255], v[36:37], v[228:229], v[252:255]
v_mfma_f32_4x4x4bf16_1k v[32:35], v[36:37], v[226:227], v[32:35]
s_waitcnt lgkmcnt(0)
v_mfma_f32_4x4x4bf16_1k v[252:255], v[36:37], v[230:231], v[252:255]
v_mfma_f32_16x16x32_bf16 v[80:83], v[192:195], a[0:3], 0
v_mfma_f32_16x16x32_bf16 v[84:87], v[192:195], a[4:7], 0
ds_read_b64_tr_b16 v[192:193], v46 offset:8192
v_mfma_f32_16x16x32_bf16 v[88:91], v[196:199], a[0:3], 0
ds_read_b64_tr_b16 v[194:195], v46 offset:9216
v_mfma_f32_16x16x32_bf16 v[92:95], v[196:199], a[4:7], 0
ds_read_b64_tr_b16 v[196:197], v47 offset:8192
v_mfma_f32_16x16x32_bf16 v[96:99], v[200:203], a[0:3], 0
s_add_u32 m0, s76, 116736
ds_read_b64_tr_b16 v[198:199], v47 offset:9216
buffer_load_dwordx4 v4, s[24:27], s74 offen lds
v_mfma_f32_16x16x32_bf16 v[100:103], v[200:203], a[4:7], 0
ds_read_b64_tr_b16 v[200:201], v48 offset:8192
v_mfma_f32_16x16x32_bf16 v[104:107], v[204:207], a[0:3], 0
ds_read_b64_tr_b16 v[202:203], v48 offset:9216
v_mfma_f32_16x16x32_bf16 v[108:111], v[204:207], a[4:7], 0
ds_read_b64_tr_b16 v[204:205], v49 offset:8192
v_mfma_f32_16x16x32_bf16 v[112:115], v[208:211], a[0:3], 0
ds_read_b64_tr_b16 v[206:207], v49 offset:9216
v_mfma_f32_16x16x32_bf16 v[116:119], v[208:211], a[4:7], 0
s_add_u32 m0, s76, 117760
ds_read_b64_tr_b16 v[208:209], v50 offset:8192
buffer_load_dwordx4 v5, s[24:27], s74 offen lds
v_mfma_f32_16x16x32_bf16 v[120:123], v[212:215], a[0:3], 0
s_add_u32 s74, s74, 128
ds_read_b64_tr_b16 v[210:211], v50 offset:9216
s_sub_u32 s89, s74, 1280
v_mfma_f32_16x16x32_bf16 v[124:127], v[212:215], a[4:7], 0
s_waitcnt lgkmcnt(6)
ds_read_b64_tr_b16 v[212:213], v51 offset:8192
s_min_u32 s74, s74, s89
v_mfma_f32_16x16x32_bf16 v[64:67], v[224:227], a[8:11], v[64:67]
ds_read_b64_tr_b16 v[214:215], v51 offset:9216
v_mfma_f32_16x16x32_bf16 v[68:71], v[224:227], a[12:15], v[68:71]
s_waitcnt vmcnt(8)
s_barrier
v_mfma_f32_16x16x32_bf16 v[72:75], v[228:231], a[8:11], v[72:75]
ds_read_b64_tr_b16 v[216:217], v44 offset:16384
ds_read_b64_tr_b16 v[218:219], v44 offset:17408
v_mfma_f32_16x16x32_bf16 v[76:79], v[228:231], a[12:15], v[76:79]
ds_read_b128 a[16:19], v6 offset:16384
ds_read_b128 a[20:23], v6 offset:18432
v_mfma_f32_16x16x32_bf16 v[80:83], v[192:195], a[8:11], v[80:83]
ds_read_b64_tr_b16 v[220:221], v45 offset:16384
ds_read_b64_tr_b16 v[222:223], v45 offset:17408
v_mfma_f32_16x16x32_bf16 v[84:87], v[192:195], a[12:15], v[84:87]
s_add_u32 m0, s76, 49152
ds_read_b64_tr_b16 v[192:193], v46 offset:16384
buffer_load_dwordx4 v10, s[28:31], s73 offen lds
v_mfma_f32_16x16x32_bf16 v[88:91], v[196:199], a[8:11], v[88:91]
ds_read_b64_tr_b16 v[194:195], v46 offset:17408
ds_read_b64_tr_b16 v[224:225], v44 offset:24576
v_mfma_f32_16x16x32_bf16 v[92:95], v[196:199], a[12:15], v[92:95]
s_waitcnt lgkmcnt(9)
ds_read_b64_tr_b16 v[196:197], v47 offset:16384
ds_read_b64_tr_b16 v[226:227], v44 offset:25600
v_mfma_f32_16x16x32_bf16 v[96:99], v[200:203], a[8:11], v[96:99]
ds_read_b64_tr_b16 v[198:199], v47 offset:17408
ds_read_b64_tr_b16 v[228:229], v45 offset:24576
v_mfma_f32_16x16x32_bf16 v[100:103], v[200:203], a[12:15], v[100:103]
s_add_u32 m0, s76, 131072
ds_read_b64_tr_b16 v[200:201], v48 offset:16384
buffer_load_dwordx4 v2, s[24:27], s74 offen lds
v_mfma_f32_16x16x32_bf16 v[104:107], v[204:207], a[8:11], v[104:107]
ds_read_b64_tr_b16 v[202:203], v48 offset:17408
ds_read_b64_tr_b16 v[230:231], v45 offset:25600
v_mfma_f32_16x16x32_bf16 v[108:111], v[204:207], a[12:15], v[108:111]
ds_read_b64_tr_b16 v[204:205], v49 offset:16384
v_mfma_f32_16x16x32_bf16 v[112:115], v[208:211], a[8:11], v[112:115]
ds_read_b64_tr_b16 v[206:207], v49 offset:17408
v_mfma_f32_16x16x32_bf16 v[116:119], v[208:211], a[12:15], v[116:119]
s_add_u32 m0, s76, 50176
ds_read_b64_tr_b16 v[208:209], v50 offset:16384
buffer_load_dwordx4 v11, s[28:31], s73 offen lds
v_mfma_f32_16x16x32_bf16 v[120:123], v[212:215], a[8:11], v[120:123]
ds_read_b64_tr_b16 v[210:211], v50 offset:17408
v_mfma_f32_16x16x32_bf16 v[124:127], v[212:215], a[12:15], v[124:127]
s_waitcnt lgkmcnt(8)
ds_read_b64_tr_b16 v[212:213], v51 offset:16384
v_mfma_f32_16x16x32_bf16 v[64:67], v[216:219], a[16:19], v[64:67]
ds_read_b64_tr_b16 v[214:215], v51 offset:17408
v_mfma_f32_16x16x32_bf16 v[68:71], v[216:219], a[20:23], v[68:71]
s_add_u32 m0, s76, 132096
s_nop 0
buffer_load_dwordx4 v3, s[24:27], s74 offen lds
v_mfma_f32_16x16x32_bf16 v[72:75], v[220:223], a[16:19], v[72:75]
ds_read_b128 a[24:27], v7 offset:16384
v_mfma_f32_16x16x32_bf16 v[76:79], v[220:223], a[20:23], v[76:79]
v_mfma_f32_16x16x32_bf16 v[80:83], v[192:195], a[16:19], v[80:83]
ds_read_b128 a[28:31], v7 offset:18432
v_mfma_f32_16x16x32_bf16 v[84:87], v[192:195], a[20:23], v[84:87]
s_add_u32 m0, s76, 51200
ds_read_b64_tr_b16 v[192:193], v46 offset:24576
buffer_load_dwordx4 v12, s[28:31], s73 offen lds
v_mfma_f32_16x16x32_bf16 v[88:91], v[196:199], a[16:19], v[88:91]
ds_read_b64_tr_b16 v[194:195], v46 offset:25600
v_mfma_f32_16x16x32_bf16 v[92:95], v[196:199], a[20:23], v[92:95]
s_waitcnt lgkmcnt(4)
ds_read_b64_tr_b16 v[196:197], v47 offset:24576
v_mfma_f32_16x16x32_bf16 v[96:99], v[200:203], a[16:19], v[96:99]
ds_read_b64_tr_b16 v[198:199], v47 offset:25600
v_mfma_f32_16x16x32_bf16 v[100:103], v[200:203], a[20:23], v[100:103]
s_add_u32 m0, s76, 133120
ds_read_b64_tr_b16 v[200:201], v48 offset:24576
buffer_load_dwordx4 v4, s[24:27], s74 offen lds
v_mfma_f32_16x16x32_bf16 v[104:107], v[204:207], a[16:19], v[104:107]
ds_read_b64_tr_b16 v[202:203], v48 offset:25600
v_mfma_f32_16x16x32_bf16 v[108:111], v[204:207], a[20:23], v[108:111]
ds_read_b64_tr_b16 v[204:205], v49 offset:24576
v_mfma_f32_16x16x32_bf16 v[112:115], v[208:211], a[16:19], v[112:115]
ds_read_b64_tr_b16 v[206:207], v49 offset:25600
v_mfma_f32_16x16x32_bf16 v[116:119], v[208:211], a[20:23], v[116:119]
s_add_u32 m0, s76, 52224
ds_read_b64_tr_b16 v[208:209], v50 offset:24576
buffer_load_dwordx4 v13, s[28:31], s73 offen lds
v_mfma_f32_16x16x32_bf16 v[120:123], v[212:215], a[16:19], v[120:123]
s_add_u32 s73, s73, 245760
ds_read_b64_tr_b16 v[210:211], v50 offset:25600
s_sub_u32 s85, s73, 2457600
v_mfma_f32_16x16x32_bf16 v[124:127], v[212:215], a[20:23], v[124:127]
s_waitcnt lgkmcnt(6)
ds_read_b64_tr_b16 v[212:213], v51 offset:24576
s_min_u32 s73, s73, s85
v_mfma_f32_16x16x32_bf16 v[64:67], v[224:227], a[24:27], v[64:67]
ds_read_b64_tr_b16 v[214:215], v51 offset:25600
v_mfma_f32_16x16x32_bf16 v[68:71], v[224:227], a[28:31], v[68:71]
s_waitcnt vmcnt(7)
s_barrier
s_add_u32 m0, s76, 134144
s_nop 0
buffer_load_dwordx4 v5, s[24:27], s74 offen lds
v_mfma_f32_16x16x32_bf16 v[72:75], v[228:231], a[24:27], v[72:75]
s_add_u32 s74, s74, 128
ds_read_b64_tr_b16 v[216:217], v44 offset:32768
ds_read_b64_tr_b16 v[218:219], v44 offset:33792
v_mfma_f32_16x16x32_bf16 v[76:79], v[228:231], a[28:31], v[76:79]
s_sub_u32 s89, s74, 1280
ds_read_b128 a[32:35], v6 offset:32768
ds_read_b128 a[36:39], v6 offset:34816
v_mfma_f32_16x16x32_bf16 v[80:83], v[192:195], a[24:27], v[80:83]
s_min_u32 s74, s74, s89
ds_read_b64_tr_b16 v[220:221], v45 offset:32768
ds_read_b64_tr_b16 v[222:223], v45 offset:33792
v_mfma_f32_16x16x32_bf16 v[84:87], v[192:195], a[28:31], v[84:87]
s_add_u32 m0, s76, 65536
ds_read_b64_tr_b16 v[192:193], v46 offset:32768
buffer_load_dwordx4 v10, s[28:31], s73 offen lds
v_mfma_f32_16x16x32_bf16 v[88:91], v[196:199], a[24:27], v[88:91]
ds_read_b64_tr_b16 v[194:195], v46 offset:33792
ds_read_b64_tr_b16 v[224:225], v44 offset:40960
v_mfma_f32_16x16x32_bf16 v[92:95], v[196:199], a[28:31], v[92:95]
s_waitcnt lgkmcnt(9)
ds_read_b64_tr_b16 v[196:197], v47 offset:32768
ds_read_b64_tr_b16 v[226:227], v44 offset:41984
v_mfma_f32_16x16x32_bf16 v[96:99], v[200:203], a[24:27], v[96:99]
ds_read_b64_tr_b16 v[198:199], v47 offset:33792
ds_read_b64_tr_b16 v[228:229], v45 offset:40960
v_mfma_f32_16x16x32_bf16 v[100:103], v[200:203], a[28:31], v[100:103]
s_add_u32 m0, s76, 81920
ds_read_b64_tr_b16 v[200:201], v48 offset:32768
buffer_load_dwordx4 v2, s[24:27], s74 offen lds
v_mfma_f32_16x16x32_bf16 v[104:107], v[204:207], a[24:27], v[104:107]
ds_read_b64_tr_b16 v[202:203], v48 offset:33792
ds_read_b64_tr_b16 v[230:231], v45 offset:41984
v_mfma_f32_16x16x32_bf16 v[108:111], v[204:207], a[28:31], v[108:111]
ds_read_b64_tr_b16 v[204:205], v49 offset:32768
v_mfma_f32_16x16x32_bf16 v[112:115], v[208:211], a[24:27], v[112:115]
ds_read_b64_tr_b16 v[206:207], v49 offset:33792
v_mfma_f32_16x16x32_bf16 v[116:119], v[208:211], a[28:31], v[116:119]
s_add_u32 m0, s76, 66560
ds_read_b64_tr_b16 v[208:209], v50 offset:32768
buffer_load_dwordx4 v11, s[28:31], s73 offen lds
v_mfma_f32_16x16x32_bf16 v[120:123], v[212:215], a[24:27], v[120:123]
ds_read_b64_tr_b16 v[210:211], v50 offset:33792
v_mfma_f32_16x16x32_bf16 v[124:127], v[212:215], a[28:31], v[124:127]
s_waitcnt lgkmcnt(8)
ds_read_b64_tr_b16 v[212:213], v51 offset:32768
v_mfma_f32_16x16x32_bf16 v[64:67], v[216:219], a[32:35], v[64:67]
ds_read_b64_tr_b16 v[214:215], v51 offset:33792
v_mfma_f32_16x16x32_bf16 v[68:71], v[216:219], a[36:39], v[68:71]
s_add_u32 m0, s76, 82944
s_nop 0
buffer_load_dwordx4 v3, s[24:27], s74 offen lds
v_mfma_f32_16x16x32_bf16 v[72:75], v[220:223], a[32:35], v[72:75]
ds_read_b128 a[40:43], v7 offset:32768
v_mfma_f32_16x16x32_bf16 v[76:79], v[220:223], a[36:39], v[76:79]
v_mfma_f32_16x16x32_bf16 v[80:83], v[192:195], a[32:35], v[80:83]
ds_read_b128 a[44:47], v7 offset:34816
v_mfma_f32_16x16x32_bf16 v[84:87], v[192:195], a[36:39], v[84:87]
s_add_u32 m0, s76, 67584
ds_read_b64_tr_b16 v[192:193], v46 offset:40960
buffer_load_dwordx4 v12, s[28:31], s73 offen lds
v_mfma_f32_16x16x32_bf16 v[88:91], v[196:199], a[32:35], v[88:91]
ds_read_b64_tr_b16 v[194:195], v46 offset:41984
v_mfma_f32_16x16x32_bf16 v[92:95], v[196:199], a[36:39], v[92:95]
s_waitcnt lgkmcnt(4)
ds_read_b64_tr_b16 v[196:197], v47 offset:40960
s_add_u32 m0, s76, 147456
s_nop 0
buffer_load_dwordx4 v22, s[64:67], s96 offen lds
s_add_u32 m0, s76, 148480
s_nop 0
buffer_load_dwordx4 v23, s[64:67], s97 offen lds
s_add_u32 m0, s76, 149504
s_nop 0
buffer_load_dwordx4 v40, s[64:67], s98 offen lds
s_add_u32 m0, s76, 150528
s_nop 0
buffer_load_dwordx4 v41, s[64:67], s99 offen lds
v_mfma_f32_16x16x32_bf16 v[96:99], v[200:203], a[32:35], v[96:99]
ds_read_b64_tr_b16 v[198:199], v47 offset:41984
v_mfma_f32_16x16x32_bf16 v[100:103], v[200:203], a[36:39], v[100:103]
s_add_u32 m0, s76, 83968
ds_read_b64_tr_b16 v[200:201], v48 offset:40960
buffer_load_dwordx4 v4, s[24:27], s74 offen lds
v_mfma_f32_16x16x32_bf16 v[104:107], v[204:207], a[32:35], v[104:107]
ds_read_b64_tr_b16 v[202:203], v48 offset:41984
v_mfma_f32_16x16x32_bf16 v[108:111], v[204:207], a[36:39], v[108:111]
ds_read_b64_tr_b16 v[204:205], v49 offset:40960
v_mfma_f32_16x16x32_bf16 v[112:115], v[208:211], a[32:35], v[112:115]
ds_read_b64_tr_b16 v[206:207], v49 offset:41984
v_mfma_f32_16x16x32_bf16 v[116:119], v[208:211], a[36:39], v[116:119]
s_add_u32 m0, s76, 68608
ds_read_b64_tr_b16 v[208:209], v50 offset:40960
buffer_load_dwordx4 v13, s[28:31], s73 offen lds
v_mfma_f32_16x16x32_bf16 v[120:123], v[212:215], a[32:35], v[120:123]
s_add_u32 s73, s73, 245760
ds_read_b64_tr_b16 v[210:211], v50 offset:41984
s_sub_u32 s85, s73, 2457600
v_mfma_f32_16x16x32_bf16 v[124:127], v[212:215], a[36:39], v[124:127]
s_waitcnt lgkmcnt(6)
ds_read_b64_tr_b16 v[212:213], v51 offset:40960
buffer_load_dword v18, off, s[60:63], 0 sc1
s_min_u32 s73, s73, s85
v_mfma_f32_16x16x32_bf16 v[64:67], v[224:227], a[40:43], v[64:67]
ds_read_b64_tr_b16 v[214:215], v51 offset:41984
v_mfma_f32_16x16x32_bf16 v[68:71], v[224:227], a[44:47], v[68:71]
s_waitcnt vmcnt(12)
s_barrier
s_add_u32 m0, s76, 84992
s_nop 0
buffer_load_dwordx4 v5, s[24:27], s74 offen lds
v_mfma_f32_16x16x32_bf16 v[72:75], v[228:231], a[40:43], v[72:75]
s_add_u32 s74, s74, 128
ds_read_b64_tr_b16 v[216:217], v44 offset:49152
ds_read_b64_tr_b16 v[218:219], v44 offset:50176
v_mfma_f32_16x16x32_bf16 v[76:79], v[228:231], a[44:47], v[76:79]
s_sub_u32 s89, s74, 1280
ds_read_b128 a[48:51], v6 offset:49152
ds_read_b128 a[52:55], v6 offset:51200
v_mfma_f32_16x16x32_bf16 v[80:83], v[192:195], a[40:43], v[80:83]
s_min_u32 s74, s74, s89
ds_read_b64_tr_b16 v[220:221], v45 offset:49152
ds_read_b64_tr_b16 v[222:223], v45 offset:50176
v_mfma_f32_16x16x32_bf16 v[84:87], v[192:195], a[44:47], v[84:87]
s_add_u32 m0, s76, 0
ds_read_b64_tr_b16 v[192:193], v46 offset:49152
buffer_load_dwordx4 v10, s[28:31], s73 offen lds
v_mfma_f32_16x16x32_bf16 v[88:91], v[196:199], a[40:43], v[88:91]
ds_read_b64_tr_b16 v[194:195], v46 offset:50176
ds_read_b64_tr_b16 v[224:225], v44 offset:57344
v_mfma_f32_16x16x32_bf16 v[92:95], v[196:199], a[44:47], v[92:95]
s_waitcnt lgkmcnt(9)
ds_read_b64_tr_b16 v[196:197], v47 offset:49152
ds_read_b64_tr_b16 v[226:227], v44 offset:58368
v_mfma_f32_16x16x32_bf16 v[96:99], v[200:203], a[40:43], v[96:99]
ds_read_b64_tr_b16 v[198:199], v47 offset:50176
ds_read_b64_tr_b16 v[228:229], v45 offset:57344
v_mfma_f32_16x16x32_bf16 v[100:103], v[200:203], a[44:47], v[100:103]
s_add_u32 m0, s76, 98304
ds_read_b64_tr_b16 v[200:201], v48 offset:49152
buffer_load_dwordx4 v2, s[24:27], s74 offen lds
v_mfma_f32_16x16x32_bf16 v[104:107], v[204:207], a[40:43], v[104:107]
ds_read_b64_tr_b16 v[202:203], v48 offset:50176
ds_read_b64_tr_b16 v[230:231], v45 offset:58368
v_mfma_f32_16x16x32_bf16 v[108:111], v[204:207], a[44:47], v[108:111]
ds_read_b64_tr_b16 v[204:205], v49 offset:49152
s_waitcnt vmcnt(6)
v_mfma_f32_16x16x32_bf16 v[112:115], v[208:211], a[40:43], v[112:115]
ds_read_b64_tr_b16 v[206:207], v49 offset:50176
ds_read_b64_tr_b16 v[128:129], v19 offset:0
v_mfma_f32_16x16x32_bf16 v[116:119], v[208:211], a[44:47], v[116:119]
s_add_u32 m0, s76, 1024
ds_read_b64_tr_b16 v[208:209], v50 offset:49152
buffer_load_dwordx4 v11, s[28:31], s73 offen lds
v_mfma_f32_16x16x32_bf16 v[120:123], v[212:215], a[40:43], v[120:123]
ds_read_b64_tr_b16 v[210:211], v50 offset:50176
ds_read_b64_tr_b16 v[130:131], v19 offset:512
v_mfma_f32_16x16x32_bf16 v[124:127], v[212:215], a[44:47], v[124:127]
s_waitcnt lgkmcnt(10)
ds_read_b64_tr_b16 v[212:213], v51 offset:49152
ds_read_b64_tr_b16 v[132:133], v19 offset:32
v_mfma_f32_16x16x32_bf16 v[64:67], v[216:219], a[48:51], v[64:67]
ds_read_b64_tr_b16 v[214:215], v51 offset:50176
ds_read_b64_tr_b16 v[134:135], v19 offset:544
v_mfma_f32_16x16x32_bf16 v[68:71], v[216:219], a[52:55], v[68:71]
s_add_u32 m0, s76, 99328
s_nop 0
buffer_load_dwordx4 v3, s[24:27], s74 offen lds
ds_read_b64_tr_b16 v[136:137], v19 offset:64
v_mfma_f32_16x16x32_bf16 v[72:75], v[220:223], a[48:51], v[72:75]
ds_read_b128 a[56:59], v7 offset:49152
ds_read_b64_tr_b16 v[138:139], v19 offset:576
v_mfma_f32_16x16x32_bf16 v[76:79], v[220:223], a[52:55], v[76:79]
ds_read_b64_tr_b16 v[140:141], v19 offset:96
ds_read_b64_tr_b16 v[142:143], v19 offset:608
v_mfma_f32_16x16x32_bf16 v[80:83], v[192:195], a[48:51], v[80:83]
ds_read_b128 a[60:63], v7 offset:51200
s_waitcnt vmcnt(5)
v_cmp_eq_u32 vcc, 0, v18
s_nop 0
s_cbranch_vccnz L_retry_2
L_back_3:
v_mfma_f32_16x16x32_bf16 v[84:87], v[192:195], a[52:55], v[84:87]
s_add_u32 m0, s76, 2048
ds_read_b64_tr_b16 v[192:193], v46 offset:57344
buffer_load_dwordx4 v12, s[28:31], s73 offen lds
v_mfma_f32_16x16x32_bf16 v[88:91], v[196:199], a[48:51], v[88:91]
ds_read_b64_tr_b16 v[194:195], v46 offset:58368
v_mfma_f32_16x16x32_bf16 v[92:95], v[196:199], a[52:55], v[92:95]
s_waitcnt lgkmcnt(9)
ds_read_b64_tr_b16 v[196:197], v47 offset:57344
v_readfirstlane_b32 s72, v18
v_mfma_f32_16x16x32_bf16 v[96:99], v[200:203], a[48:51], v[96:99]
ds_read_b64_tr_b16 v[198:199], v47 offset:58368
buffer_store_dwordx4 v[128:131], v58, s[48:51], s100 offen sc1
v_mfma_f32_16x16x32_bf16 v[100:103], v[200:203], a[52:55], v[100:103]
s_add_u32 m0, s76, 100352
ds_read_b64_tr_b16 v[200:201], v48 offset:57344
buffer_load_dwordx4 v4, s[24:27], s74 offen lds
v_mfma_f32_16x16x32_bf16 v[104:107], v[204:207], a[48:51], v[104:107]
ds_read_b64_tr_b16 v[202:203], v48 offset:58368
v_mfma_f32_16x16x32_bf16 v[108:111], v[204:207], a[52:55], v[108:111]
ds_read_b64_tr_b16 v[204:205], v49 offset:57344
v_mfma_f32_16x16x32_bf16 v[112:115], v[208:211], a[48:51], v[112:115]
ds_read_b64_tr_b16 v[206:207], v49 offset:58368
v_mfma_f32_16x16x32_bf16 v[116:119], v[208:211], a[52:55], v[116:119]
s_add_u32 m0, s76, 3072
ds_read_b64_tr_b16 v[208:209], v50 offset:57344
buffer_load_dwordx4 v13, s[28:31], s73 offen lds
v_mfma_f32_16x16x32_bf16 v[120:123], v[212:215], a[48:51], v[120:123]
s_add_u32 s73, s73, 245760
ds_read_b64_tr_b16 v[210:211], v50 offset:58368
s_sub_u32 s85, s73, 2457600
v_mfma_f32_16x16x32_bf16 v[124:127], v[212:215], a[52:55], v[124:127]
s_waitcnt lgkmcnt(6)
ds_read_b64_tr_b16 v[212:213], v51 offset:57344
s_min_u32 s73, s73, s85
v_mfma_f32_16x16x32_bf16 v[64:67], v[224:227], a[56:59], v[64:67]
ds_read_b64_tr_b16 v[214:215], v51 offset:58368
v_mfma_f32_16x16x32_bf16 v[68:71], v[224:227], a[60:63], v[68:71]
s_waitcnt vmcnt(8)
s_barrier
s_add_u32 m0, s76, 101376
s_nop 0
buffer_load_dwordx4 v5, s[24:27], s74 offen lds
v_mfma_f32_16x16x32_bf16 v[72:75], v[228:231], a[56:59], v[72:75]
s_add_u32 s74, s74, 128
ds_read_b64_tr_b16 v[216:217], v232 offset:0
ds_read_b64_tr_b16 v[218:219], v232 offset:1024
v_mfma_f32_16x16x32_bf16 v[76:79], v[228:231], a[60:63], v[76:79]
s_sub_u32 s89, s74, 1280
ds_read_b128 a[64:67], v6 offset:0
ds_read_b128 a[68:71], v6 offset:2048
v_mfma_f32_16x16x32_bf16 v[80:83], v[192:195], a[56:59], v[80:83]
s_min_u32 s74, s74, s89
ds_read_b64_tr_b16 v[220:221], v233 offset:0
ds_read_b64_tr_b16 v[222:223], v233 offset:1024
v_mfma_f32_16x16x32_bf16 v[84:87], v[192:195], a[60:63], v[84:87]
s_add_u32 m0, s76, 16384
ds_read_b64_tr_b16 v[192:193], v234 offset:0
buffer_load_dwordx4 v10, s[28:31], s73 offen lds
v_mfma_f32_16x16x32_bf16 v[88:91], v[196:199], a[56:59], v[88:91]
ds_read_b64_tr_b16 v[194:195], v234 offset:1024
ds_read_b64_tr_b16 v[224:225], v232 offset:8192
v_mfma_f32_16x16x32_bf16 v[92:95], v[196:199], a[60:63], v[92:95]
s_waitcnt lgkmcnt(9)
ds_read_b64_tr_b16 v[196:197], v235 offset:0
ds_read_b64_tr_b16 v[226:227], v232 offset:9216
v_mfma_f32_16x16x32_bf16 v[96:99], v[200:203], a[56:59], v[96:99]
ds_read_b64_tr_b16 v[198:199], v235 offset:1024
ds_read_b64_tr_b16 v[228:229], v233 offset:8192
v_mfma_f32_16x16x32_bf16 v[100:103], v[200:203], a[60:63], v[100:103]
s_add_u32 m0, s76, 114688
ds_read_b64_tr_b16 v[200:201], v236 offset:0
buffer_load_dwordx4 v2, s[24:27], s74 offen lds
v_mfma_f32_16x16x32_bf16 v[104:107], v[204:207], a[56:59], v[104:107]
ds_read_b64_tr_b16 v[202:203], v236 offset:1024
ds_read_b64_tr_b16 v[230:231], v233 offset:9216
v_mfma_f32_16x16x32_bf16 v[108:111], v[204:207], a[60:63], v[108:111]
ds_read_b64_tr_b16 v[204:205], v237 offset:0
buffer_store_dwordx4 v[132:135], v58, s[48:51], s101 offen sc1
v_mfma_f32_16x16x32_bf16 v[112:115], v[208:211], a[56:59], v[112:115]
ds_read_b64_tr_b16 v[206:207], v237 offset:1024
v_mfma_f32_16x16x32_bf16 v[116:119], v[208:211], a[60:63], v[116:119]
s_add_u32 m0, s76, 17408
ds_read_b64_tr_b16 v[208:209], v238 offset:0
buffer_load_dwordx4 v11, s[28:31], s73 offen lds
v_mfma_f32_16x16x32_bf16 v[120:123], v[212:215], a[56:59], v[120:123]
ds_read_b64_tr_b16 v[210:211], v238 offset:1024
v_mov_b32 v33, v32
v_mfma_f32_16x16x32_bf16 v[124:127], v[212:215], a[60:63], v[124:127]
s_waitcnt lgkmcnt(8)
ds_read_b64_tr_b16 v[212:213], v239 offset:0
v_mov_b32 v253, v252
v_mfma_f32_16x16x32_bf16 v[64:67], v[216:219], a[64:67], v[64:67]
ds_read_b64_tr_b16 v[214:215], v239 offset:1024
v_mfma_f32_16x16x32_bf16 v[68:71], v[216:219], a[68:71], v[68:71]
s_add_u32 m0, s76, 115712
s_nop 0
buffer_load_dwordx4 v3, s[24:27], s74 offen lds
v_mfma_f32_16x16x32_bf16 v[72:75], v[220:223], a[64:67], v[72:75]
ds_read_b128 a[72:75], v7 offset:0
v_mfma_f32_16x16x32_bf16 v[76:79], v[220:223], a[68:71], v[76:79]
v_permlane16_swap_b32 v32, v33
v_mfma_f32_16x16x32_bf16 v[80:83], v[192:195], a[64:67], v[80:83]
ds_read_b128 a[76:79], v7 offset:2048
v_permlane16_swap_b32 v252, v253
v_mfma_f32_16x16x32_bf16 v[84:87], v[192:195], a[68:71], v[84:87]
s_add_u32 m0, s76, 18432
ds_read_b64_tr_b16 v[192:193], v234 offset:8192
buffer_load_dwordx4 v12, s[28:31], s73 offen lds
v_mfma_f32_16x16x32_bf16 v[88:91], v[196:199], a[64:67], v[88:91]
ds_read_b64_tr_b16 v[194:195], v234 offset:9216
buffer_store_dwordx4 v[136:139], v58, s[48:51], s0 offen sc1
v_mfma_f32_16x16x32_bf16 v[92:95], v[196:199], a[68:71], v[92:95]
s_waitcnt lgkmcnt(4)
ds_read_b64_tr_b16 v[196:197], v235 offset:8192
v_mfma_f32_16x16x32_bf16 v[96:99], v[200:203], a[64:67], v[96:99]
ds_read_b64_tr_b16 v[198:199], v235 offset:9216
v_mfma_f32_16x16x32_bf16 v[100:103], v[200:203], a[68:71], v[100:103]
s_add_u32 m0, s76, 116736
ds_read_b64_tr_b16 v[200:201], v236 offset:8192
buffer_load_dwordx4 v4, s[24:27], s74 offen lds
v_mfma_f32_16x16x32_bf16 v[104:107], v[204:207], a[64:67], v[104:107]
ds_read_b64_tr_b16 v[202:203], v236 offset:9216
v_add_f32 v32, v32, v33
v_mfma_f32_16x16x32_bf16 v[108:111], v[204:207], a[68:71], v[108:111]
ds_read_b64_tr_b16 v[204:205], v237 offset:8192
v_add_f32 v252, v252, v253
v_mfma_f32_16x16x32_bf16 v[112:115], v[208:211], a[64:67], v[112:115]
ds_read_b64_tr_b16 v[206:207], v237 offset:9216
v_mov_b32 v33, v32
v_mfma_f32_16x16x32_bf16 v[116:119], v[208:211], a[68:71], v[116:119]
s_add_u32 m0, s76, 19456
ds_read_b64_tr_b16 v[208:209], v238 offset:8192
buffer_load_dwordx4 v13, s[28:31], s73 offen lds
v_mfma_f32_16x16x32_bf16 v[120:123], v[212:215], a[64:67], v[120:123]
s_add_u32 s73, s73, 245760
ds_read_b64_tr_b16 v[210:211], v238 offset:9216
s_sub_u32 s85, s73, 2457600
v_mfma_f32_16x16x32_bf16 v[124:127], v[212:215], a[68:71], v[124:127]
s_waitcnt lgkmcnt(6)
ds_read_b64_tr_b16 v[212:213], v239 offset:8192
s_min_u32 s73, s73, s85
v_mfma_f32_16x16x32_bf16 v[64:67], v[224:227], a[72:75], v[64:67]
ds_read_b64_tr_b16 v[214:215], v239 offset:9216
v_mov_b32 v253, v252
v_mfma_f32_16x16x32_bf16 v[68:71], v[224:227], a[76:79], v[68:71]
s_waitcnt vmcnt(9)
s_barrier
s_add_u32 m0, s76, 117760
s_nop 0
buffer_load_dwordx4 v5, s[24:27], s74 offen lds
v_mfma_f32_16x16x32_bf16 v[72:75], v[228:231], a[72:75], v[72:75]
s_add_u32 s74, s74, 128
ds_read_b64_tr_b16 v[216:217], v44 offset:0
ds_read_b64_tr_b16 v[218:219], v44 offset:1024
v_mfma_f32_16x16x32_bf16 v[76:79], v[228:231], a[76:79], v[76:79]
s_sub_u32 s89, s74, 1280
ds_read_b128 a[80:83], v6 offset:16384
ds_read_b128 a[84:87], v6 offset:18432
v_mfma_f32_16x16x32_bf16 v[80:83], v[192:195], a[72:75], v[80:83]
s_min_u32 s74, s74, s89
ds_read_b64_tr_b16 v[220:221], v45 offset:0
ds_read_b64_tr_b16 v[222:223], v45 offset:1024
v_mfma_f32_16x16x32_bf16 v[84:87], v[192:195], a[76:79], v[84:87]
s_add_u32 m0, s76, 32768
ds_read_b64_tr_b16 v[192:193], v46 offset:0
buffer_load_dwordx4 v10, s[28:31], s73 offen lds
v_mfma_f32_16x16x32_bf16 v[88:91], v[196:199], a[72:75], v[88:91]
ds_read_b64_tr_b16 v[194:195], v46 offset:1024
ds_read_b64_tr_b16 v[224:225], v44 offset:8192
v_mfma_f32_16x16x32_bf16 v[92:95], v[196:199], a[76:79], v[92:95]
s_waitcnt lgkmcnt(9)
ds_read_b64_tr_b16 v[196:197], v47 offset:0
ds_read_b64_tr_b16 v[226:227], v44 offset:9216
v_permlane32_swap_b32 v32, v33
v_permlane32_swap_b32 v252, v253
v_add_f32 v32, v32, v33
v_add_f32 v252, v252, v253
v_and_b32 v34, 16, v0
v_cmp_ne_u32 vcc, 0, v34
v_lshlrev_b32 v34, 3, v20
v_lshl_or_b32 v34, v21, 31, v34
v_cndmask_b32 v32, v32, v252, vcc
v_mov_b32 v33, s72
buffer_store_dwordx2 v[32:33], v34, s[52:55], s86 offen sc1
v_mfma_f32_16x16x32_bf16 v[96:99], v[200:203], a[72:75], v[96:99]
ds_read_b64_tr_b16 v[198:199], v47 offset:1024
ds_read_b64_tr_b16 v[228:229], v45 offset:8192
v_mfma_f32_16x16x32_bf16 v[100:103], v[200:203], a[76:79], v[100:103]
s_add_u32 m0, s76, 131072
ds_read_b64_tr_b16 v[200:201], v48 offset:0
buffer_load_dwordx4 v2, s[24:27], s74 offen lds
v_mfma_f32_16x16x32_bf16 v[104:107], v[204:207], a[72:75], v[104:107]
ds_read_b64_tr_b16 v[202:203], v48 offset:1024
ds_read_b64_tr_b16 v[230:231], v45 offset:9216
v_mfma_f32_16x16x32_bf16 v[108:111], v[204:207], a[76:79], v[108:111]
ds_read_b64_tr_b16 v[204:205], v49 offset:0
buffer_store_dwordx4 v[140:143], v58, s[48:51], s1 offen sc1
v_mfma_f32_16x16x32_bf16 v[112:115], v[208:211], a[72:75], v[112:115]
ds_read_b64_tr_b16 v[206:207], v49 offset:1024
v_mfma_f32_16x16x32_bf16 v[116:119], v[208:211], a[76:79], v[116:119]
s_add_u32 m0, s76, 33792
ds_read_b64_tr_b16 v[208:209], v50 offset:0
buffer_load_dwordx4 v11, s[28:31], s73 offen lds
v_mfma_f32_16x16x32_bf16 v[120:123], v[212:215], a[72:75], v[120:123]
ds_read_b64_tr_b16 v[210:211], v50 offset:1024
v_mfma_f32_16x16x32_bf16 v[124:127], v[212:215], a[76:79], v[124:127]
s_waitcnt lgkmcnt(8)
ds_read_b64_tr_b16 v[212:213], v51 offset:0
v_mfma_f32_16x16x32_bf16 v[64:67], v[216:219], a[80:83], v[64:67]
ds_read_b64_tr_b16 v[214:215], v51 offset:1024
v_mfma_f32_16x16x32_bf16 v[68:71], v[216:219], a[84:87], v[68:71]
s_add_u32 m0, s76, 132096
s_nop 0
buffer_load_dwordx4 v3, s[24:27], s74 offen lds
v_mfma_f32_16x16x32_bf16 v[72:75], v[220:223], a[80:83], v[72:75]
ds_read_b128 a[88:91], v7 offset:16384
v_mfma_f32_16x16x32_bf16 v[76:79], v[220:223], a[84:87], v[76:79]
v_mfma_f32_16x16x32_bf16 v[80:83], v[192:195], a[80:83], v[80:83]
s_mov_b32 s100, 0xaaaaaaaa
ds_read_b128 a[92:95], v7 offset:18432
v_mfma_f32_16x16x32_bf16 v[84:87], v[192:195], a[84:87], v[84:87]
s_add_u32 m0, s76, 34816
ds_read_b64_tr_b16 v[192:193], v46 offset:8192
buffer_load_dwordx4 v12, s[28:31], s73 offen lds
v_mfma_f32_16x16x32_bf16 v[88:91], v[196:199], a[80:83], v[88:91]
ds_read_b64_tr_b16 v[194:195], v46 offset:9216
v_mfma_f32_16x16x32_bf16 v[92:95], v[196:199], a[84:87], v[92:95]
s_waitcnt lgkmcnt(4)
ds_read_b64_tr_b16 v[196:197], v47 offset:8192
v_mfma_f32_16x16x32_bf16 v[96:99], v[200:203], a[80:83], v[96:99]
s_mov_b32 s101, 0xaaaaaaaa
ds_read_b64_tr_b16 v[198:199], v47 offset:9216
v_mfma_f32_16x16x32_bf16 v[100:103], v[200:203], a[84:87], v[100:103]
s_add_u32 m0, s76, 133120
ds_read_b64_tr_b16 v[200:201], v48 offset:8192
buffer_load_dwordx4 v4, s[24:27], s74 offen lds
v_mfma_f32_16x16x32_bf16 v[104:107], v[204:207], a[80:83], v[104:107]
ds_read_b64_tr_b16 v[202:203], v48 offset:9216
v_mfma_f32_16x16x32_bf16 v[108:111], v[204:207], a[84:87], v[108:111]
ds_read_b64_tr_b16 v[204:205], v49 offset:8192
v_mfma_f32_16x16x32_bf16 v[112:115], v[208:211], a[80:83], v[112:115]
ds_read_b64_tr_b16 v[206:207], v49 offset:9216
v_mfma_f32_16x16x32_bf16 v[116:119], v[208:211], a[84:87], v[116:119]
s_add_u32 m0, s76, 35840
ds_read_b64_tr_b16 v[208:209], v50 offset:8192
buffer_load_dwordx4 v13, s[28:31], s73 offen lds
v_mfma_f32_16x16x32_bf16 v[120:123], v[212:215], a[80:83], v[120:123]
s_add_u32 s73, s73, 245760
ds_read_b64_tr_b16 v[210:211], v50 offset:9216
s_sub_u32 s85, s73, 2457600
v_mfma_f32_16x16x32_bf16 v[124:127], v[212:215], a[84:87], v[124:127]
s_waitcnt lgkmcnt(6)
ds_read_b64_tr_b16 v[212:213], v51 offset:8192
s_min_u32 s73, s73, s85
v_mfma_f32_16x16x32_bf16 v[64:67], v[224:227], a[88:91], v[64:67]
ds_read_b64_tr_b16 v[214:215], v51 offset:9216
v_mfma_f32_16x16x32_bf16 v[68:71], v[224:227], a[92:95], v[68:71]
s_waitcnt vmcnt(9)
s_barrier
s_add_u32 m0, s76, 134144
s_nop 0
buffer_load_dwordx4 v5, s[24:27], s74 offen lds
v_mfma_f32_16x16x32_bf16 v[72:75], v[228:231], a[88:91], v[72:75]
s_add_u32 s74, s74, 128
ds_read_b64_tr_b16 v[216:217], v44 offset:16384
ds_read_b64_tr_b16 v[218:219], v44 offset:17408
v_mfma_f32_16x16x32_bf16 v[76:79], v[228:231], a[92:95], v[76:79]
s_sub_u32 s89, s74, 1280
ds_read_b128 a[96:99], v6 offset:32768
ds_read_b128 a[100:103], v6 offset:34816
v_mfma_f32_16x16x32_bf16 v[80:83], v[192:195], a[88:91], v[80:83]
s_min_u32 s74, s74, s89
ds_read_b64_tr_b16 v[220:221], v45 offset:16384
ds_read_b64_tr_b16 v[222:223], v45 offset:17408
v_mfma_f32_16x16x32_bf16 v[84:87], v[192:195], a[92:95], v[84:87]
s_add_u32 m0, s76, 49152
ds_read_b64_tr_b16 v[192:193], v46 offset:16384
buffer_load_dwordx4 v10, s[28:31], s73 offen lds
v_mfma_f32_16x16x32_bf16 v[88:91], v[196:199], a[88:91], v[88:91]
ds_read_b64_tr_b16 v[194:195], v46 offset:17408
ds_read_b64_tr_b16 v[224:225], v44 offset:24576
v_mfma_f32_16x16x32_bf16 v[92:95], v[196:199], a[92:95], v[92:95]
s_waitcnt lgkmcnt(9)
ds_read_b64_tr_b16 v[196:197], v47 offset:16384
ds_read_b64_tr_b16 v[226:227], v44 offset:25600
v_mfma_f32_16x16x32_bf16 v[96:99], v[200:203], a[88:91], v[96:99]
ds_read_b64_tr_b16 v[198:199], v47 offset:17408
ds_read_b64_tr_b16 v[228:229], v45 offset:24576
v_mfma_f32_16x16x32_bf16 v[100:103], v[200:203], a[92:95], v[100:103]
s_add_u32 m0, s76, 81920
ds_read_b64_tr_b16 v[200:201], v48 offset:16384
buffer_load_dwordx4 v2, s[24:27], s74 offen lds
v_mfma_f32_16x16x32_bf16 v[104:107], v[204:207], a[88:91], v[104:107]
ds_read_b64_tr_b16 v[202:203], v48 offset:17408
ds_read_b64_tr_b16 v[230:231], v45 offset:25600
v_mfma_f32_16x16x32_bf16 v[108:111], v[204:207], a[92:95], v[108:111]
ds_read_b64_tr_b16 v[204:205], v49 offset:16384
v_mfma_f32_16x16x32_bf16 v[112:115], v[208:211], a[88:91], v[112:115]
ds_read_b64_tr_b16 v[206:207], v49 offset:17408
v_and_b32 v41, 0x7fff, v42
v_mfma_f32_16x16x32_bf16 v[116:119], v[208:211], a[92:95], v[116:119]
s_add_u32 m0, s76, 50176
ds_read_b64_tr_b16 v[208:209], v50 offset:16384
buffer_load_dwordx4 v11, s[28:31], s73 offen lds
v_mfma_f32_16x16x32_bf16 v[120:123], v[212:215], a[88:91], v[120:123]
ds_read_b64_tr_b16 v[210:211], v50 offset:17408
v_mfma_f32_16x16x32_bf16 v[124:127], v[212:215], a[92:95], v[124:127]
s_waitcnt lgkmcnt(8)
ds_read_b64_tr_b16 v[212:213], v51 offset:16384
v_mfma_f32_16x16x32_bf16 v[64:67], v[216:219], a[96:99], v[64:67]
ds_read_b64_tr_b16 v[214:215], v51 offset:17408
v_mfma_f32_16x16x32_bf16 v[68:71], v[216:219], a[100:103], v[68:71]
s_add_u32 m0, s76, 82944
s_nop 0
buffer_load_dwordx4 v3, s[24:27], s74 offen lds
v_mfma_f32_16x16x32_bf16 v[72:75], v[220:223], a[96:99], v[72:75]
ds_read_b128 a[104:107], v7 offset:32768
v_mfma_f32_16x16x32_bf16 v[76:79], v[220:223], a[100:103], v[76:79]
v_mfma_f32_16x16x32_bf16 v[80:83], v[192:195], a[96:99], v[80:83]
ds_read_b128 a[108:111], v7 offset:34816
v_mfma_f32_16x16x32_bf16 v[84:87], v[192:195], a[100:103], v[84:87]
s_add_u32 m0, s76, 51200
ds_read_b64_tr_b16 v[192:193], v46 offset:24576
buffer_load_dwordx4 v12, s[28:31], s73 offen lds
v_mfma_f32_16x16x32_bf16 v[88:91], v[196:199], a[96:99], v[88:91]
ds_read_b64_tr_b16 v[194:195], v46 offset:25600
v_mfma_f32_16x16x32_bf16 v[92:95], v[196:199], a[100:103], v[92:95]
s_waitcnt lgkmcnt(4)
ds_read_b64_tr_b16 v[196:197], v47 offset:24576
buffer_load_dwordx4 v[24:27], v41, s[52:55], 0 offen sc1
v_mfma_f32_16x16x32_bf16 v[96:99], v[200:203], a[96:99], v[96:99]
ds_read_b64_tr_b16 v[198:199], v47 offset:25600
v_mfma_f32_16x16x32_bf16 v[100:103], v[200:203], a[100:103], v[100:103]
s_add_u32 m0, s76, 83968
ds_read_b64_tr_b16 v[200:201], v48 offset:24576
buffer_load_dwordx4 v4, s[24:27], s74 offen lds
v_mfma_f32_16x16x32_bf16 v[104:107], v[204:207], a[96:99], v[104:107]
ds_read_b64_tr_b16 v[202:203], v48 offset:25600
v_mfma_f32_16x16x32_bf16 v[108:111], v[204:207], a[100:103], v[108:111]
ds_read_b64_tr_b16 v[204:205], v49 offset:24576
v_mfma_f32_16x16x32_bf16 v[112:115], v[208:211], a[96:99], v[112:115]
ds_read_b64_tr_b16 v[206:207], v49 offset:25600
v_mfma_f32_16x16x32_bf16 v[116:119], v[208:211], a[100:103], v[116:119]
s_add_u32 m0, s76, 52224
ds_read_b64_tr_b16 v[208:209], v50 offset:24576
buffer_load_dwordx4 v13, s[28:31], s73 offen lds
v_mfma_f32_16x16x32_bf16 v[120:123], v[212:215], a[96:99], v[120:123]
s_add_u32 s73, s73, 245760
ds_read_b64_tr_b16 v[210:211], v50 offset:25600
s_sub_u32 s85, s73, 2457600
v_mfma_f32_16x16x32_bf16 v[124:127], v[212:215], a[100:103], v[124:127]
s_waitcnt lgkmcnt(6)
ds_read_b64_tr_b16 v[212:213], v51 offset:24576
s_min_u32 s73, s73, s85
v_mfma_f32_16x16x32_bf16 v[64:67], v[224:227], a[104:107], v[64:67]
ds_read_b64_tr_b16 v[214:215], v51 offset:25600
v_mfma_f32_16x16x32_bf16 v[68:71], v[224:227], a[108:111], v[68:71]
s_waitcnt vmcnt(8)
s_barrier
s_add_u32 m0, s76, 84992
s_nop 0
buffer_load_dwordx4 v5, s[24:27], s74 offen lds
v_mfma_f32_16x16x32_bf16 v[72:75], v[228:231], a[104:107], v[72:75]
s_add_u32 s74, s74, 128
ds_read_b64_tr_b16 v[216:217], v44 offset:32768
ds_read_b64_tr_b16 v[218:219], v44 offset:33792
v_mfma_f32_16x16x32_bf16 v[76:79], v[228:231], a[108:111], v[76:79]
s_sub_u32 s89, s74, 1280
ds_read_b128 a[112:115], v6 offset:49152
ds_read_b128 a[116:119], v6 offset:51200
v_mfma_f32_16x16x32_bf16 v[80:83], v[192:195], a[104:107], v[80:83]
s_min_u32 s74, s74, s89
ds_read_b64_tr_b16 v[220:221], v45 offset:32768
ds_read_b64_tr_b16 v[222:223], v45 offset:33792
v_mfma_f32_16x16x32_bf16 v[84:87], v[192:195], a[108:111], v[84:87]
s_add_u32 m0, s76, 65536
ds_read_b64_tr_b16 v[192:193], v46 offset:32768
buffer_load_dwordx4 v10, s[28:31], s73 offen lds
v_mfma_f32_16x16x32_bf16 v[88:91], v[196:199], a[104:107], v[88:91]
ds_read_b64_tr_b16 v[194:195], v46 offset:33792
ds_read_b64_tr_b16 v[224:225], v44 offset:40960
v_mfma_f32_16x16x32_bf16 v[92:95], v[196:199], a[108:111], v[92:95]
s_waitcnt lgkmcnt(9)
ds_read_b64_tr_b16 v[196:197], v47 offset:32768
ds_read_b64_tr_b16 v[226:227], v44 offset:41984
v_mfma_f32_16x16x32_bf16 v[96:99], v[200:203], a[104:107], v[96:99]
ds_read_b64_tr_b16 v[198:199], v47 offset:33792
ds_read_b64_tr_b16 v[228:229], v45 offset:40960
v_mfma_f32_16x16x32_bf16 v[100:103], v[200:203], a[108:111], v[100:103]
s_add_u32 m0, s76, 98304
ds_read_b64_tr_b16 v[200:201], v48 offset:32768
buffer_load_dwordx4 v2, s[24:27], s74 offen lds
v_mfma_f32_16x16x32_bf16 v[104:107], v[204:207], a[104:107], v[104:107]
ds_read_b64_tr_b16 v[202:203], v48 offset:33792
ds_read_b64_tr_b16 v[230:231], v45 offset:41984
v_mfma_f32_16x16x32_bf16 v[108:111], v[204:207], a[108:111], v[108:111]
ds_read_b64_tr_b16 v[204:205], v49 offset:32768
v_mfma_f32_16x16x32_bf16 v[112:115], v[208:211], a[104:107], v[112:115]
ds_read_b64_tr_b16 v[206:207], v49 offset:33792
v_mfma_f32_16x16x32_bf16 v[116:119], v[208:211], a[108:111], v[116:119]
s_add_u32 m0, s76, 66560
ds_read_b64_tr_b16 v[208:209], v50 offset:32768
buffer_load_dwordx4 v11, s[28:31], s73 offen lds
v_mfma_f32_16x16x32_bf16 v[120:123], v[212:215], a[104:107], v[120:123]
ds_read_b64_tr_b16 v[210:211], v50 offset:33792
v_mfma_f32_16x16x32_bf16 v[124:127], v[212:215], a[108:111], v[124:127]
s_waitcnt lgkmcnt(8)
ds_read_b64_tr_b16 v[212:213], v51 offset:32768
v_mfma_f32_16x16x32_bf16 v[64:67], v[216:219], a[112:115], v[64:67]
ds_read_b64_tr_b16 v[214:215], v51 offset:33792
v_mfma_f32_16x16x32_bf16 v[68:71], v[216:219], a[116:119], v[68:71]
s_add_u32 m0, s76, 99328
s_nop 0
buffer_load_dwordx4 v3, s[24:27], s74 offen lds
v_mfma_f32_16x16x32_bf16 v[72:75], v[220:223], a[112:115], v[72:75]
ds_read_b128 a[120:123], v7 offset:49152
v_mfma_f32_16x16x32_bf16 v[76:79], v[220:223], a[116:119], v[76:79]
v_mfma_f32_16x16x32_bf16 v[80:83], v[192:195], a[112:115], v[80:83]
ds_read_b128 a[124:127], v7 offset:51200
v_mfma_f32_16x16x32_bf16 v[84:87], v[192:195], a[116:119], v[84:87]
s_add_u32 m0, s76, 67584
ds_read_b64_tr_b16 v[192:193], v46 offset:40960
buffer_load_dwordx4 v12, s[28:31], s73 offen lds
v_mfma_f32_16x16x32_bf16 v[88:91], v[196:199], a[112:115], v[88:91]
ds_read_b64_tr_b16 v[194:195], v46 offset:41984
v_mfma_f32_16x16x32_bf16 v[92:95], v[196:199], a[116:119], v[92:95]
s_waitcnt lgkmcnt(4)
ds_read_b64_tr_b16 v[196:197], v47 offset:40960
v_mfma_f32_16x16x32_bf16 v[96:99], v[200:203], a[112:115], v[96:99]
ds_read_b64_tr_b16 v[198:199], v47 offset:41984
v_mfma_f32_16x16x32_bf16 v[100:103], v[200:203], a[116:119], v[100:103]
s_add_u32 m0, s76, 100352
ds_read_b64_tr_b16 v[200:201], v48 offset:40960
buffer_load_dwordx4 v4, s[24:27], s74 offen lds
v_mfma_f32_16x16x32_bf16 v[104:107], v[204:207], a[112:115], v[104:107]
ds_read_b64_tr_b16 v[202:203], v48 offset:41984
v_mfma_f32_16x16x32_bf16 v[108:111], v[204:207], a[116:119], v[108:111]
ds_read_b64_tr_b16 v[204:205], v49 offset:40960
v_mfma_f32_16x16x32_bf16 v[112:115], v[208:211], a[112:115], v[112:115]
ds_read_b64_tr_b16 v[206:207], v49 offset:41984
buffer_load_dword v128, v60, s[52:55], s21 offen offset:0 sc1
v_mfma_f32_16x16x32_bf16 v[116:119], v[208:211], a[116:119], v[116:119]
s_add_u32 m0, s76, 68608
ds_read_b64_tr_b16 v[208:209], v50 offset:40960
buffer_load_dwordx4 v13, s[28:31], s73 offen lds
v_mfma_f32_16x16x32_bf16 v[120:123], v[212:215], a[112:115], v[120:123]
ds_read_b64_tr_b16 v[210:211], v50 offset:41984
buffer_load_dword v129, v60, s[52:55], s21 offen offset:256 sc1
v_mfma_f32_16x16x32_bf16 v[124:127], v[212:215], a[116:119], v[124:127]
s_waitcnt lgkmcnt(6)
ds_read_b64_tr_b16 v[212:213], v51 offset:40960
v_mfma_f32_16x16x32_bf16 v[64:67], v[224:227], a[120:123], v[64:67]
ds_read_b64_tr_b16 v[214:215], v51 offset:41984
buffer_load_dword v130, v60, s[52:55], s21 offen offset:512 sc1
v_mfma_f32_16x16x32_bf16 v[68:71], v[224:227], a[124:127], v[68:71]
s_waitcnt vmcnt(10)
s_barrier
s_add_u32 m0, s76, 101376
s_nop 0
buffer_load_dwordx4 v5, s[24:27], s74 offen lds
v_mfma_f32_16x16x32_bf16 v[72:75], v[228:231], a[120:123], v[72:75]
ds_read_b64_tr_b16 v[216:217], v44 offset:49152
ds_read_b64_tr_b16 v[218:219], v44 offset:50176
v_mfma_f32_16x16x32_bf16 v[76:79], v[228:231], a[124:127], v[76:79]
ds_read_b128 a[128:131], v6 offset:0
ds_read_b128 a[132:135], v6 offset:2048
v_mfma_f32_16x16x32_bf16 v[80:83], v[192:195], a[120:123], v[80:83]
ds_read_b64_tr_b16 v[220:221], v45 offset:49152
ds_read_b64_tr_b16 v[222:223], v45 offset:50176
v_mfma_f32_16x16x32_bf16 v[84:87], v[192:195], a[124:127], v[84:87]
s_add_u32 m0, s76, 0
ds_read_b64_tr_b16 v[192:193], v46 offset:49152
buffer_load_dwordx4 v14, s[32:35], s75 offen lds
v_mfma_f32_16x16x32_bf16 v[88:91], v[196:199], a[120:123], v[88:91]
ds_read_b64_tr_b16 v[194:195], v46 offset:50176
ds_read_b64_tr_b16 v[224:225], v44 offset:57344
v_mfma_f32_16x16x32_bf16 v[92:95], v[196:199], a[124:127], v[92:95]
s_waitcnt lgkmcnt(9)
ds_read_b64_tr_b16 v[196:197], v47 offset:49152
ds_read_b64_tr_b16 v[226:227], v44 offset:58368
v_mfma_f32_16x16x32_bf16 v[96:99], v[200:203], a[120:123], v[96:99]
ds_read_b64_tr_b16 v[198:199], v47 offset:50176
ds_read_b64_tr_b16 v[228:229], v45 offset:57344
v_mfma_f32_16x16x32_bf16 v[100:103], v[200:203], a[124:127], v[100:103]
s_add_u32 m0, s76, 1024
ds_read_b64_tr_b16 v[200:201], v48 offset:49152
buffer_load_dwordx4 v15, s[32:35], s75 offen lds
v_mfma_f32_16x16x32_bf16 v[104:107], v[204:207], a[120:123], v[104:107]
ds_read_b64_tr_b16 v[202:203], v48 offset:50176
ds_read_b64_tr_b16 v[230:231], v45 offset:58368
v_mfma_f32_16x16x32_bf16 v[108:111], v[204:207], a[124:127], v[108:111]
ds_read_b64_tr_b16 v[204:205], v49 offset:49152
buffer_load_dword v131, v60, s[52:55], s21 offen offset:768 sc1
v_mfma_f32_16x16x32_bf16 v[112:115], v[208:211], a[120:123], v[112:115]
ds_read_b64_tr_b16 v[206:207], v49 offset:50176
buffer_load_dword v132, v60, s[52:55], s21 offen offset:1024 sc1
v_mfma_f32_16x16x32_bf16 v[116:119], v[208:211], a[124:127], v[116:119]
s_add_u32 m0, s76, 2048
ds_read_b64_tr_b16 v[208:209], v50 offset:49152
buffer_load_dwordx4 v16, s[32:35], s75 offen lds
v_mfma_f32_16x16x32_bf16 v[120:123], v[212:215], a[120:123], v[120:123]
ds_read_b64_tr_b16 v[210:211], v50 offset:50176
buffer_load_dword v133, v60, s[52:55], s21 offen offset:1280 sc1
v_mfma_f32_16x16x32_bf16 v[124:127], v[212:215], a[124:127], v[124:127]
s_waitcnt lgkmcnt(8)
ds_read_b64_tr_b16 v[212:213], v51 offset:49152
buffer_load_dword v134, v60, s[52:55], s21 offen offset:1536 sc1
buffer_load_dword v135, v60, s[52:55], s21 offen offset:1792 sc1
buffer_load_dword v136, v60, s[52:55], s21 offen offset:2048 sc1
buffer_load_dword v137, v60, s[52:55], s21 offen offset:2304 sc1
v_mfma_f32_16x16x32_bf16 v[64:67], v[216:219], a[128:131], v[64:67]
ds_read_b64_tr_b16 v[214:215], v51 offset:50176
v_mfma_f32_16x16x32_bf16 v[68:71], v[216:219], a[132:135], v[68:71]
s_add_u32 m0, s76, 3072
s_nop 0
buffer_load_dwordx4 v17, s[32:35], s75 offen lds
s_add_u32 s75, s75, 221184
v_mfma_f32_16x16x32_bf16 v[72:75], v[220:223], a[128:131], v[72:75]
s_sub_u32 s85, s75, 2211840
ds_read_b128 a[136:139], v7 offset:0
s_min_u32 s75, s75, s85
v_mfma_f32_16x16x32_bf16 v[76:79], v[220:223], a[132:135], v[76:79]
v_mfma_f32_16x16x32_bf16 v[80:83], v[192:195], a[128:131], v[80:83]
ds_read_b128 a[140:143], v7 offset:2048
v_mfma_f32_16x16x32_bf16 v[84:87], v[192:195], a[132:135], v[84:87]
s_add_u32 m0, s76, 16384
ds_read_b64_tr_b16 v[192:193], v46 offset:57344
buffer_load_dwordx4 v14, s[32:35], s75 offen lds
v_mfma_f32_16x16x32_bf16 v[88:91], v[196:199], a[128:131], v[88:91]
ds_read_b64_tr_b16 v[194:195], v46 offset:58368
v_mfma_f32_16x16x32_bf16 v[92:95], v[196:199], a[132:135], v[92:95]
s_waitcnt lgkmcnt(4)
ds_read_b64_tr_b16 v[196:197], v47 offset:57344
v_mfma_f32_16x16x32_bf16 v[96:99], v[200:203], a[128:131], v[96:99]
ds_read_b64_tr_b16 v[198:199], v47 offset:58368
v_mfma_f32_16x16x32_bf16 v[100:103], v[200:203], a[132:135], v[100:103]
s_add_u32 m0, s76, 17408
ds_read_b64_tr_b16 v[200:201], v48 offset:57344
buffer_load_dwordx4 v15, s[32:35], s75 offen lds
v_mfma_f32_16x16x32_bf16 v[104:107], v[204:207], a[128:131], v[104:107]
ds_read_b64_tr_b16 v[202:203], v48 offset:58368
v_mfma_f32_16x16x32_bf16 v[108:111], v[204:207], a[132:135], v[108:111]
ds_read_b64_tr_b16 v[204:205], v49 offset:57344
v_mfma_f32_16x16x32_bf16 v[112:115], v[208:211], a[128:131], v[112:115]
ds_read_b64_tr_b16 v[206:207], v49 offset:58368
s_waitcnt vmcnt(15)
v_min3_u32 v250, v128, v129, s72
v_mfma_f32_16x16x32_bf16 v[116:119], v[208:211], a[132:135], v[116:119]
s_add_u32 m0, s76, 18432
ds_read_b64_tr_b16 v[208:209], v50 offset:57344
buffer_load_dwordx4 v16, s[32:35], s75 offen lds
v_mfma_f32_16x16x32_bf16 v[120:123], v[212:215], a[128:131], v[120:123]
ds_read_b64_tr_b16 v[210:211], v50 offset:58368
v_max3_u32 v251, v128, v129, s72
v_mfma_f32_16x16x32_bf16 v[124:127], v[212:215], a[132:135], v[124:127]
s_waitcnt lgkmcnt(6)
ds_read_b64_tr_b16 v[212:213], v51 offset:57344
s_waitcnt vmcnt(11)
v_min3_u32 v250, v250, v130, v131
v_mfma_f32_16x16x32_bf16 v[64:67], v[224:227], a[136:139], v[64:67]
ds_read_b64_tr_b16 v[214:215], v51 offset:58368
v_max3_u32 v251, v251, v130, v131
v_mfma_f32_16x16x32_bf16 v[68:71], v[224:227], a[140:143], v[68:71]
s_barrier
s_add_u32 m0, s76, 19456
s_nop 0
buffer_load_dwordx4 v17, s[32:35], s75 offen lds
v_mfma_f32_16x16x32_bf16 v[72:75], v[228:231], a[136:139], v[72:75]
s_add_u32 s75, s75, 221184
ds_read_b64_tr_b16 v[216:217], v232 offset:0
ds_read_b64_tr_b16 v[218:219], v232 offset:1024
v_mfma_f32_16x16x32_bf16 v[76:79], v[228:231], a[140:143], v[76:79]
s_sub_u32 s85, s75, 2211840
ds_read_b128 a[144:147], v6 offset:16384
ds_read_b128 a[148:151], v6 offset:18432
v_mfma_f32_16x16x32_bf16 v[80:83], v[192:195], a[136:139], v[80:83]
s_min_u32 s75, s75, s85
ds_read_b64_tr_b16 v[220:221], v233 offset:0
ds_read_b64_tr_b16 v[222:223], v233 offset:1024
v_mfma_f32_16x16x32_bf16 v[84:87], v[192:195], a[140:143], v[84:87]
s_add_u32 m0, s76, 32768
ds_read_b64_tr_b16 v[192:193], v234 offset:0
buffer_load_dwordx4 v14, s[32:35], s75 offen lds
v_mfma_f32_16x16x32_bf16 v[88:91], v[196:199], a[136:139], v[88:91]
ds_read_b64_tr_b16 v[194:195], v234 offset:1024
ds_read_b64_tr_b16 v[224:225], v232 offset:8192
v_mfma_f32_16x16x32_bf16 v[92:95], v[196:199], a[140:143], v[92:95]
s_waitcnt lgkmcnt(9)
ds_read_b64_tr_b16 v[196:197], v235 offset:0
ds_read_b64_tr_b16 v[226:227], v232 offset:9216
v_mfma_f32_16x16x32_bf16 v[96:99], v[200:203], a[136:139], v[96:99]
ds_read_b64_tr_b16 v[198:199], v235 offset:1024
ds_read_b64_tr_b16 v[228:229], v233 offset:8192
v_mfma_f32_16x16x32_bf16 v[100:103], v[200:203], a[140:143], v[100:103]
ds_read_b64_tr_b16 v[200:201], v236 offset:0
s_waitcnt vmcnt(10)
v_min3_u32 v250, v250, v132, v133
v_mfma_f32_16x16x32_bf16 v[104:107], v[204:207], a[136:139], v[104:107]
ds_read_b64_tr_b16 v[202:203], v236 offset:1024
ds_read_b64_tr_b16 v[230:231], v233 offset:9216
v_mfma_f32_16x16x32_bf16 v[108:111], v[204:207], a[140:143], v[108:111]
s_add_u32 m0, s76, 33792
ds_read_b64_tr_b16 v[204:205], v237 offset:0
buffer_load_dwordx4 v15, s[32:35], s75 offen lds
v_mfma_f32_16x16x32_bf16 v[112:115], v[208:211], a[136:139], v[112:115]
ds_read_b64_tr_b16 v[206:207], v237 offset:1024
v_max3_u32 v251, v251, v132, v133
v_mfma_f32_16x16x32_bf16 v[116:119], v[208:211], a[140:143], v[116:119]
ds_read_b64_tr_b16 v[208:209], v238 offset:0
s_waitcnt vmcnt(9)
v_min3_u32 v250, v250, v134, v135
v_mfma_f32_16x16x32_bf16 v[120:123], v[212:215], a[136:139], v[120:123]
ds_read_b64_tr_b16 v[210:211], v238 offset:1024
v_max3_u32 v251, v251, v134, v135
v_mfma_f32_16x16x32_bf16 v[124:127], v[212:215], a[140:143], v[124:127]
s_waitcnt lgkmcnt(8)
ds_read_b64_tr_b16 v[212:213], v239 offset:0
s_waitcnt vmcnt(7)
v_min3_u32 v250, v250, v136, v137
v_cmp_ne_u32 vcc, s72, v26
s_nop 0
s_cbranch_vccnz L_retry_8
L_back_9:
v_mov_b32 v28, v24
v_mov_b32 v30, v25
v_cmp_gt_u32 vcc, 16, v0
v_mov_b32 v53, 0
v_permlane16_swap_b32 v24, v28
v_permlane16_swap_b32 v25, v30
v_cndmask_b32 v52, 0, v24, vcc
v_cndmask_b32 v28, 0, v28, vcc
v_mov_b32 v29, 0
s_cmp_lt_u32 s70, 5
s_cselect_b32 s84, 0x3ea52b5c, 1.0
v_mov_b32 v54, v25
v_mul_f32 v56, s84, v25
v_mul_f32 v31, s84, v30
v_mfma_f32_16x16x32_bf16 v[64:67], v[216:219], a[144:147], v[64:67]
ds_read_b64_tr_b16 v[214:215], v239 offset:1024
v_max3_u32 v251, v251, v136, v137
v_mfma_f32_16x16x32_bf16 v[68:71], v[216:219], a[148:151], v[68:71]
v_cmp_ne_u32 vcc, v250, v251
s_nop 0
s_and_b64 vcc, vcc, s[100:101]
s_cbranch_vccnz L_retry_4
L_back_5:
v_mfma_f32_16x16x32_bf16 v[72:75], v[220:223], a[144:147], v[72:75]
s_add_u32 m0, s76, 34816
ds_read_b128 a[152:155], v7 offset:16384
buffer_load_dwordx4 v16, s[32:35], s75 offen lds
v_mfma_f32_16x16x32_bf16 v[76:79], v[220:223], a[148:151], v[76:79]
v_add_f32 v128, v128, v133
v_mfma_f32_16x16x32_bf16 v[80:83], v[192:195], a[144:147], v[80:83]
ds_read_b128 a[156:159], v7 offset:18432
v_add_f32 v129, v129, v134
v_mfma_f32_16x16x32_bf16 v[84:87], v[192:195], a[148:151], v[84:87]
ds_read_b64_tr_b16 v[192:193], v234 offset:8192
v_add_f32 v130, v130, v135
v_mfma_f32_16x16x32_bf16 v[88:91], v[196:199], a[144:147], v[88:91]
ds_read_b64_tr_b16 v[194:195], v234 offset:9216
v_add_f32 v131, v131, v136
v_mfma_f32_16x16x32_bf16 v[92:95], v[196:199], a[148:151], v[92:95]
s_waitcnt lgkmcnt(4)
ds_read_b64_tr_b16 v[196:197], v235 offset:8192
v_add_f32 v132, v132, v137
v_mfma_f32_16x16x32_bf16 v[96:99], v[200:203], a[144:147], v[96:99]
ds_read_b64_tr_b16 v[198:199], v235 offset:9216
v_add_f32 v128, v128, v129
v_mfma_f32_16x16x32_bf16 v[100:103], v[200:203], a[148:151], v[100:103]
ds_read_b64_tr_b16 v[200:201], v236 offset:8192
v_add_f32 v130, v130, v131
v_mfma_f32_16x16x32_bf16 v[104:107], v[204:207], a[144:147], v[104:107]
s_add_u32 m0, s76, 35840
ds_read_b64_tr_b16 v[202:203], v236 offset:9216
buffer_load_dwordx4 v17, s[32:35], s75 offen lds
v_mfma_f32_16x16x32_bf16 v[108:111], v[204:207], a[148:151], v[108:111]
s_add_u32 s75, s75, 221184
ds_read_b64_tr_b16 v[204:205], v237 offset:8192
s_sub_u32 s85, s75, 2211840
v_mfma_f32_16x16x32_bf16 v[112:115], v[208:211], a[144:147], v[112:115]
s_min_u32 s75, s75, s85
ds_read_b64_tr_b16 v[206:207], v237 offset:9216
v_add_f32 v128, v128, v132
v_mfma_f32_16x16x32_bf16 v[116:119], v[208:211], a[148:151], v[116:119]
ds_read_b64_tr_b16 v[208:209], v238 offset:8192
v_add_u32 v38, 81920, v43
v_mfma_f32_16x16x32_bf16 v[120:123], v[212:215], a[144:147], v[120:123]
ds_read_b64_tr_b16 v[210:211], v238 offset:9216
v_add_f32 v128, v128, v130
v_mfma_f32_16x16x32_bf16 v[124:127], v[212:215], a[148:151], v[124:127]
s_waitcnt lgkmcnt(6)
ds_read_b64_tr_b16 v[212:213], v239 offset:8192
v_and_b32 v130, 1, v0
v_mul_u32_u24 v130, 508, v130
v_cvt_pk_bf16_f32 v129, v128, v128
v_add3_u32 v130, v130, v60, s76
v_and_b32 v129, 0xffff0000, v129
v_xor_b32 v39, 0x1000, v38
v_sub_f32 v129, v128, v129
v_xor_b32 v250, 0x2000, v38
v_cvt_pk_bf16_f32 v128, v128, v129
v_mov_b32 v129, 0
v_xor_b32 v251, 0x3000, v38
v_add_u32 v130, 81920, v130
ds_write_b64 v130, v[128:129]
v_mfma_f32_16x16x32_bf16 v[64:67], v[224:227], a[152:155], v[64:67]
ds_read_b64_tr_b16 v[214:215], v239 offset:9216
v_mfma_f32_16x16x32_bf16 v[68:71], v[224:227], a[156:159], v[68:71]
s_waitcnt lgkmcnt(1)
s_waitcnt vmcnt(8)
s_barrier
s_cmp_lg_u32 s68, 0
s_cbranch_scc1 L_wgf_10
v_mov_b32 v18, s72
s_mov_b64 exec, 1
buffer_store_dword v18, off, s[52:55], s17 sc1
s_mov_b64 exec, -1
L_wgf_10:
v_mfma_f32_16x16x32_bf16 v[72:75], v[228:231], a[152:155], v[72:75]
ds_read_b64_tr_b16 v[216:217], v44 offset:0
ds_read_b64_tr_b16 v[218:219], v44 offset:1024
v_mfma_f32_16x16x32_bf16 v[76:79], v[228:231], a[156:159], v[76:79]
ds_read_b64_tr_b16 v[220:221], v45 offset:0
ds_read_b64_tr_b16 v[222:223], v45 offset:1024
v_mfma_f32_16x16x32_bf16 v[80:83], v[192:195], a[152:155], v[80:83]
ds_read_b64_tr_b16 v[224:225], v44 offset:8192
ds_read_b64_tr_b16 v[226:227], v44 offset:9216
v_mfma_f32_16x16x32_bf16 v[84:87], v[192:195], a[156:159], v[84:87]
s_add_u32 m0, s76, 49152
ds_read_b64_tr_b16 v[192:193], v46 offset:0
buffer_load_dwordx4 v14, s[32:35], s75 offen lds
ds_read_b64 v[240:241], v38 offset:0
ds_read_b64 v[242:243], v38 offset:128
ds_read_b64 v[244:245], v39 offset:0
ds_read_b64 v[246:247], v39 offset:128
v_mfma_f32_16x16x32_bf16 v[88:91], v[196:199], a[152:155], v[88:91]
ds_read_b64_tr_b16 v[194:195], v46 offset:1024
ds_read_b64_tr_b16 v[228:229], v45 offset:8192
v_mfma_f32_16x16x32_bf16 v[92:95], v[196:199], a[156:159], v[92:95]
s_waitcnt lgkmcnt(13)
ds_read_b64_tr_b16 v[196:197], v47 offset:0
ds_read_b64_tr_b16 v[230:231], v45 offset:9216
v_mfma_f32_16x16x32_bf16 v[96:99], v[200:203], a[152:155], v[96:99]
ds_read_b64_tr_b16 v[198:199], v47 offset:1024
s_waitcnt lgkmcnt(8)
v_mfma_f32_16x16x16bf16_1k v[64:67], v[240:241], v[52:53], v[64:67]
v_mfma_f32_16x16x32_bf16 v[100:103], v[200:203], a[156:159], v[100:103]
ds_read_b64_tr_b16 v[200:201], v48 offset:0
v_mfma_f32_16x16x16bf16_1k v[68:71], v[240:241], v[28:29], v[68:71]
v_mfma_f32_16x16x32_bf16 v[104:107], v[204:207], a[152:155], v[104:107]
s_add_u32 m0, s76, 50176
ds_read_b64_tr_b16 v[202:203], v48 offset:1024
buffer_load_dwordx4 v15, s[32:35], s75 offen lds
s_waitcnt lgkmcnt(9)
v_mfma_f32_16x16x16bf16_1k v[72:75], v[242:243], v[52:53], v[72:75]
v_mfma_f32_16x16x32_bf16 v[108:111], v[204:207], a[156:159], v[108:111]
ds_read_b64_tr_b16 v[204:205], v49 offset:0
v_mfma_f32_16x16x16bf16_1k v[76:79], v[242:243], v[28:29], v[76:79]
v_mfma_f32_16x16x32_bf16 v[112:115], v[208:211], a[152:155], v[112:115]
ds_read_b64_tr_b16 v[206:207], v49 offset:1024
s_waitcnt lgkmcnt(10)
v_mfma_f32_16x16x16bf16_1k v[80:83], v[244:245], v[52:53], v[80:83]
v_mfma_f32_16x16x32_bf16 v[116:119], v[208:211], a[156:159], v[116:119]
ds_read_b64_tr_b16 v[208:209], v50 offset:0
v_mfma_f32_16x16x16bf16_1k v[84:87], v[244:245], v[28:29], v[84:87]
v_mfma_f32_16x16x32_bf16 v[120:123], v[212:215], a[152:155], v[120:123]
ds_read_b64_tr_b16 v[210:211], v50 offset:1024
s_waitcnt lgkmcnt(11)
v_mfma_f32_16x16x16bf16_1k v[88:91], v[246:247], v[52:53], v[88:91]
v_mfma_f32_16x16x32_bf16 v[124:127], v[212:215], a[156:159], v[124:127]
s_waitcnt lgkmcnt(6)
ds_read_b64_tr_b16 v[212:213], v51 offset:0
v_mfma_f32_16x16x16bf16_1k v[92:95], v[246:247], v[28:29], v[92:95]
v_mfma_f32_16x16x32_bf16 v[128:131], v[216:219], a[0:3], 0
ds_read_b64_tr_b16 v[214:215], v51 offset:1024
ds_read_b64 v[240:241], v250 offset:0
v_mfma_f32_16x16x32_bf16 v[132:135], v[216:219], a[4:7], 0
ds_read_b64 v[242:243], v250 offset:128
ds_read_b64 v[244:245], v251 offset:0
v_mfma_f32_16x16x32_bf16 v[136:139], v[220:223], a[0:3], 0
s_add_u32 m0, s76, 51200
s_nop 0
buffer_load_dwordx4 v16, s[32:35], s75 offen lds
ds_read_b64 v[246:247], v251 offset:128
v_mfma_f32_16x16x32_bf16 v[140:143], v[220:223], a[4:7], 0
v_mul_f32 v64, v64, v56
v_mul_f32 v65, v65, v56
v_mul_f32 v66, v66, v56
v_mul_f32 v67, v67, v56
v_mul_f32 v68, v68, v31
v_mul_f32 v69, v69, v31
v_cvt_pk_bf16_f32 v64, v64, v65
v_mfma_f32_4x4x4bf16_1k v[32:35], v[36:37], v[216:217], 0
v_mfma_f32_4x4x4bf16_1k v[252:255], v[36:37], v[220:221], 0
v_cvt_pk_bf16_f32 v65, v66, v67
v_mfma_f32_4x4x4bf16_1k v[32:35], v[36:37], v[218:219], v[32:35]
v_mfma_f32_4x4x4bf16_1k v[252:255], v[36:37], v[222:223], v[252:255]
s_nop 0
v_mfma_f32_4x4x4bf16_1k v[32:35], v[36:37], v[224:225], v[32:35]
v_mfma_f32_4x4x4bf16_1k v[252:255], v[36:37], v[228:229], v[252:255]
s_nop 0
v_mfma_f32_4x4x4bf16_1k v[32:35], v[36:37], v[226:227], v[32:35]
v_mfma_f32_4x4x4bf16_1k v[252:255], v[36:37], v[230:231], v[252:255]
v_mfma_f32_16x16x32_bf16 v[144:147], v[192:195], a[0:3], 0
v_cvt_pk_bf16_f32 v66, v68, v69
v_mul_f32 v70, v70, v31
v_mfma_f32_16x16x32_bf16 v[148:151], v[192:195], a[4:7], 0
ds_read_b64_tr_b16 v[192:193], v46 offset:8192
v_mul_f32 v71, v71, v31
v_mfma_f32_16x16x32_bf16 v[152:155], v[196:199], a[0:3], 0
ds_read_b64_tr_b16 v[194:195], v46 offset:9216
v_cvt_pk_bf16_f32 v67, v70, v71
v_mfma_f32_16x16x32_bf16 v[156:159], v[196:199], a[4:7], 0
s_waitcnt lgkmcnt(6)
ds_read_b64_tr_b16 v[196:197], v47 offset:8192
v_permlane16_swap_b32 v64, v66
v_mfma_f32_16x16x32_bf16 v[160:163], v[200:203], a[0:3], 0
ds_read_b64_tr_b16 v[198:199], v47 offset:9216
s_waitcnt lgkmcnt(7)
v_mfma_f32_16x16x16bf16_1k v[96:99], v[240:241], v[52:53], v[96:99]
v_mfma_f32_16x16x32_bf16 v[164:167], v[200:203], a[4:7], 0
s_add_u32 m0, s76, 52224
ds_read_b64_tr_b16 v[200:201], v48 offset:8192
buffer_load_dwordx4 v17, s[32:35], s75 offen lds
v_mfma_f32_16x16x16bf16_1k v[100:103], v[240:241], v[28:29], v[100:103]
v_mfma_f32_16x16x32_bf16 v[168:171], v[204:207], a[0:3], 0
s_add_u32 s75, s75, 221184
ds_read_b64_tr_b16 v[202:203], v48 offset:9216
s_sub_u32 s85, s75, 2211840
s_waitcnt lgkmcnt(8)
v_mfma_f32_16x16x16bf16_1k v[104:107], v[242:243], v[52:53], v[104:107]
v_mfma_f32_16x16x32_bf16 v[172:175], v[204:207], a[4:7], 0
s_min_u32 s75, s75, s85
ds_read_b64_tr_b16 v[204:205], v49 offset:8192
v_permlane16_swap_b32 v65, v67
v_mfma_f32_16x16x16bf16_1k v[108:111], v[242:243], v[28:29], v[108:111]
v_mfma_f32_16x16x32_bf16 v[176:179], v[208:211], a[0:3], 0
ds_read_b64_tr_b16 v[206:207], v49 offset:9216
s_waitcnt lgkmcnt(9)
v_mfma_f32_16x16x16bf16_1k v[112:115], v[244:245], v[52:53], v[112:115]
v_mfma_f32_16x16x32_bf16 v[180:183], v[208:211], a[4:7], 0
ds_read_b64_tr_b16 v[208:209], v50 offset:8192
buffer_store_dwordx4 v[64:67], v42, s[36:39], s92 offen sc1
v_mfma_f32_16x16x16bf16_1k v[116:119], v[244:245], v[28:29], v[116:119]
v_mfma_f32_16x16x32_bf16 v[184:187], v[212:215], a[0:3], 0
ds_read_b64_tr_b16 v[210:211], v50 offset:9216
s_waitcnt lgkmcnt(10)
v_mfma_f32_16x16x16bf16_1k v[120:123], v[246:247], v[52:53], v[120:123]
v_mfma_f32_16x16x32_bf16 v[188:191], v[212:215], a[4:7], 0
s_waitcnt lgkmcnt(6)
ds_read_b64_tr_b16 v[212:213], v51 offset:8192
v_mul_f32 v72, v72, v56
v_mfma_f32_16x16x16bf16_1k v[124:127], v[246:247], v[28:29], v[124:127]
v_mfma_f32_16x16x32_bf16 v[128:131], v[224:227], a[8:11], v[128:131]
ds_read_b64_tr_b16 v[214:215], v51 offset:9216
v_mul_f32 v73, v73, v56
v_mfma_f32_16x16x32_bf16 v[132:135], v[224:227], a[12:15], v[132:135]
s_waitcnt vmcnt(9)
s_barrier
v_mul_f32 v74, v74, v56
v_mfma_f32_16x16x32_bf16 v[136:139], v[228:231], a[8:11], v[136:139]
ds_read_b64_tr_b16 v[216:217], v44 offset:16384
ds_read_b64_tr_b16 v[218:219], v44 offset:17408
v_mfma_f32_16x16x32_bf16 v[140:143], v[228:231], a[12:15], v[140:143]
ds_read_b64_tr_b16 v[220:221], v45 offset:16384
ds_read_b64_tr_b16 v[222:223], v45 offset:17408
v_mfma_f32_16x16x32_bf16 v[144:147], v[192:195], a[8:11], v[144:147]
ds_read_b64_tr_b16 v[224:225], v44 offset:24576
ds_read_b64_tr_b16 v[226:227], v44 offset:25600
v_mfma_f32_16x16x32_bf16 v[148:151], v[192:195], a[12:15], v[148:151]
s_add_u32 m0, s76, 65536
ds_read_b64_tr_b16 v[192:193], v46 offset:16384
buffer_load_dwordx4 v14, s[32:35], s75 offen lds
v_mfma_f32_16x16x32_bf16 v[152:155], v[196:199], a[8:11], v[152:155]
ds_read_b64_tr_b16 v[194:195], v46 offset:17408
ds_read_b64_tr_b16 v[228:229], v45 offset:24576
v_mfma_f32_16x16x32_bf16 v[156:159], v[196:199], a[12:15], v[156:159]
s_waitcnt lgkmcnt(9)
ds_read_b64_tr_b16 v[196:197], v47 offset:16384
ds_read_b64_tr_b16 v[230:231], v45 offset:25600
v_mfma_f32_16x16x32_bf16 v[160:163], v[200:203], a[8:11], v[160:163]
ds_read_b64_tr_b16 v[198:199], v47 offset:17408
v_mul_f32 v75, v75, v56
v_mfma_f32_16x16x32_bf16 v[164:167], v[200:203], a[12:15], v[164:167]
ds_read_b64_tr_b16 v[200:201], v48 offset:16384
v_mul_f32 v76, v76, v31
v_mfma_f32_16x16x32_bf16 v[168:171], v[204:207], a[8:11], v[168:171]
s_add_u32 m0, s76, 66560
ds_read_b64_tr_b16 v[202:203], v48 offset:17408
buffer_load_dwordx4 v15, s[32:35], s75 offen lds
v_mfma_f32_16x16x32_bf16 v[172:175], v[204:207], a[12:15], v[172:175]
ds_read_b64_tr_b16 v[204:205], v49 offset:16384
v_mul_f32 v77, v77, v31
v_mfma_f32_16x16x32_bf16 v[176:179], v[208:211], a[8:11], v[176:179]
ds_read_b64_tr_b16 v[206:207], v49 offset:17408
v_cvt_pk_bf16_f32 v68, v72, v73
v_mfma_f32_16x16x32_bf16 v[180:183], v[208:211], a[12:15], v[180:183]
ds_read_b64_tr_b16 v[208:209], v50 offset:16384
v_cvt_pk_bf16_f32 v69, v74, v75
v_mfma_f32_16x16x32_bf16 v[184:187], v[212:215], a[8:11], v[184:187]
ds_read_b64_tr_b16 v[210:211], v50 offset:17408
v_cvt_pk_bf16_f32 v70, v76, v77
v_mfma_f32_16x16x32_bf16 v[188:191], v[212:215], a[12:15], v[188:191]
s_waitcnt lgkmcnt(6)
ds_read_b64_tr_b16 v[212:213], v51 offset:16384
v_mul_f32 v78, v78, v31
v_mfma_f32_16x16x32_bf16 v[128:131], v[216:219], a[16:19], v[128:131]
ds_read_b64_tr_b16 v[214:215], v51 offset:17408
v_mul_f32 v79, v79, v31
v_mfma_f32_16x16x32_bf16 v[132:135], v[216:219], a[20:23], v[132:135]
v_cvt_pk_bf16_f32 v71, v78, v79
v_permlane16_swap_b32 v68, v70
s_nop 0
v_permlane16_swap_b32 v69, v71
buffer_store_dwordx4 v[68:71], v61, s[36:39], s92 offen sc1
v_mul_f32 v80, v80, v56
v_mul_f32 v81, v81, v56
v_mul_f32 v82, v82, v56
v_mul_f32 v83, v83, v56
v_mul_f32 v84, v84, v31
v_mul_f32 v85, v85, v31
v_cvt_pk_bf16_f32 v72, v80, v81
v_cvt_pk_bf16_f32 v73, v82, v83
v_cvt_pk_bf16_f32 v74, v84, v85
v_mul_f32 v86, v86, v31
v_mul_f32 v87, v87, v31
v_cvt_pk_bf16_f32 v75, v86, v87
v_permlane16_swap_b32 v72, v74
s_nop 0
v_permlane16_swap_b32 v73, v75
buffer_store_dwordx4 v[72:75], v42, s[36:39], s93 offen sc1
v_mul_f32 v88, v88, v56
v_mul_f32 v89, v89, v56
v_mul_f32 v90, v90, v56
v_mul_f32 v91, v91, v56
v_mul_f32 v92, v92, v31
v_mul_f32 v93, v93, v31
v_cvt_pk_bf16_f32 v76, v88, v89
v_cvt_pk_bf16_f32 v77, v90, v91
v_cvt_pk_bf16_f32 v78, v92, v93
v_mul_f32 v94, v94, v31
v_mul_f32 v95, v95, v31
v_cvt_pk_bf16_f32 v79, v94, v95
v_permlane16_swap_b32 v76, v78
s_nop 0
v_permlane16_swap_b32 v77, v79
buffer_store_dwordx4 v[76:79], v61, s[36:39], s93 offen sc1
v_mfma_f32_16x16x32_bf16 v[136:139], v[220:223], a[16:19], v[136:139]
s_add_u32 m0, s76, 67584
s_nop 0
buffer_load_dwordx4 v16, s[32:35], s75 offen lds
v_mul_f32 v96, v96, v56
v_mfma_f32_16x16x32_bf16 v[140:143], v[220:223], a[20:23], v[140:143]
v_mul_f32 v97, v97, v56
v_mul_f32 v98, v98, v56
v_mfma_f32_16x16x32_bf16 v[144:147], v[192:195], a[16:19], v[144:147]
v_mul_f32 v99, v99, v56
v_mul_f32 v100, v100, v31
v_mfma_f32_16x16x32_bf16 v[148:151], v[192:195], a[20:23], v[148:151]
ds_read_b64_tr_b16 v[192:193], v46 offset:24576
v_mul_f32 v101, v101, v31
v_mfma_f32_16x16x32_bf16 v[152:155], v[196:199], a[16:19], v[152:155]
ds_read_b64_tr_b16 v[194:195], v46 offset:25600
v_cvt_pk_bf16_f32 v80, v96, v97
v_mfma_f32_16x16x32_bf16 v[156:159], v[196:199], a[20:23], v[156:159]
s_waitcnt lgkmcnt(2)
ds_read_b64_tr_b16 v[196:197], v47 offset:24576
v_cvt_pk_bf16_f32 v81, v98, v99
v_mfma_f32_16x16x32_bf16 v[160:163], v[200:203], a[16:19], v[160:163]
ds_read_b64_tr_b16 v[198:199], v47 offset:25600
v_cvt_pk_bf16_f32 v82, v100, v101
v_mfma_f32_16x16x32_bf16 v[164:167], v[200:203], a[20:23], v[164:167]
ds_read_b64_tr_b16 v[200:201], v48 offset:24576
v_mul_f32 v102, v102, v31
v_mfma_f32_16x16x32_bf16 v[168:171], v[204:207], a[16:19], v[168:171]
s_add_u32 m0, s76, 68608
ds_read_b64_tr_b16 v[202:203], v48 offset:25600
buffer_load_dwordx4 v17, s[32:35], s75 offen lds
v_mfma_f32_16x16x32_bf16 v[172:175], v[204:207], a[20:23], v[172:175]
s_add_u32 s75, s75, 221184
ds_read_b64_tr_b16 v[204:205], v49 offset:24576
s_sub_u32 s85, s75, 2211840
v_mfma_f32_16x16x32_bf16 v[176:179], v[208:211], a[16:19], v[176:179]
s_min_u32 s75, s75, s85
ds_read_b64_tr_b16 v[206:207], v49 offset:25600
v_mul_f32 v103, v103, v31
v_mfma_f32_16x16x32_bf16 v[180:183], v[208:211], a[20:23], v[180:183]
ds_read_b64_tr_b16 v[208:209], v50 offset:24576
v_cvt_pk_bf16_f32 v83, v102, v103
v_mfma_f32_16x16x32_bf16 v[184:187], v[212:215], a[16:19], v[184:187]
ds_read_b64_tr_b16 v[210:211], v50 offset:25600
v_permlane16_swap_b32 v80, v82
v_mfma_f32_16x16x32_bf16 v[188:191], v[212:215], a[20:23], v[188:191]
s_waitcnt lgkmcnt(6)
ds_read_b64_tr_b16 v[212:213], v51 offset:24576
v_mfma_f32_16x16x32_bf16 v[128:131], v[224:227], a[24:27], v[128:131]
ds_read_b64_tr_b16 v[214:215], v51 offset:25600
v_permlane16_swap_b32 v81, v83
v_mfma_f32_16x16x32_bf16 v[132:135], v[224:227], a[28:31], v[132:135]
s_waitcnt vmcnt(12)
s_barrier
v_mfma_f32_16x16x32_bf16 v[136:139], v[228:231], a[24:27], v[136:139]
ds_read_b64_tr_b16 v[216:217], v44 offset:32768
ds_read_b64_tr_b16 v[218:219], v44 offset:33792
v_mfma_f32_16x16x32_bf16 v[140:143], v[228:231], a[28:31], v[140:143]
ds_read_b64_tr_b16 v[220:221], v45 offset:32768
ds_read_b64_tr_b16 v[222:223], v45 offset:33792
v_mfma_f32_16x16x32_bf16 v[144:147], v[192:195], a[24:27], v[144:147]
ds_read_b64_tr_b16 v[224:225], v44 offset:40960
ds_read_b64_tr_b16 v[226:227], v44 offset:41984
v_mfma_f32_16x16x32_bf16 v[148:151], v[192:195], a[28:31], v[148:151]
s_add_u32 m0, s76, 0
ds_read_b64_tr_b16 v[192:193], v46 offset:32768
buffer_load_dwordx4 v14, s[32:35], s75 offen lds
v_mfma_f32_16x16x32_bf16 v[152:155], v[196:199], a[24:27], v[152:155]
ds_read_b64_tr_b16 v[194:195], v46 offset:33792
ds_read_b64_tr_b16 v[228:229], v45 offset:40960
v_mfma_f32_16x16x32_bf16 v[156:159], v[196:199], a[28:31], v[156:159]
s_waitcnt lgkmcnt(9)
ds_read_b64_tr_b16 v[196:197], v47 offset:32768
ds_read_b64_tr_b16 v[230:231], v45 offset:41984
v_mfma_f32_16x16x32_bf16 v[160:163], v[200:203], a[24:27], v[160:163]
ds_read_b64_tr_b16 v[198:199], v47 offset:33792
buffer_store_dwordx4 v[80:83], v42, s[36:39], s94 offen sc1
v_mfma_f32_16x16x32_bf16 v[164:167], v[200:203], a[28:31], v[164:167]
ds_read_b64_tr_b16 v[200:201], v48 offset:32768
v_mfma_f32_16x16x32_bf16 v[168:171], v[204:207], a[24:27], v[168:171]
s_add_u32 m0, s76, 1024
ds_read_b64_tr_b16 v[202:203], v48 offset:33792
buffer_load_dwordx4 v15, s[32:35], s75 offen lds
v_mfma_f32_16x16x32_bf16 v[172:175], v[204:207], a[28:31], v[172:175]
ds_read_b64_tr_b16 v[204:205], v49 offset:32768
v_mul_f32 v104, v104, v56
v_mfma_f32_16x16x32_bf16 v[176:179], v[208:211], a[24:27], v[176:179]
ds_read_b64_tr_b16 v[206:207], v49 offset:33792
v_mul_f32 v105, v105, v56
v_mfma_f32_16x16x32_bf16 v[180:183], v[208:211], a[28:31], v[180:183]
ds_read_b64_tr_b16 v[208:209], v50 offset:32768
v_mul_f32 v106, v106, v56
v_mfma_f32_16x16x32_bf16 v[184:187], v[212:215], a[24:27], v[184:187]
ds_read_b64_tr_b16 v[210:211], v50 offset:33792
v_mul_f32 v107, v107, v56
v_mfma_f32_16x16x32_bf16 v[188:191], v[212:215], a[28:31], v[188:191]
s_waitcnt lgkmcnt(6)
ds_read_b64_tr_b16 v[212:213], v51 offset:32768
v_mul_f32 v108, v108, v31
v_mfma_f32_16x16x32_bf16 v[128:131], v[216:219], a[32:35], v[128:131]
ds_read_b64_tr_b16 v[214:215], v51 offset:33792
v_mul_f32 v109, v109, v31
v_mfma_f32_16x16x32_bf16 v[132:135], v[216:219], a[36:39], v[132:135]
v_cvt_pk_bf16_f32 v84, v104, v105
v_cvt_pk_bf16_f32 v85, v106, v107
v_mfma_f32_16x16x32_bf16 v[136:139], v[220:223], a[32:35], v[136:139]
s_add_u32 m0, s76, 2048
s_nop 0
buffer_load_dwordx4 v16, s[32:35], s75 offen lds
v_cvt_pk_bf16_f32 v86, v108, v109
v_mfma_f32_16x16x32_bf16 v[140:143], v[220:223], a[36:39], v[140:143]
v_mul_f32 v110, v110, v31
v_mul_f32 v111, v111, v31
v_cvt_pk_bf16_f32 v87, v110, v111
v_permlane16_swap_b32 v84, v86
s_nop 0
v_permlane16_swap_b32 v85, v87
buffer_store_dwordx4 v[84:87], v61, s[36:39], s94 offen sc1
v_mul_f32 v112, v112, v56
v_mul_f32 v113, v113, v56
v_mul_f32 v114, v114, v56
v_mul_f32 v115, v115, v56
v_mul_f32 v116, v116, v31
v_mul_f32 v117, v117, v31
v_cvt_pk_bf16_f32 v88, v112, v113
v_cvt_pk_bf16_f32 v89, v114, v115
v_cvt_pk_bf16_f32 v90, v116, v117
v_mul_f32 v118, v118, v31
v_mul_f32 v119, v119, v31
v_cvt_pk_bf16_f32 v91, v118, v119
v_permlane16_swap_b32 v88, v90
s_nop 0
v_permlane16_swap_b32 v89, v91
buffer_store_dwordx4 v[88:91], v42, s[36:39], s95 offen sc1
v_mul_f32 v120, v120, v56
v_mul_f32 v121, v121, v56
v_mul_f32 v122, v122, v56
v_mul_f32 v123, v123, v56
v_mul_f32 v124, v124, v31
v_mul_f32 v125, v125, v31
v_cvt_pk_bf16_f32 v92, v120, v121
v_cvt_pk_bf16_f32 v93, v122, v123
v_cvt_pk_bf16_f32 v94, v124, v125
v_mul_f32 v126, v126, v31
v_mul_f32 v127, v127, v31
v_cvt_pk_bf16_f32 v95, v126, v127
v_permlane16_swap_b32 v92, v94
s_nop 0
v_permlane16_swap_b32 v93, v95
buffer_store_dwordx4 v[92:95], v61, s[36:39], s95 offen sc1
v_mfma_f32_16x16x32_bf16 v[144:147], v[192:195], a[32:35], v[144:147]
v_mfma_f32_16x16x32_bf16 v[148:151], v[192:195], a[36:39], v[148:151]
ds_read_b64_tr_b16 v[192:193], v46 offset:40960
v_mfma_f32_16x16x32_bf16 v[152:155], v[196:199], a[32:35], v[152:155]
ds_read_b64_tr_b16 v[194:195], v46 offset:41984
v_mfma_f32_16x16x32_bf16 v[156:159], v[196:199], a[36:39], v[156:159]
s_waitcnt lgkmcnt(2)
ds_read_b64_tr_b16 v[196:197], v47 offset:40960
v_mfma_f32_16x16x32_bf16 v[160:163], v[200:203], a[32:35], v[160:163]
ds_read_b64_tr_b16 v[198:199], v47 offset:41984
v_mov_b32 v33, v32
v_mfma_f32_16x16x32_bf16 v[164:167], v[200:203], a[36:39], v[164:167]
ds_read_b64_tr_b16 v[200:201], v48 offset:40960
v_mov_b32 v253, v252
v_mfma_f32_16x16x32_bf16 v[168:171], v[204:207], a[32:35], v[168:171]
s_add_u32 m0, s76, 3072
ds_read_b64_tr_b16 v[202:203], v48 offset:41984
buffer_load_dwordx4 v17, s[32:35], s75 offen lds
v_mfma_f32_16x16x32_bf16 v[172:175], v[204:207], a[36:39], v[172:175]
s_add_u32 s75, s75, 221184
ds_read_b64_tr_b16 v[204:205], v49 offset:40960
s_sub_u32 s85, s75, 2211840
v_mfma_f32_16x16x32_bf16 v[176:179], v[208:211], a[32:35], v[176:179]
s_min_u32 s75, s75, s85
ds_read_b64_tr_b16 v[206:207], v49 offset:41984
v_permlane16_swap_b32 v32, v33
v_mfma_f32_16x16x32_bf16 v[180:183], v[208:211], a[36:39], v[180:183]
ds_read_b64_tr_b16 v[208:209], v50 offset:40960
v_mfma_f32_16x16x32_bf16 v[184:187], v[212:215], a[32:35], v[184:187]
ds_read_b64_tr_b16 v[210:211], v50 offset:41984
v_permlane16_swap_b32 v252, v253
v_mfma_f32_16x16x32_bf16 v[188:191], v[212:215], a[36:39], v[188:191]
s_waitcnt lgkmcnt(6)
ds_read_b64_tr_b16 v[212:213], v51 offset:40960
v_mfma_f32_16x16x32_bf16 v[128:131], v[224:227], a[40:43], v[128:131]
ds_read_b64_tr_b16 v[214:215], v51 offset:41984
v_add_f32 v32, v32, v33
v_mfma_f32_16x16x32_bf16 v[132:135], v[224:227], a[44:47], v[132:135]
s_waitcnt vmcnt(16)
s_barrier
v_add_f32 v252, v252, v253
v_mfma_f32_16x16x32_bf16 v[136:139], v[228:231], a[40:43], v[136:139]
ds_read_b64_tr_b16 v[216:217], v44 offset:49152
ds_read_b64_tr_b16 v[218:219], v44 offset:50176
v_mfma_f32_16x16x32_bf16 v[140:143], v[228:231], a[44:47], v[140:143]
ds_read_b64_tr_b16 v[220:221], v45 offset:49152
ds_read_b64_tr_b16 v[222:223], v45 offset:50176
v_mfma_f32_16x16x32_bf16 v[144:147], v[192:195], a[40:43], v[144:147]
ds_read_b64_tr_b16 v[224:225], v44 offset:57344
ds_read_b64_tr_b16 v[226:227], v44 offset:58368
v_mfma_f32_16x16x32_bf16 v[148:151], v[192:195], a[44:47], v[148:151]
s_add_u32 m0, s76, 16384
ds_read_b64_tr_b16 v[192:193], v46 offset:49152
buffer_load_dwordx4 v14, s[32:35], s75 offen lds
v_mfma_f32_16x16x32_bf16 v[152:155], v[196:199], a[40:43], v[152:155]
ds_read_b64_tr_b16 v[194:195], v46 offset:50176
ds_read_b64_tr_b16 v[228:229], v45 offset:57344
v_mfma_f32_16x16x32_bf16 v[156:159], v[196:199], a[44:47], v[156:159]
s_waitcnt lgkmcnt(9)
ds_read_b64_tr_b16 v[196:197], v47 offset:49152
ds_read_b64_tr_b16 v[230:231], v45 offset:58368
v_mfma_f32_16x16x32_bf16 v[160:163], v[200:203], a[40:43], v[160:163]
ds_read_b64_tr_b16 v[198:199], v47 offset:50176
v_mov_b32 v33, v32
v_mfma_f32_16x16x32_bf16 v[164:167], v[200:203], a[44:47], v[164:167]
ds_read_b64_tr_b16 v[200:201], v48 offset:49152
v_mov_b32 v253, v252
v_mfma_f32_16x16x32_bf16 v[168:171], v[204:207], a[40:43], v[168:171]
s_add_u32 m0, s76, 17408
ds_read_b64_tr_b16 v[202:203], v48 offset:50176
buffer_load_dwordx4 v15, s[32:35], s75 offen lds
v_mfma_f32_16x16x32_bf16 v[172:175], v[204:207], a[44:47], v[172:175]
ds_read_b64_tr_b16 v[204:205], v49 offset:49152
v_permlane32_swap_b32 v32, v33
v_mfma_f32_16x16x32_bf16 v[176:179], v[208:211], a[40:43], v[176:179]
ds_read_b64_tr_b16 v[206:207], v49 offset:50176
v_mfma_f32_16x16x32_bf16 v[180:183], v[208:211], a[44:47], v[180:183]
ds_read_b64_tr_b16 v[208:209], v50 offset:49152
v_permlane32_swap_b32 v252, v253
v_mfma_f32_16x16x32_bf16 v[184:187], v[212:215], a[40:43], v[184:187]
ds_read_b64_tr_b16 v[210:211], v50 offset:50176
v_mfma_f32_16x16x32_bf16 v[188:191], v[212:215], a[44:47], v[188:191]
s_waitcnt lgkmcnt(6)
ds_read_b64_tr_b16 v[212:213], v51 offset:49152
v_add_f32 v32, v32, v33
v_mfma_f32_16x16x32_bf16 v[128:131], v[216:219], a[48:51], v[128:131]
ds_read_b64_tr_b16 v[214:215], v51 offset:50176
v_add_f32 v252, v252, v253
v_mfma_f32_16x16x32_bf16 v[132:135], v[216:219], a[52:55], v[132:135]
v_and_b32 v34, 16, v0
v_cmp_ne_u32 vcc, 0, v34
v_lshlrev_b32 v34, 3, v20
v_lshl_or_b32 v34, v21, 31, v34
v_cndmask_b32 v32, v32, v252, vcc
v_mfma_f32_16x16x32_bf16 v[136:139], v[220:223], a[48:51], v[136:139]
s_add_u32 m0, s76, 18432
s_nop 0
buffer_load_dwordx4 v16, s[32:35], s75 offen lds
v_mfma_f32_16x16x32_bf16 v[140:143], v[220:223], a[52:55], v[140:143]
s_add_u32 s86, s86, 163840
v_mov_b32 v33, s72
buffer_store_dwordx2 v[32:33], v34, s[52:55], s86 offen sc1
v_mfma_f32_16x16x32_bf16 v[144:147], v[192:195], a[48:51], v[144:147]
v_accvgpr_read_b32 v10, a224
v_accvgpr_read_b32 v11, a225
v_mfma_f32_16x16x32_bf16 v[148:151], v[192:195], a[52:55], v[148:151]
ds_read_b64_tr_b16 v[192:193], v46 offset:57344
v_accvgpr_read_b32 v12, a226
v_mfma_f32_16x16x32_bf16 v[152:155], v[196:199], a[48:51], v[152:155]
ds_read_b64_tr_b16 v[194:195], v46 offset:58368
v_accvgpr_read_b32 v13, a227
v_mfma_f32_16x16x32_bf16 v[156:159], v[196:199], a[52:55], v[156:159]
s_waitcnt lgkmcnt(2)
ds_read_b64_tr_b16 v[196:197], v47 offset:57344
v_accvgpr_read_b32 v9, a228
v_mfma_f32_16x16x32_bf16 v[160:163], v[200:203], a[48:51], v[160:163]
ds_read_b64_tr_b16 v[198:199], v47 offset:58368
v_accvgpr_read_b32 v2, a229
v_mfma_f32_16x16x32_bf16 v[164:167], v[200:203], a[52:55], v[164:167]
ds_read_b64_tr_b16 v[200:201], v48 offset:57344
v_accvgpr_read_b32 v3, a230
v_mfma_f32_16x16x32_bf16 v[168:171], v[204:207], a[48:51], v[168:171]
s_add_u32 m0, s76, 19456
ds_read_b64_tr_b16 v[202:203], v48 offset:58368
buffer_load_dwordx4 v17, s[32:35], s75 offen lds
v_mfma_f32_16x16x32_bf16 v[172:175], v[204:207], a[52:55], v[172:175]
s_add_u32 s75, s75, 221184
ds_read_b64_tr_b16 v[204:205], v49 offset:57344
s_sub_u32 s85, s75, 2211840
v_mfma_f32_16x16x32_bf16 v[176:179], v[208:211], a[48:51], v[176:179]
s_min_u32 s75, s75, s85
ds_read_b64_tr_b16 v[206:207], v49 offset:58368
v_accvgpr_read_b32 v4, a231
v_mfma_f32_16x16x32_bf16 v[180:183], v[208:211], a[52:55], v[180:183]
ds_read_b64_tr_b16 v[208:209], v50 offset:57344
v_lshlrev_b32 v40, 2, v21
v_mfma_f32_16x16x32_bf16 v[184:187], v[212:215], a[48:51], v[184:187]
ds_read_b64_tr_b16 v[210:211], v50 offset:58368
v_sub_u32 v40, v20, v40
v_mfma_f32_16x16x32_bf16 v[188:191], v[212:215], a[52:55], v[188:191]
s_waitcnt lgkmcnt(6)
ds_read_b64_tr_b16 v[212:213], v51 offset:57344
v_mov_b32 v41, 0xf149f2ca
v_mfma_f32_16x16x32_bf16 v[128:131], v[224:227], a[56:59], v[128:131]
ds_read_b64_tr_b16 v[214:215], v51 offset:58368
v_accvgpr_read_b32 v5, a232
v_mfma_f32_16x16x32_bf16 v[132:135], v[224:227], a[60:63], v[132:135]
s_waitcnt vmcnt(13)
s_barrier
v_cmp_gt_i32 s[90:91], 0, v40
v_mfma_f32_16x16x32_bf16 v[136:139], v[228:231], a[56:59], v[136:139]
ds_read_b64_tr_b16 v[216:217], v232 offset:0
ds_read_b64_tr_b16 v[218:219], v232 offset:1024
v_mfma_f32_16x16x32_bf16 v[140:143], v[228:231], a[60:63], v[140:143]
ds_read_b64_tr_b16 v[220:221], v233 offset:0
ds_read_b64_tr_b16 v[222:223], v233 offset:1024
buffer_load_dword v26, v55, s[52:55], 0 offen sc1
v_mfma_f32_16x16x32_bf16 v[144:147], v[192:195], a[56:59], v[144:147]
ds_read_b64_tr_b16 v[224:225], v232 offset:8192
ds_read_b64_tr_b16 v[226:227], v232 offset:9216
v_mfma_f32_16x16x32_bf16 v[148:151], v[192:195], a[60:63], v[148:151]
s_add_u32 m0, s76, 32768
ds_read_b64_tr_b16 v[192:193], v234 offset:0
buffer_load_dwordx4 v14, s[32:35], s75 offen lds
v_mfma_f32_16x16x32_bf16 v[152:155], v[196:199], a[56:59], v[152:155]
ds_read_b64_tr_b16 v[194:195], v234 offset:1024
ds_read_b64_tr_b16 v[228:229], v233 offset:8192
v_mfma_f32_16x16x32_bf16 v[156:159], v[196:199], a[60:63], v[156:159]
s_waitcnt lgkmcnt(9)
ds_read_b64_tr_b16 v[196:197], v235 offset:0
ds_read_b64_tr_b16 v[230:231], v233 offset:9216
v_mfma_f32_16x16x32_bf16 v[160:163], v[200:203], a[56:59], v[160:163]
ds_read_b64_tr_b16 v[198:199], v235 offset:1024
v_accvgpr_read_b32 v6, a233
v_mfma_f32_16x16x32_bf16 v[164:167], v[200:203], a[60:63], v[164:167]
ds_read_b64_tr_b16 v[200:201], v236 offset:0
v_accvgpr_read_b32 v7, a234
v_mfma_f32_16x16x32_bf16 v[168:171], v[204:207], a[56:59], v[168:171]
s_add_u32 m0, s76, 33792
ds_read_b64_tr_b16 v[202:203], v236 offset:1024
buffer_load_dwordx4 v15, s[32:35], s75 offen lds
v_mfma_f32_16x16x32_bf16 v[172:175], v[204:207], a[60:63], v[172:175]
ds_read_b64_tr_b16 v[204:205], v237 offset:0
v_cmp_gt_i32 s[96:97], 1, v40
v_mfma_f32_16x16x32_bf16 v[176:179], v[208:211], a[56:59], v[176:179]
ds_read_b64_tr_b16 v[206:207], v237 offset:1024
v_accvgpr_read_b32 v8, a235
v_mfma_f32_16x16x32_bf16 v[180:183], v[208:211], a[60:63], v[180:183]
ds_read_b64_tr_b16 v[208:209], v238 offset:0
v_cmp_gt_i32 s[98:99], 2, v40
v_mfma_f32_16x16x32_bf16 v[184:187], v[212:215], a[56:59], v[184:187]
ds_read_b64_tr_b16 v[210:211], v238 offset:1024
v_cndmask_b32 v64, v41, 0, s[90:91]
v_mfma_f32_16x16x32_bf16 v[188:191], v[212:215], a[60:63], v[188:191]
s_waitcnt lgkmcnt(6)
ds_read_b64_tr_b16 v[212:213], v239 offset:0
v_cndmask_b32 v80, 0, v41, s[90:91]
v_mfma_f32_16x16x32_bf16 v[128:131], v[216:219], a[64:67], v[128:131]
ds_read_b64_tr_b16 v[214:215], v239 offset:1024
v_accvgpr_read_b32 v19, a236
v_mfma_f32_16x16x32_bf16 v[132:135], v[216:219], a[68:71], v[132:135]
v_cmp_gt_i32 s[90:91], 3, v40
v_cndmask_b32 v65, v41, 0, s[96:97]
v_mfma_f32_16x16x32_bf16 v[136:139], v[220:223], a[64:67], v[136:139]
s_add_u32 m0, s76, 34816
s_nop 0
buffer_load_dwordx4 v16, s[32:35], s75 offen lds
v_cndmask_b32 v81, 0, v41, s[96:97]
v_mfma_f32_16x16x32_bf16 v[140:143], v[220:223], a[68:71], v[140:143]
v_cmp_gt_i32 s[96:97], 8, v40
v_cndmask_b32 v66, v41, 0, s[98:99]
v_mfma_f32_16x16x32_bf16 v[144:147], v[192:195], a[64:67], v[144:147]
v_accvgpr_read_b32 v22, a237
v_cndmask_b32 v82, 0, v41, s[98:99]
v_mfma_f32_16x16x32_bf16 v[148:151], v[192:195], a[68:71], v[148:151]
ds_read_b64_tr_b16 v[192:193], v234 offset:8192
v_cmp_gt_i32 s[98:99], 9, v40
v_mfma_f32_16x16x32_bf16 v[152:155], v[196:199], a[64:67], v[152:155]
ds_read_b64_tr_b16 v[194:195], v234 offset:9216
v_cndmask_b32 v67, v41, 0, s[90:91]
v_mfma_f32_16x16x32_bf16 v[156:159], v[196:199], a[68:71], v[156:159]
s_waitcnt lgkmcnt(2)
ds_read_b64_tr_b16 v[196:197], v235 offset:8192
v_cndmask_b32 v83, 0, v41, s[90:91]
v_mfma_f32_16x16x32_bf16 v[160:163], v[200:203], a[64:67], v[160:163]
ds_read_b64_tr_b16 v[198:199], v235 offset:9216
v_accvgpr_read_b32 v23, a238
v_mfma_f32_16x16x32_bf16 v[164:167], v[200:203], a[68:71], v[164:167]
ds_read_b64_tr_b16 v[200:201], v236 offset:8192
s_waitcnt vmcnt(10)
v_mov_b32 v18, s72
s_mov_b64 exec, 1
buffer_store_dword v18, off, s[52:55], s18 sc1
s_mov_b64 exec, -1
v_cmp_gt_i32 s[90:91], 10, v40
v_mfma_f32_16x16x32_bf16 v[168:171], v[204:207], a[64:67], v[168:171]
s_add_u32 m0, s76, 35840
ds_read_b64_tr_b16 v[202:203], v236 offset:9216
buffer_load_dwordx4 v17, s[32:35], s75 offen lds
v_mfma_f32_16x16x32_bf16 v[172:175], v[204:207], a[68:71], v[172:175]
s_add_u32 s75, s75, 221184
ds_read_b64_tr_b16 v[204:205], v237 offset:8192
s_sub_u32 s85, s75, 2211840
v_mfma_f32_16x16x32_bf16 v[176:179], v[208:211], a[64:67], v[176:179]
s_min_u32 s75, s75, s85
ds_read_b64_tr_b16 v[206:207], v237 offset:9216
v_cndmask_b32 v68, v41, 0, s[96:97]
v_mfma_f32_16x16x32_bf16 v[180:183], v[208:211], a[68:71], v[180:183]
ds_read_b64_tr_b16 v[208:209], v238 offset:8192
v_cndmask_b32 v84, 0, v41, s[96:97]
v_mfma_f32_16x16x32_bf16 v[184:187], v[212:215], a[64:67], v[184:187]
ds_read_b64_tr_b16 v[210:211], v238 offset:9216
v_cmp_gt_i32 s[96:97], 11, v40
v_mfma_f32_16x16x32_bf16 v[188:191], v[212:215], a[68:71], v[188:191]
s_waitcnt lgkmcnt(6)
ds_read_b64_tr_b16 v[212:213], v239 offset:8192
v_cndmask_b32 v69, v41, 0, s[98:99]
v_mfma_f32_16x16x32_bf16 v[128:131], v[224:227], a[72:75], v[128:131]
ds_read_b64_tr_b16 v[214:215], v239 offset:9216
v_cndmask_b32 v85, 0, v41, s[98:99]
v_mfma_f32_16x16x32_bf16 v[132:135], v[224:227], a[76:79], v[132:135]
s_waitcnt vmcnt(11)
s_barrier
v_cmp_gt_i32 s[98:99], 16, v40
v_mfma_f32_16x16x32_bf16 v[136:139], v[228:231], a[72:75], v[136:139]
ds_read_b64_tr_b16 v[216:217], v44 offset:0
ds_read_b64_tr_b16 v[218:219], v44 offset:1024
v_mfma_f32_16x16x32_bf16 v[140:143], v[228:231], a[76:79], v[140:143]
ds_read_b64_tr_b16 v[220:221], v45 offset:0
ds_read_b64_tr_b16 v[222:223], v45 offset:1024
v_mfma_f32_16x16x32_bf16 v[144:147], v[192:195], a[72:75], v[144:147]
ds_read_b64_tr_b16 v[224:225], v44 offset:8192
ds_read_b64_tr_b16 v[226:227], v44 offset:9216
v_mfma_f32_16x16x32_bf16 v[148:151], v[192:195], a[76:79], v[148:151]
s_add_u32 m0, s76, 49152
ds_read_b64_tr_b16 v[192:193], v46 offset:0
buffer_load_dwordx4 v14, s[32:35], s75 offen lds
v_mfma_f32_16x16x32_bf16 v[152:155], v[196:199], a[72:75], v[152:155]
ds_read_b64_tr_b16 v[194:195], v46 offset:1024
ds_read_b64_tr_b16 v[228:229], v45 offset:8192
v_mfma_f32_16x16x32_bf16 v[156:159], v[196:199], a[76:79], v[156:159]
s_waitcnt lgkmcnt(9)
ds_read_b64_tr_b16 v[196:197], v47 offset:0
ds_read_b64_tr_b16 v[230:231], v45 offset:9216
v_mfma_f32_16x16x32_bf16 v[160:163], v[200:203], a[72:75], v[160:163]
ds_read_b64_tr_b16 v[198:199], v47 offset:1024
v_cndmask_b32 v70, v41, 0, s[90:91]
v_mfma_f32_16x16x32_bf16 v[164:167], v[200:203], a[76:79], v[164:167]
ds_read_b64_tr_b16 v[200:201], v48 offset:0
v_cndmask_b32 v86, 0, v41, s[90:91]
v_mfma_f32_16x16x32_bf16 v[168:171], v[204:207], a[72:75], v[168:171]
s_add_u32 m0, s76, 50176
ds_read_b64_tr_b16 v[202:203], v48 offset:1024
buffer_load_dwordx4 v15, s[32:35], s75 offen lds
v_mfma_f32_16x16x32_bf16 v[172:175], v[204:207], a[76:79], v[172:175]
ds_read_b64_tr_b16 v[204:205], v49 offset:0
v_cmp_gt_i32 s[90:91], 17, v40
v_mfma_f32_16x16x32_bf16 v[176:179], v[208:211], a[72:75], v[176:179]
ds_read_b64_tr_b16 v[206:207], v49 offset:1024
v_cndmask_b32 v71, v41, 0, s[96:97]
v_mfma_f32_16x16x32_bf16 v[180:183], v[208:211], a[76:79], v[180:183]
ds_read_b64_tr_b16 v[208:209], v50 offset:0
v_cndmask_b32 v87, 0, v41, s[96:97]
v_mfma_f32_16x16x32_bf16 v[184:187], v[212:215], a[72:75], v[184:187]
ds_read_b64_tr_b16 v[210:211], v50 offset:1024
v_cmp_gt_i32 s[96:97], 18, v40
v_mfma_f32_16x16x32_bf16 v[188:191], v[212:215], a[76:79], v[188:191]
s_waitcnt lgkmcnt(6)
ds_read_b64_tr_b16 v[212:213], v51 offset:0
v_cndmask_b32 v72, v41, 0, s[98:99]
v_mfma_f32_16x16x32_bf16 v[128:131], v[216:219], a[80:83], v[128:131]
ds_read_b64_tr_b16 v[214:215], v51 offset:1024
v_cndmask_b32 v88, 0, v41, s[98:99]
v_mfma_f32_16x16x32_bf16 v[132:135], v[216:219], a[84:87], v[132:135]
v_mfma_f32_16x16x32_bf16 v[136:139], v[220:223], a[80:83], v[136:139]
s_add_u32 m0, s76, 51200
s_nop 0
buffer_load_dwordx4 v16, s[32:35], s75 offen lds
v_mfma_f32_16x16x32_bf16 v[140:143], v[220:223], a[84:87], v[140:143]
v_cmp_gt_i32 s[98:99], 19, v40
v_mfma_f32_16x16x32_bf16 v[144:147], v[192:195], a[80:83], v[144:147]
v_mfma_f32_16x16x32_bf16 v[148:151], v[192:195], a[84:87], v[148:151]
ds_read_b64_tr_b16 v[192:193], v46 offset:8192
v_cndmask_b32 v73, v41, 0, s[90:91]
v_mfma_f32_16x16x32_bf16 v[152:155], v[196:199], a[80:83], v[152:155]
ds_read_b64_tr_b16 v[194:195], v46 offset:9216
v_mfma_f32_16x16x32_bf16 v[156:159], v[196:199], a[84:87], v[156:159]
s_waitcnt lgkmcnt(2)
ds_read_b64_tr_b16 v[196:197], v47 offset:8192
v_mfma_f32_16x16x32_bf16 v[160:163], v[200:203], a[80:83], v[160:163]
ds_read_b64_tr_b16 v[198:199], v47 offset:9216
v_cndmask_b32 v89, 0, v41, s[90:91]
v_mfma_f32_16x16x32_bf16 v[164:167], v[200:203], a[84:87], v[164:167]
ds_read_b64_tr_b16 v[200:201], v48 offset:8192
v_mfma_f32_16x16x32_bf16 v[168:171], v[204:207], a[80:83], v[168:171]
s_add_u32 m0, s76, 52224
ds_read_b64_tr_b16 v[202:203], v48 offset:9216
buffer_load_dwordx4 v17, s[32:35], s75 offen lds
v_mfma_f32_16x16x32_bf16 v[172:175], v[204:207], a[84:87], v[172:175]
s_add_u32 s75, s75, 221184
ds_read_b64_tr_b16 v[204:205], v49 offset:8192
s_sub_u32 s85, s75, 2211840
v_mfma_f32_16x16x32_bf16 v[176:179], v[208:211], a[80:83], v[176:179]
s_min_u32 s75, s75, s85
ds_read_b64_tr_b16 v[206:207], v49 offset:9216
v_cmp_gt_i32 s[90:91], 24, v40
v_mfma_f32_16x16x32_bf16 v[180:183], v[208:211], a[84:87], v[180:183]
ds_read_b64_tr_b16 v[208:209], v50 offset:8192
v_cndmask_b32 v74, v41, 0, s[96:97]
v_mfma_f32_16x16x32_bf16 v[184:187], v[212:215], a[80:83], v[184:187]
ds_read_b64_tr_b16 v[210:211], v50 offset:9216
v_mfma_f32_16x16x32_bf16 v[188:191], v[212:215], a[84:87], v[188:191]
s_waitcnt lgkmcnt(6)
ds_read_b64_tr_b16 v[212:213], v51 offset:8192
v_cndmask_b32 v90, 0, v41, s[96:97]
v_mfma_f32_16x16x32_bf16 v[128:131], v[224:227], a[88:91], v[128:131]
ds_read_b64_tr_b16 v[214:215], v51 offset:9216
v_mfma_f32_16x16x32_bf16 v[132:135], v[224:227], a[92:95], v[132:135]
s_waitcnt vmcnt(10)
s_barrier
v_cmp_gt_i32 s[96:97], 25, v40
v_mfma_f32_16x16x32_bf16 v[136:139], v[228:231], a[88:91], v[136:139]
ds_read_b64_tr_b16 v[216:217], v44 offset:16384
ds_read_b64_tr_b16 v[218:219], v44 offset:17408
v_mfma_f32_16x16x32_bf16 v[140:143], v[228:231], a[92:95], v[140:143]
ds_read_b64_tr_b16 v[220:221], v45 offset:16384
ds_read_b64_tr_b16 v[222:223], v45 offset:17408
v_mfma_f32_16x16x32_bf16 v[144:147], v[192:195], a[88:91], v[144:147]
ds_read_b64_tr_b16 v[224:225], v44 offset:24576
ds_read_b64_tr_b16 v[226:227], v44 offset:25600
v_mfma_f32_16x16x32_bf16 v[148:151], v[192:195], a[92:95], v[148:151]
s_add_u32 m0, s76, 65536
ds_read_b64_tr_b16 v[192:193], v46 offset:16384
buffer_load_dwordx4 v14, s[32:35], s75 offen lds
v_mfma_f32_16x16x32_bf16 v[152:155], v[196:199], a[88:91], v[152:155]
ds_read_b64_tr_b16 v[194:195], v46 offset:17408
ds_read_b64_tr_b16 v[228:229], v45 offset:24576
v_mfma_f32_16x16x32_bf16 v[156:159], v[196:199], a[92:95], v[156:159]
s_waitcnt lgkmcnt(9)
ds_read_b64_tr_b16 v[196:197], v47 offset:16384
ds_read_b64_tr_b16 v[230:231], v45 offset:25600
v_mfma_f32_16x16x32_bf16 v[160:163], v[200:203], a[88:91], v[160:163]
ds_read_b64_tr_b16 v[198:199], v47 offset:17408
v_cndmask_b32 v75, v41, 0, s[98:99]
v_mfma_f32_16x16x32_bf16 v[164:167], v[200:203], a[92:95], v[164:167]
ds_read_b64_tr_b16 v[200:201], v48 offset:16384
v_cndmask_b32 v91, 0, v41, s[98:99]
v_mfma_f32_16x16x32_bf16 v[168:171], v[204:207], a[88:91], v[168:171]
s_add_u32 m0, s76, 66560
ds_read_b64_tr_b16 v[202:203], v48 offset:17408
buffer_load_dwordx4 v15, s[32:35], s75 offen lds
v_mfma_f32_16x16x32_bf16 v[172:175], v[204:207], a[92:95], v[172:175]
ds_read_b64_tr_b16 v[204:205], v49 offset:16384
v_mov_b32 v245, 0x3f80
v_mfma_f32_16x16x32_bf16 v[176:179], v[208:211], a[88:91], v[176:179]
ds_read_b64_tr_b16 v[206:207], v49 offset:17408
v_cmp_gt_i32 s[98:99], 26, v40
v_mfma_f32_16x16x32_bf16 v[180:183], v[208:211], a[92:95], v[180:183]
ds_read_b64_tr_b16 v[208:209], v50 offset:16384
v_cndmask_b32 v76, v41, 0, s[90:91]
s_waitcnt vmcnt(11)
v_cmp_ne_u32 vcc, s72, v26
s_nop 0
s_cbranch_vccnz L_retry_11
L_back_12:
v_mfma_f32_16x16x32_bf16 v[184:187], v[212:215], a[88:91], v[184:187]
ds_read_b64_tr_b16 v[210:211], v50 offset:17408
v_mov_b32 v246, 0x3f803f80
v_mfma_f32_16x16x32_bf16 v[188:191], v[212:215], a[92:95], v[188:191]
s_waitcnt lgkmcnt(6)
ds_read_b64_tr_b16 v[212:213], v51 offset:16384
v_cndmask_b32 v92, 0, v41, s[90:91]
v_mfma_f32_16x16x32_bf16 v[128:131], v[216:219], a[96:99], v[128:131]
ds_read_b64_tr_b16 v[214:215], v51 offset:17408
v_cmp_gt_i32 s[90:91], 27, v40
v_mfma_f32_16x16x32_bf16 v[132:135], v[216:219], a[100:103], v[132:135]
buffer_load_dwordx4 a[160:163], v57, s[48:51], s11 offen offset:0 sc1
v_cndmask_b32 v77, v41, 0, s[96:97]
v_mfma_f32_16x16x32_bf16 v[136:139], v[220:223], a[96:99], v[136:139]
s_add_u32 m0, s76, 67584
s_nop 0
buffer_load_dwordx4 v16, s[32:35], s75 offen lds
buffer_load_dwordx4 a[164:167], v57, s[48:51], s11 offen offset:1024 sc1
v_mfma_f32_16x16x32_bf16 v[140:143], v[220:223], a[100:103], v[140:143]
v_mov_b32 v247, 0x3f803f80
v_mfma_f32_16x16x32_bf16 v[144:147], v[192:195], a[96:99], v[144:147]
v_cndmask_b32 v93, 0, v41, s[96:97]
v_mfma_f32_16x16x32_bf16 v[148:151], v[192:195], a[100:103], v[148:151]
ds_read_b64_tr_b16 v[192:193], v46 offset:24576
buffer_load_dwordx4 a[168:171], v57, s[48:51], s11 offen offset:2048 sc1
v_mfma_f32_16x16x32_bf16 v[152:155], v[196:199], a[96:99], v[152:155]
ds_read_b64_tr_b16 v[194:195], v46 offset:25600
v_cndmask_b32 v78, v41, 0, s[98:99]
v_mfma_f32_16x16x32_bf16 v[156:159], v[196:199], a[100:103], v[156:159]
s_waitcnt lgkmcnt(2)
ds_read_b64_tr_b16 v[196:197], v47 offset:24576
s_add_u32 s88, s7, 87040
v_mfma_f32_16x16x32_bf16 v[160:163], v[200:203], a[96:99], v[160:163]
ds_read_b64_tr_b16 v[198:199], v47 offset:25600
v_cndmask_b32 v94, 0, v41, s[98:99]
v_mfma_f32_16x16x32_bf16 v[164:167], v[200:203], a[100:103], v[164:167]
ds_read_b64_tr_b16 v[200:201], v48 offset:24576
buffer_load_dwordx4 a[172:175], v57, s[48:51], s11 offen offset:3072 sc1
v_mfma_f32_16x16x32_bf16 v[168:171], v[204:207], a[96:99], v[168:171]
s_add_u32 m0, s76, 68608
ds_read_b64_tr_b16 v[202:203], v48 offset:25600
buffer_load_dwordx4 v17, s[32:35], s75 offen lds
v_mfma_f32_16x16x32_bf16 v[172:175], v[204:207], a[100:103], v[172:175]
ds_read_b64_tr_b16 v[204:205], v49 offset:24576
v_cndmask_b32 v79, v41, 0, s[90:91]
v_mfma_f32_16x16x32_bf16 v[176:179], v[208:211], a[96:99], v[176:179]
ds_read_b64_tr_b16 v[206:207], v49 offset:25600
v_lshl_add_u32 v25, v20, 4, s88
v_mfma_f32_16x16x32_bf16 v[180:183], v[208:211], a[100:103], v[180:183]
ds_read_b64_tr_b16 v[208:209], v50 offset:24576
v_cndmask_b32 v95, 0, v41, s[90:91]
v_mfma_f32_16x16x32_bf16 v[184:187], v[212:215], a[96:99], v[184:187]
ds_read_b64_tr_b16 v[210:211], v50 offset:25600
buffer_load_dwordx4 a[176:179], v19, s[48:51], s11 offen sc1
s_add_u32 s11, s11, 20480
v_mfma_f32_16x16x32_bf16 v[188:191], v[212:215], a[100:103], v[188:191]
s_waitcnt lgkmcnt(6)
ds_read_b64_tr_b16 v[212:213], v51 offset:24576
v_mfma_f32_16x16x32_bf16 v[128:131], v[224:227], a[104:107], v[128:131]
ds_read_b64_tr_b16 v[214:215], v51 offset:25600
s_cmp_ge_u32 s87, 8
s_cselect_b32 s88, 0x3f800000, 0x3f80f149
v_mfma_f32_16x16x32_bf16 v[132:135], v[224:227], a[108:111], v[132:135]
s_waitcnt vmcnt(13)
s_barrier
v_mfma_f32_16x16x32_bf16 v[136:139], v[228:231], a[104:107], v[136:139]
ds_read_b64_tr_b16 v[216:217], v44 offset:32768
ds_read_b64_tr_b16 v[218:219], v44 offset:33792
v_mfma_f32_16x16x32_bf16 v[140:143], v[228:231], a[108:111], v[140:143]
ds_read_b64_tr_b16 v[220:221], v45 offset:32768
ds_read_b64_tr_b16 v[222:223], v45 offset:33792
v_mfma_f32_16x16x32_bf16 v[144:147], v[192:195], a[104:107], v[144:147]
ds_read_b64_tr_b16 v[224:225], v44 offset:40960
ds_read_b64_tr_b16 v[226:227], v44 offset:41984
v_mfma_f32_16x16x32_bf16 v[148:151], v[192:195], a[108:111], v[148:151]
ds_read_b64_tr_b16 v[192:193], v46 offset:32768
v_mov_b32 v244, s88
v_mfma_f32_16x16x32_bf16 v[152:155], v[196:199], a[104:107], v[152:155]
ds_read_b64_tr_b16 v[194:195], v46 offset:33792
ds_read_b64_tr_b16 v[228:229], v45 offset:40960
v_mfma_f32_16x16x32_bf16 v[156:159], v[196:199], a[108:111], v[156:159]
s_waitcnt lgkmcnt(9)
ds_read_b64_tr_b16 v[196:197], v47 offset:32768
ds_read_b64_tr_b16 v[230:231], v45 offset:41984
v_mfma_f32_16x16x32_bf16 v[160:163], v[200:203], a[104:107], v[160:163]
ds_read_b64_tr_b16 v[198:199], v47 offset:33792
buffer_load_dwordx4 a[180:183], v57, s[48:51], s11 offen offset:0 sc1
v_mfma_f32_16x16x32_bf16 v[164:167], v[200:203], a[108:111], v[164:167]
ds_read_b64_tr_b16 v[200:201], v48 offset:32768
buffer_load_dwordx4 a[184:187], v57, s[48:51], s11 offen offset:1024 sc1
v_mfma_f32_16x16x32_bf16 v[168:171], v[204:207], a[104:107], v[168:171]
ds_read_b64_tr_b16 v[202:203], v48 offset:33792
ds_write_b128 v25, v[244:247] offset:0
v_mfma_f32_16x16x32_bf16 v[172:175], v[204:207], a[108:111], v[172:175]
ds_read_b64_tr_b16 v[204:205], v49 offset:32768
buffer_load_dwordx4 a[188:191], v57, s[48:51], s11 offen offset:2048 sc1
v_mfma_f32_16x16x32_bf16 v[176:179], v[208:211], a[104:107], v[176:179]
ds_read_b64_tr_b16 v[206:207], v49 offset:33792
buffer_load_dwordx4 a[192:195], v57, s[48:51], s11 offen offset:3072 sc1
v_mfma_f32_16x16x32_bf16 v[180:183], v[208:211], a[108:111], v[180:183]
ds_read_b64_tr_b16 v[208:209], v50 offset:32768
v_mfma_f32_16x16x32_bf16 v[184:187], v[212:215], a[104:107], v[184:187]
ds_read_b64_tr_b16 v[210:211], v50 offset:33792
v_mfma_f32_16x16x32_bf16 v[188:191], v[212:215], a[108:111], v[188:191]
s_waitcnt lgkmcnt(7)
ds_read_b64_tr_b16 v[212:213], v51 offset:32768
v_mfma_f32_16x16x32_bf16 v[128:131], v[216:219], a[112:115], v[128:131]
ds_read_b64_tr_b16 v[214:215], v51 offset:33792
v_mfma_f32_16x16x32_bf16 v[132:135], v[216:219], a[116:119], v[132:135]
s_cmp_ge_u32 s87, 7
s_cselect_b32 s88, 0x3f800000, 0x3f80f149
v_mfma_f32_16x16x32_bf16 v[136:139], v[220:223], a[112:115], v[136:139]
buffer_load_dwordx4 a[196:199], v19, s[48:51], s11 offen sc1
s_add_u32 s11, s11, 20480
v_mfma_f32_16x16x32_bf16 v[140:143], v[220:223], a[116:119], v[140:143]
buffer_load_dwordx4 a[200:203], v57, s[48:51], s11 offen offset:0 sc1
v_mov_b32 v244, s88
v_mfma_f32_16x16x32_bf16 v[144:147], v[192:195], a[112:115], v[144:147]
v_mfma_f32_16x16x32_bf16 v[148:151], v[192:195], a[116:119], v[148:151]
ds_read_b64_tr_b16 v[192:193], v46 offset:40960
v_mfma_f32_16x16x32_bf16 v[152:155], v[196:199], a[112:115], v[152:155]
ds_read_b64_tr_b16 v[194:195], v46 offset:41984
v_mfma_f32_16x16x32_bf16 v[156:159], v[196:199], a[116:119], v[156:159]
s_waitcnt lgkmcnt(2)
ds_read_b64_tr_b16 v[196:197], v47 offset:40960
ds_write_b128 v25, v[244:247] offset:5632
v_mfma_f32_16x16x32_bf16 v[160:163], v[200:203], a[112:115], v[160:163]
ds_read_b64_tr_b16 v[198:199], v47 offset:41984
buffer_load_dwordx4 a[204:207], v57, s[48:51], s11 offen offset:1024 sc1
v_mfma_f32_16x16x32_bf16 v[164:167], v[200:203], a[116:119], v[164:167]
ds_read_b64_tr_b16 v[200:201], v48 offset:40960
v_mfma_f32_16x16x32_bf16 v[168:171], v[204:207], a[112:115], v[168:171]
ds_read_b64_tr_b16 v[202:203], v48 offset:41984
buffer_load_dwordx4 a[208:211], v57, s[48:51], s11 offen offset:2048 sc1
v_mfma_f32_16x16x32_bf16 v[172:175], v[204:207], a[116:119], v[172:175]
ds_read_b64_tr_b16 v[204:205], v49 offset:40960
v_mfma_f32_16x16x32_bf16 v[176:179], v[208:211], a[112:115], v[176:179]
ds_read_b64_tr_b16 v[206:207], v49 offset:41984
s_cmp_ge_u32 s87, 6
s_cselect_b32 s88, 0x3f800000, 0x3f80f149
v_mfma_f32_16x16x32_bf16 v[180:183], v[208:211], a[116:119], v[180:183]
ds_read_b64_tr_b16 v[208:209], v50 offset:40960
v_mfma_f32_16x16x32_bf16 v[184:187], v[212:215], a[112:115], v[184:187]
ds_read_b64_tr_b16 v[210:211], v50 offset:41984
buffer_load_dwordx4 a[212:215], v57, s[48:51], s11 offen offset:3072 sc1
v_mfma_f32_16x16x32_bf16 v[188:191], v[212:215], a[116:119], v[188:191]
s_waitcnt lgkmcnt(6)
ds_read_b64_tr_b16 v[212:213], v51 offset:40960
v_mfma_f32_16x16x32_bf16 v[128:131], v[224:227], a[120:123], v[128:131]
ds_read_b64_tr_b16 v[214:215], v51 offset:41984
v_mov_b32 v244, s88
v_mfma_f32_16x16x32_bf16 v[132:135], v[224:227], a[124:127], v[132:135]
s_waitcnt vmcnt(18)
s_barrier
v_mfma_f32_16x16x32_bf16 v[136:139], v[228:231], a[120:123], v[136:139]
ds_read_b64_tr_b16 v[216:217], v44 offset:49152
ds_read_b64_tr_b16 v[218:219], v44 offset:50176
v_mfma_f32_16x16x32_bf16 v[140:143], v[228:231], a[124:127], v[140:143]
ds_read_b64_tr_b16 v[220:221], v45 offset:49152
ds_read_b64_tr_b16 v[222:223], v45 offset:50176
v_mfma_f32_16x16x32_bf16 v[144:147], v[192:195], a[120:123], v[144:147]
s_add_u32 s21, s21, 163840
ds_read_b64_tr_b16 v[224:225], v44 offset:57344
ds_read_b64_tr_b16 v[226:227], v44 offset:58368
v_mfma_f32_16x16x32_bf16 v[148:151], v[192:195], a[124:127], v[148:151]
ds_read_b64_tr_b16 v[192:193], v46 offset:49152
buffer_load_dword v112, v60, s[52:55], s21 offen offset:0 sc1
v_mfma_f32_16x16x32_bf16 v[152:155], v[196:199], a[120:123], v[152:155]
ds_read_b64_tr_b16 v[194:195], v46 offset:50176
ds_read_b64_tr_b16 v[228:229], v45 offset:57344
v_mfma_f32_16x16x32_bf16 v[156:159], v[196:199], a[124:127], v[156:159]
s_waitcnt lgkmcnt(9)
ds_read_b64_tr_b16 v[196:197], v47 offset:49152
ds_read_b64_tr_b16 v[230:231], v45 offset:58368
v_mfma_f32_16x16x32_bf16 v[160:163], v[200:203], a[120:123], v[160:163]
ds_read_b64_tr_b16 v[198:199], v47 offset:50176
buffer_load_dword v113, v60, s[52:55], s21 offen offset:256 sc1
v_mfma_f32_16x16x32_bf16 v[164:167], v[200:203], a[124:127], v[164:167]
ds_read_b64_tr_b16 v[200:201], v48 offset:49152
buffer_load_dword v114, v60, s[52:55], s21 offen offset:512 sc1
ds_write_b128 v25, v[244:247] offset:11264
v_mfma_f32_16x16x32_bf16 v[168:171], v[204:207], a[120:123], v[168:171]
ds_read_b64_tr_b16 v[202:203], v48 offset:50176
buffer_load_dwordx4 a[216:219], v19, s[48:51], s11 offen sc1
s_add_u32 s11, s11, 20480
v_mfma_f32_16x16x32_bf16 v[172:175], v[204:207], a[124:127], v[172:175]
ds_read_b64_tr_b16 v[204:205], v49 offset:49152
buffer_load_dword v115, v60, s[52:55], s21 offen offset:768 sc1
buffer_load_dword v63, v62, s[52:55], 0 offen sc1
v_mfma_f32_16x16x32_bf16 v[176:179], v[208:211], a[120:123], v[176:179]
ds_read_b64_tr_b16 v[206:207], v49 offset:50176
v_mfma_f32_16x16x32_bf16 v[180:183], v[208:211], a[124:127], v[180:183]
ds_read_b64_tr_b16 v[208:209], v50 offset:49152
buffer_load_dword v116, v60, s[52:55], s21 offen offset:1024 sc1
v_mfma_f32_16x16x32_bf16 v[184:187], v[212:215], a[120:123], v[184:187]
ds_read_b64_tr_b16 v[210:211], v50 offset:50176
buffer_load_dword v117, v60, s[52:55], s21 offen offset:1280 sc1
v_mfma_f32_16x16x32_bf16 v[188:191], v[212:215], a[124:127], v[188:191]
s_waitcnt lgkmcnt(7)
ds_read_b64_tr_b16 v[212:213], v51 offset:49152
buffer_load_dwordx4 a[220:223], v57, s[48:51], s11 offen offset:0 sc1
v_mfma_f32_16x16x32_bf16 v[128:131], v[216:219], a[128:131], v[128:131]
ds_read_b64_tr_b16 v[214:215], v51 offset:50176
buffer_load_dword v118, v60, s[52:55], s21 offen offset:1536 sc1
v_mfma_f32_16x16x32_bf16 v[132:135], v[216:219], a[132:135], v[132:135]
buffer_load_dwordx4 a[224:227], v57, s[48:51], s11 offen offset:1024 sc1
buffer_load_dwordx4 a[228:231], v57, s[48:51], s11 offen offset:2048 sc1
v_mfma_f32_16x16x32_bf16 v[136:139], v[220:223], a[128:131], v[136:139]
buffer_load_dword v119, v60, s[52:55], s21 offen offset:1792 sc1
buffer_load_dwordx4 a[232:235], v57, s[48:51], s11 offen offset:3072 sc1
v_mfma_f32_16x16x32_bf16 v[140:143], v[220:223], a[132:135], v[140:143]
v_mfma_f32_16x16x32_bf16 v[144:147], v[192:195], a[128:131], v[144:147]
buffer_load_dword v120, v60, s[52:55], s21 offen offset:2048 sc1
s_waitcnt vmcnt(9)
v_cmp_ne_u32 vcc, s72, v63
s_nop 0
s_cbranch_vccnz L_retry_13
L_back_14:
v_mfma_f32_16x16x32_bf16 v[148:151], v[192:195], a[132:135], v[148:151]
ds_read_b64_tr_b16 v[192:193], v46 offset:57344
buffer_load_dwordx4 a[236:239], v19, s[48:51], s11 offen sc1
s_add_u32 s11, s11, 20480
v_mfma_f32_16x16x32_bf16 v[152:155], v[196:199], a[128:131], v[152:155]
ds_read_b64_tr_b16 v[194:195], v46 offset:58368
buffer_load_dword v121, v60, s[52:55], s21 offen offset:2304 sc1
v_mfma_f32_16x16x32_bf16 v[156:159], v[196:199], a[132:135], v[156:159]
s_waitcnt lgkmcnt(2)
ds_read_b64_tr_b16 v[196:197], v47 offset:57344
v_mfma_f32_16x16x32_bf16 v[160:163], v[200:203], a[128:131], v[160:163]
ds_read_b64_tr_b16 v[198:199], v47 offset:58368
buffer_load_dwordx4 a[240:243], v57, s[48:51], s11 offen offset:0 sc1
v_mfma_f32_16x16x32_bf16 v[164:167], v[200:203], a[132:135], v[164:167]
s_add_u32 s88, s8, 2621440
ds_read_b64_tr_b16 v[200:201], v48 offset:57344
v_accvgpr_read_b32 v14, a252
v_mfma_f32_16x16x32_bf16 v[168:171], v[204:207], a[128:131], v[168:171]
s_add_u32 m0, s7, 81920
ds_read_b64_tr_b16 v[202:203], v48 offset:58368
buffer_load_dwordx4 v10, s[36:39], s88 offen sc1 lds
v_mfma_f32_16x16x32_bf16 v[172:175], v[204:207], a[132:135], v[172:175]
s_add_u32 s88, s8, 2686976
ds_read_b64_tr_b16 v[204:205], v49 offset:57344
v_accvgpr_read_b32 v15, a253
v_mfma_f32_16x16x32_bf16 v[176:179], v[208:211], a[128:131], v[176:179]
ds_read_b64_tr_b16 v[206:207], v49 offset:58368
buffer_load_dwordx4 a[244:247], v57, s[48:51], s11 offen offset:1024 sc1
v_mfma_f32_16x16x32_bf16 v[180:183], v[208:211], a[132:135], v[180:183]
s_add_u32 m0, s7, 82944
ds_read_b64_tr_b16 v[208:209], v50 offset:57344
buffer_load_dwordx4 v10, s[36:39], s88 offen sc1 lds
v_mfma_f32_16x16x32_bf16 v[184:187], v[212:215], a[128:131], v[184:187]
ds_read_b64_tr_b16 v[210:211], v50 offset:58368
v_accvgpr_read_b32 v16, a254
v_mfma_f32_16x16x32_bf16 v[188:191], v[212:215], a[132:135], v[188:191]
s_waitcnt lgkmcnt(6)
ds_read_b64_tr_b16 v[212:213], v51 offset:57344
v_accvgpr_read_b32 v17, a255
v_mfma_f32_16x16x32_bf16 v[128:131], v[224:227], a[136:139], v[128:131]
ds_read_b64_tr_b16 v[214:215], v51 offset:58368
buffer_load_dwordx4 a[248:251], v57, s[48:51], s11 offen offset:2048 sc1
v_mfma_f32_16x16x32_bf16 v[132:135], v[224:227], a[140:143], v[132:135]
s_barrier
s_add_u32 s88, s8, 2752512
v_mfma_f32_16x16x32_bf16 v[136:139], v[228:231], a[136:139], v[136:139]
ds_read_b64_tr_b16 v[216:217], v232 offset:0
ds_read_b64_tr_b16 v[218:219], v232 offset:1024
v_mfma_f32_16x16x32_bf16 v[140:143], v[228:231], a[140:143], v[140:143]
ds_read_b64_tr_b16 v[220:221], v233 offset:0
ds_read_b64_tr_b16 v[222:223], v233 offset:1024
v_mfma_f32_16x16x32_bf16 v[144:147], v[192:195], a[136:139], v[144:147]
ds_read_b64_tr_b16 v[224:225], v232 offset:8192
ds_read_b64_tr_b16 v[226:227], v232 offset:9216
v_mfma_f32_16x16x32_bf16 v[148:151], v[192:195], a[140:143], v[148:151]
ds_read_b64_tr_b16 v[192:193], v234 offset:0
v_min3_u32 v250, v112, v113, s72
v_mfma_f32_16x16x32_bf16 v[152:155], v[196:199], a[136:139], v[152:155]
ds_read_b64_tr_b16 v[194:195], v234 offset:1024
ds_read_b64_tr_b16 v[228:229], v233 offset:8192
v_mfma_f32_16x16x32_bf16 v[156:159], v[196:199], a[140:143], v[156:159]
s_waitcnt lgkmcnt(9)
ds_read_b64_tr_b16 v[196:197], v235 offset:0
ds_read_b64_tr_b16 v[230:231], v233 offset:9216
v_mfma_f32_16x16x32_bf16 v[160:163], v[200:203], a[136:139], v[160:163]
ds_read_b64_tr_b16 v[198:199], v235 offset:1024
v_max3_u32 v251, v112, v113, s72
v_mfma_f32_16x16x32_bf16 v[164:167], v[200:203], a[140:143], v[164:167]
ds_read_b64_tr_b16 v[200:201], v236 offset:0
v_min3_u32 v250, v250, v114, v115
v_mfma_f32_16x16x32_bf16 v[168:171], v[204:207], a[136:139], v[168:171]
ds_read_b64_tr_b16 v[202:203], v236 offset:1024
v_max3_u32 v251, v251, v114, v115
v_mfma_f32_16x16x32_bf16 v[172:175], v[204:207], a[140:143], v[172:175]
ds_read_b64_tr_b16 v[204:205], v237 offset:0
s_waitcnt vmcnt(14)
v_min3_u32 v250, v250, v116, v117
v_mfma_f32_16x16x32_bf16 v[176:179], v[208:211], a[136:139], v[176:179]
ds_read_b64_tr_b16 v[206:207], v237 offset:1024
v_max3_u32 v251, v251, v116, v117
v_mfma_f32_16x16x32_bf16 v[180:183], v[208:211], a[140:143], v[180:183]
ds_read_b64_tr_b16 v[208:209], v238 offset:0
s_waitcnt vmcnt(9)
v_min3_u32 v250, v250, v118, v119
v_mfma_f32_16x16x32_bf16 v[184:187], v[212:215], a[136:139], v[184:187]
ds_read_b64_tr_b16 v[210:211], v238 offset:1024
v_max3_u32 v251, v251, v118, v119
v_mfma_f32_16x16x32_bf16 v[188:191], v[212:215], a[140:143], v[188:191]
s_waitcnt lgkmcnt(6)
ds_read_b64_tr_b16 v[212:213], v239 offset:0
s_waitcnt vmcnt(5)
v_min3_u32 v250, v250, v120, v121
v_mfma_f32_16x16x32_bf16 v[128:131], v[216:219], a[144:147], v[128:131]
ds_read_b64_tr_b16 v[214:215], v239 offset:1024
v_max3_u32 v251, v251, v120, v121
v_mfma_f32_16x16x32_bf16 v[132:135], v[216:219], a[148:151], v[132:135]
v_cmp_ne_u32 vcc, v250, v251
s_nop 0
s_and_b64 vcc, vcc, s[100:101]
s_cbranch_vccnz L_retry_6
L_back_7:
v_mfma_f32_16x16x32_bf16 v[136:139], v[220:223], a[144:147], v[136:139]
v_add_f32 v112, v112, v117
v_mfma_f32_16x16x32_bf16 v[140:143], v[220:223], a[148:151], v[140:143]
v_add_f32 v113, v113, v118
v_add_f32 v114, v114, v119
v_mfma_f32_16x16x32_bf16 v[144:147], v[192:195], a[144:147], v[144:147]
v_add_f32 v115, v115, v120
v_add_f32 v116, v116, v121
v_mfma_f32_16x16x32_bf16 v[148:151], v[192:195], a[148:151], v[148:151]
ds_read_b64_tr_b16 v[192:193], v234 offset:8192
v_add_f32 v112, v112, v113
v_mfma_f32_16x16x32_bf16 v[152:155], v[196:199], a[144:147], v[152:155]
ds_read_b64_tr_b16 v[194:195], v234 offset:9216
v_add_f32 v114, v114, v115
v_mfma_f32_16x16x32_bf16 v[156:159], v[196:199], a[148:151], v[156:159]
s_waitcnt lgkmcnt(2)
ds_read_b64_tr_b16 v[196:197], v235 offset:8192
v_add_f32 v112, v112, v116
v_mfma_f32_16x16x32_bf16 v[160:163], v[200:203], a[144:147], v[160:163]
ds_read_b64_tr_b16 v[198:199], v235 offset:9216
v_add_u32 v38, 0, v43
v_mfma_f32_16x16x32_bf16 v[164:167], v[200:203], a[148:151], v[164:167]
ds_read_b64_tr_b16 v[200:201], v236 offset:8192
v_add_f32 v112, v112, v114
v_mfma_f32_16x16x32_bf16 v[168:171], v[204:207], a[144:147], v[168:171]
ds_read_b64_tr_b16 v[202:203], v236 offset:9216
v_and_b32 v114, 1, v0
v_mfma_f32_16x16x32_bf16 v[172:175], v[204:207], a[148:151], v[172:175]
ds_read_b64_tr_b16 v[204:205], v237 offset:8192
v_mul_u32_u24 v114, 508, v114
v_mfma_f32_16x16x32_bf16 v[176:179], v[208:211], a[144:147], v[176:179]
ds_read_b64_tr_b16 v[206:207], v237 offset:9216
v_cvt_pk_bf16_f32 v113, v112, v112
v_mfma_f32_16x16x32_bf16 v[180:183], v[208:211], a[148:151], v[180:183]
ds_read_b64_tr_b16 v[208:209], v238 offset:8192
v_add3_u32 v114, v114, v60, s76
v_mfma_f32_16x16x32_bf16 v[184:187], v[212:215], a[144:147], v[184:187]
ds_read_b64_tr_b16 v[210:211], v238 offset:9216
v_and_b32 v113, 0xffff0000, v113
v_mfma_f32_16x16x32_bf16 v[188:191], v[212:215], a[148:151], v[188:191]
s_waitcnt lgkmcnt(6)
ds_read_b64_tr_b16 v[212:213], v239 offset:8192
v_xor_b32 v39, 0x1000, v38
v_sub_f32 v113, v112, v113
v_xor_b32 v250, 0x2000, v38
v_cvt_pk_bf16_f32 v112, v112, v113
v_mov_b32 v113, 0
v_xor_b32 v251, 0x3000, v38
v_add_u32 v114, 0, v114
ds_write_b64 v114, v[112:113]
v_mfma_f32_16x16x32_bf16 v[128:131], v[224:227], a[152:155], v[128:131]
s_add_u32 m0, s7, 83968
ds_read_b64_tr_b16 v[214:215], v239 offset:9216
buffer_load_dwordx4 v11, s[36:39], s88 offen sc1 lds
v_mfma_f32_16x16x32_bf16 v[132:135], v[224:227], a[156:159], v[132:135]
s_waitcnt lgkmcnt(1)
s_barrier
s_add_u32 s88, s9, 2621440
v_mfma_f32_16x16x32_bf16 v[136:139], v[228:231], a[152:155], v[136:139]
ds_read_b64 v[112:113], v38 offset:0
ds_read_b64 v[114:115], v38 offset:128
v_mfma_f32_16x16x32_bf16 v[140:143], v[228:231], a[156:159], v[140:143]
ds_read_b64 v[116:117], v39 offset:0
ds_read_b64 v[118:119], v39 offset:128
v_mfma_f32_16x16x32_bf16 v[144:147], v[192:195], a[152:155], v[144:147]
ds_read_b64 v[120:121], v250 offset:0
ds_read_b64 v[122:123], v250 offset:128
v_mfma_f32_16x16x32_bf16 v[148:151], v[192:195], a[156:159], v[148:151]
ds_read_b64 v[124:125], v251 offset:0
ds_read_b64 v[126:127], v251 offset:128
v_mfma_f32_16x16x32_bf16 v[152:155], v[196:199], a[152:155], v[152:155]
s_add_u32 m0, s7, 87552
s_nop 0
buffer_load_dwordx4 v10, s[36:39], s88 offen sc1 lds
s_add_u32 s88, s9, 2686976
v_mfma_f32_16x16x32_bf16 v[156:159], v[196:199], a[156:159], v[156:159]
s_waitcnt lgkmcnt(8)
v_mfma_f32_16x16x32_bf16 v[160:163], v[200:203], a[152:155], v[160:163]
s_add_u32 m0, s7, 88576
s_nop 0
buffer_load_dwordx4 v10, s[36:39], s88 offen sc1 lds
s_add_u32 s88, s9, 2752512
s_waitcnt lgkmcnt(7)
v_mfma_f32_16x16x16bf16_1k v[128:131], v[112:113], v[52:53], v[128:131]
v_mfma_f32_16x16x32_bf16 v[164:167], v[200:203], a[156:159], v[164:167]
s_add_u32 m0, s7, 89600
s_nop 0
buffer_load_dwordx4 v11, s[36:39], s88 offen sc1 lds
s_add_u32 s88, s10, 2621440
v_mfma_f32_16x16x16bf16_1k v[132:135], v[112:113], v[28:29], v[132:135]
v_mfma_f32_16x16x32_bf16 v[168:171], v[204:207], a[152:155], v[168:171]
s_add_u32 m0, s7, 93184
s_nop 0
buffer_load_dwordx4 v10, s[36:39], s88 offen sc1 lds
s_add_u32 s88, s10, 2686976
s_waitcnt lgkmcnt(6)
v_mfma_f32_16x16x16bf16_1k v[136:139], v[114:115], v[52:53], v[136:139]
v_mfma_f32_16x16x32_bf16 v[172:175], v[204:207], a[156:159], v[172:175]
s_add_u32 m0, s7, 94208
s_nop 0
buffer_load_dwordx4 v10, s[36:39], s88 offen sc1 lds
s_add_u32 s88, s10, 2752512
v_mfma_f32_16x16x16bf16_1k v[140:143], v[114:115], v[28:29], v[140:143]
v_mfma_f32_16x16x32_bf16 v[176:179], v[208:211], a[152:155], v[176:179]
s_add_u32 m0, s7, 95232
s_nop 0
buffer_load_dwordx4 v11, s[36:39], s88 offen sc1 lds
buffer_load_dwordx4 v[96:99], v9, s[36:39], s6 offen sc1
s_waitcnt lgkmcnt(5)
v_mfma_f32_16x16x16bf16_1k v[144:147], v[116:117], v[52:53], v[144:147]
v_mfma_f32_16x16x32_bf16 v[180:183], v[208:211], a[156:159], v[180:183]
s_add_u32 s88, s6, 98304
buffer_load_dwordx4 v[100:103], v9, s[36:39], s88 offen sc1
s_add_u32 s88, s6, 65536
v_mfma_f32_16x16x16bf16_1k v[148:151], v[116:117], v[28:29], v[148:151]
v_mfma_f32_16x16x32_bf16 v[184:187], v[212:215], a[152:155], v[184:187]
buffer_load_dwordx4 v[104:107], v9, s[36:39], s88 offen sc1
s_waitcnt lgkmcnt(4)
v_mfma_f32_16x16x16bf16_1k v[152:155], v[118:119], v[52:53], v[152:155]
v_mfma_f32_16x16x32_bf16 v[188:191], v[212:215], a[156:159], v[188:191]
v_mfma_f32_16x16x16bf16_1k v[156:159], v[118:119], v[28:29], v[156:159]
L_join:
s_waitcnt lgkmcnt(3)
v_mfma_f32_16x16x16bf16_1k v[160:163], v[120:121], v[52:53], v[160:163]
v_mfma_f32_16x16x16bf16_1k v[164:167], v[120:121], v[28:29], v[164:167]
s_add_u32 m0, s7, 84992
s_add_u32 s88, s8, 5275648
buffer_load_dwordx4 v12, s[36:39], s88 offen sc1 lds
s_waitcnt lgkmcnt(2)
v_mfma_f32_16x16x16bf16_1k v[168:171], v[122:123], v[52:53], v[168:171]
v_mfma_f32_16x16x16bf16_1k v[172:175], v[122:123], v[28:29], v[172:175]
s_add_u32 m0, s7, 86016
s_add_u32 s88, s8, 5341184
buffer_load_dwordx4 v13, s[36:39], s88 offen sc1 lds
s_waitcnt lgkmcnt(1)
v_mfma_f32_16x16x16bf16_1k v[176:179], v[124:125], v[52:53], v[176:179]
v_mfma_f32_16x16x16bf16_1k v[180:183], v[124:125], v[28:29], v[180:183]
s_add_u32 m0, s7, 90624
s_add_u32 s88, s9, 5275648
buffer_load_dwordx4 v12, s[36:39], s88 offen sc1 lds
s_waitcnt lgkmcnt(0)
v_mfma_f32_16x16x16bf16_1k v[184:187], v[126:127], v[52:53], v[184:187]
v_mfma_f32_16x16x16bf16_1k v[188:191], v[126:127], v[28:29], v[188:191]
s_add_u32 m0, s7, 91648
s_add_u32 s88, s9, 5341184
buffer_load_dwordx4 v13, s[36:39], s88 offen sc1 lds
v_pk_mul_f32 v[128:129], v[128:129], v[54:55] op_sel_hi:[1,0]
v_pk_mul_f32 v[130:131], v[130:131], v[54:55] op_sel_hi:[1,0]
v_pk_mul_f32 v[132:133], v[132:133], v[30:31] op_sel_hi:[1,0]
v_pk_mul_f32 v[134:135], v[134:135], v[30:31] op_sel_hi:[1,0]
v_cvt_pk_bf16_f32 v128, v128, v129
v_cvt_pk_bf16_f32 v129, v130, v131
v_cvt_pk_bf16_f32 v130, v132, v133
v_cvt_pk_bf16_f32 v131, v134, v135
v_pk_max_i16 v128, v128, 0
v_pk_max_i16 v129, v129, 0
v_pk_max_i16 v130, v130, 0
v_pk_max_i16 v131, v131, 0
v_pk_mul_f32 v[136:137], v[136:137], v[54:55] op_sel_hi:[1,0]
v_pk_mul_f32 v[138:139], v[138:139], v[54:55] op_sel_hi:[1,0]
v_pk_mul_f32 v[140:141], v[140:141], v[30:31] op_sel_hi:[1,0]
v_pk_mul_f32 v[142:143], v[142:143], v[30:31] op_sel_hi:[1,0]
v_cvt_pk_bf16_f32 v132, v136, v137
v_cvt_pk_bf16_f32 v133, v138, v139
v_cvt_pk_bf16_f32 v134, v140, v141
v_cvt_pk_bf16_f32 v135, v142, v143
v_pk_max_i16 v132, v132, 0
v_pk_max_i16 v133, v133, 0
v_pk_max_i16 v134, v134, 0
v_pk_max_i16 v135, v135, 0
v_permlane16_swap_b32 v128, v130
v_permlane16_swap_b32 v129, v131
buffer_store_dwordx4 v[128:131], v42, s[40:43], s92 offen sc1
s_add_u32 m0, s7, 96256
s_add_u32 s88, s10, 5275648
buffer_load_dwordx4 v12, s[36:39], s88 offen sc1 lds
v_pk_mul_f32 v[144:145], v[144:145], v[54:55] op_sel_hi:[1,0]
v_pk_mul_f32 v[146:147], v[146:147], v[54:55] op_sel_hi:[1,0]
v_pk_mul_f32 v[148:149], v[148:149], v[30:31] op_sel_hi:[1,0]
v_pk_mul_f32 v[150:151], v[150:151], v[30:31] op_sel_hi:[1,0]
v_cvt_pk_bf16_f32 v136, v144, v145
v_cvt_pk_bf16_f32 v137, v146, v147
v_cvt_pk_bf16_f32 v138, v148, v149
v_cvt_pk_bf16_f32 v139, v150, v151
v_pk_max_i16 v136, v136, 0
v_pk_max_i16 v137, v137, 0
v_pk_max_i16 v138, v138, 0
v_pk_max_i16 v139, v139, 0
v_permlane16_swap_b32 v132, v134
v_permlane16_swap_b32 v133, v135
buffer_store_dwordx4 v[132:135], v61, s[40:43], s92 offen sc1
v_pk_mul_f32 v[152:153], v[152:153], v[54:55] op_sel_hi:[1,0]
v_pk_mul_f32 v[154:155], v[154:155], v[54:55] op_sel_hi:[1,0]
v_pk_mul_f32 v[156:157], v[156:157], v[30:31] op_sel_hi:[1,0]
v_pk_mul_f32 v[158:159], v[158:159], v[30:31] op_sel_hi:[1,0]
v_cvt_pk_bf16_f32 v140, v152, v153
v_cvt_pk_bf16_f32 v141, v154, v155
v_cvt_pk_bf16_f32 v142, v156, v157
v_cvt_pk_bf16_f32 v143, v158, v159
v_pk_max_i16 v140, v140, 0
v_pk_max_i16 v141, v141, 0
v_pk_max_i16 v142, v142, 0
v_pk_max_i16 v143, v143, 0
v_permlane16_swap_b32 v136, v138
v_permlane16_swap_b32 v137, v139
s_add_u32 m0, s7, 97280
s_add_u32 s88, s10, 5341184
buffer_load_dwordx4 v13, s[36:39], s88 offen sc1 lds
v_pk_mul_f32 v[160:161], v[160:161], v[54:55] op_sel_hi:[1,0]
v_pk_mul_f32 v[162:163], v[162:163], v[54:55] op_sel_hi:[1,0]
v_pk_mul_f32 v[164:165], v[164:165], v[30:31] op_sel_hi:[1,0]
v_pk_mul_f32 v[166:167], v[166:167], v[30:31] op_sel_hi:[1,0]
v_cvt_pk_bf16_f32 v144, v160, v161
v_cvt_pk_bf16_f32 v145, v162, v163
v_cvt_pk_bf16_f32 v146, v164, v165
v_cvt_pk_bf16_f32 v147, v166, v167
v_pk_max_i16 v144, v144, 0
v_pk_max_i16 v145, v145, 0
v_pk_max_i16 v146, v146, 0
v_pk_max_i16 v147, v147, 0
v_permlane16_swap_b32 v140, v142
v_permlane16_swap_b32 v141, v143
v_pk_mul_f32 v[168:169], v[168:169], v[54:55] op_sel_hi:[1,0]
v_pk_mul_f32 v[170:171], v[170:171], v[54:55] op_sel_hi:[1,0]
v_pk_mul_f32 v[172:173], v[172:173], v[30:31] op_sel_hi:[1,0]
v_pk_mul_f32 v[174:175], v[174:175], v[30:31] op_sel_hi:[1,0]
v_cvt_pk_bf16_f32 v148, v168, v169
v_cvt_pk_bf16_f32 v149, v170, v171
v_cvt_pk_bf16_f32 v150, v172, v173
v_cvt_pk_bf16_f32 v151, v174, v175
v_pk_max_i16 v148, v148, 0
v_pk_max_i16 v149, v149, 0
v_pk_max_i16 v150, v150, 0
v_pk_max_i16 v151, v151, 0
v_permlane16_swap_b32 v144, v146
v_permlane16_swap_b32 v145, v147
v_pk_mul_f32 v[176:177], v[176:177], v[54:55] op_sel_hi:[1,0]
v_pk_mul_f32 v[178:179], v[178:179], v[54:55] op_sel_hi:[1,0]
v_pk_mul_f32 v[180:181], v[180:181], v[30:31] op_sel_hi:[1,0]
v_pk_mul_f32 v[182:183], v[182:183], v[30:31] op_sel_hi:[1,0]
v_cvt_pk_bf16_f32 v152, v176, v177
v_cvt_pk_bf16_f32 v153, v178, v179
v_cvt_pk_bf16_f32 v154, v180, v181
v_cvt_pk_bf16_f32 v155, v182, v183
v_pk_max_i16 v152, v152, 0
v_pk_max_i16 v153, v153, 0
v_pk_max_i16 v154, v154, 0
v_pk_max_i16 v155, v155, 0
v_permlane16_swap_b32 v148, v150
v_permlane16_swap_b32 v149, v151
v_pk_mul_f32 v[184:185], v[184:185], v[54:55] op_sel_hi:[1,0]
v_pk_mul_f32 v[186:187], v[186:187], v[54:55] op_sel_hi:[1,0]
v_pk_mul_f32 v[188:189], v[188:189], v[30:31] op_sel_hi:[1,0]
v_pk_mul_f32 v[190:191], v[190:191], v[30:31] op_sel_hi:[1,0]
v_cvt_pk_bf16_f32 v156, v184, v185
v_cvt_pk_bf16_f32 v157, v186, v187
v_cvt_pk_bf16_f32 v158, v188, v189
v_cvt_pk_bf16_f32 v159, v190, v191
v_pk_max_i16 v156, v156, 0
v_pk_max_i16 v157, v157, 0
v_pk_max_i16 v158, v158, 0
v_pk_max_i16 v159, v159, 0
v_permlane16_swap_b32 v152, v154
v_permlane16_swap_b32 v153, v155
s_nop 0
v_permlane16_swap_b32 v156, v158
v_permlane16_swap_b32 v157, v159
s_mov_b32 s26, 2621440
v_mov_b32 v40, 0x3f80
v_mov_b32 v110, 0
v_mov_b32 v111, 0
v_cndmask_b32 v112, 0, v40, s[4:5]
v_mov_b32 v113, 0
s_waitcnt vmcnt(8)
v_cndmask_b32 v108, v104, v40, s[4:5]
v_cndmask_b32 v109, v105, 0, s[4:5]
v_cndmask_b32 v114, v106, 0, s[4:5]
v_cndmask_b32 v115, v107, 0, s[4:5]
s_and_b32 s88, s77, 1
s_lshl_b32 s88, s88, 1
s_lshl_b32 s96, 0x33333333, s88
s_mov_b32 s97, s96
s_lshr_b32 s89, s68, 1
s_add_u32 s88, s88, s89
s_lshl_b32 s98, 0x11111111, s88
s_mov_b32 s99, s98
s_barrier
ds_read_b128 v[224:227], v2 offset:0
ds_read_b128 v[228:231], v3 offset:0
ds_read_b128 v[232:235], v4 offset:0
ds_read_b128 v[236:239], v2 offset:5632
ds_read_b128 v[240:243], v3 offset:5632
ds_read_b128 v[244:247], v4 offset:5632
s_waitcnt lgkmcnt(5)
v_mfma_f32_32x32x16_bf16 v[160:175], v[224:227], v[96:99], v[64:79]
s_waitcnt lgkmcnt(4)
v_mfma_f32_32x32x16_bf16 v[176:191], v[228:231], v[100:103], v[64:79]
s_waitcnt lgkmcnt(3)
v_mfma_f32_32x32x16_bf16 v[160:175], v[232:235], v[108:111], v[160:175]
v_mfma_f32_32x32x16_bf16 v[176:191], v[232:235], v[112:115], v[176:191]
buffer_store_dwordx4 v[136:139], v42, s[40:43], s93 offen sc1
s_waitcnt lgkmcnt(2)
v_mfma_f32_32x32x16_bf16 v[192:207], v[236:239], v[96:99], 0
ds_read_b128 v[224:227], v2 offset:11264
s_nop 6
v_max3_f32 v36, v160, v161, v162
v_max3_f32 v37, v163, v164, v165
v_max3_f32 v36, v36, v166, v167
v_max3_f32 v37, v37, v168, v169
s_waitcnt lgkmcnt(2)
v_mfma_f32_32x32x16_bf16 v[208:223], v[240:243], v[100:103], 0
s_waitcnt lgkmcnt(1)
ds_read_b128 v[228:231], v3 offset:11264
v_max3_f32 v36, v36, v170, v171
v_max3_f32 v37, v37, v172, v173
v_max3_f32 v36, v36, v174, v175
v_mfma_f32_32x32x16_bf16 v[192:207], v[244:247], v[108:111], v[192:207]
ds_read_b128 v[232:235], v4 offset:11264
v_max3_f32 v38, v176, v177, v178
v_max3_f32 v39, v179, v180, v181
v_max3_f32 v38, v38, v182, v183
v_max3_f32 v39, v39, v184, v185
v_mfma_f32_32x32x16_bf16 v[208:223], v[244:247], v[112:115], v[208:223]
s_waitcnt lgkmcnt(1)
buffer_store_dwordx4 v[140:143], v61, s[40:43], s93 offen sc1
v_max3_f32 v38, v38, v186, v187
v_max3_f32 v39, v39, v188, v189
v_max3_f32 v38, v38, v190, v191
v_mfma_f32_32x32x16_bf16 v[160:175], v[224:227], v[96:99], 0
ds_read_b128 v[236:239], v2 offset:16896
v_max3_f32 v36, v36, v192, v193
v_max3_f32 v37, v37, v194, v195
v_max3_f32 v36, v36, v196, v197
v_max3_f32 v37, v37, v198, v199
v_mfma_f32_32x32x16_bf16 v[176:191], v[228:231], v[100:103], 0
s_waitcnt lgkmcnt(1)
ds_read_b128 v[240:243], v3 offset:16896
v_max3_f32 v36, v36, v200, v201
v_max3_f32 v37, v37, v202, v203
v_max3_f32 v36, v36, v204, v205
v_max3_f32 v37, v37, v206, v207
v_mfma_f32_32x32x16_bf16 v[160:175], v[232:235], v[108:111], v[160:175]
ds_read_b128 v[244:247], v4 offset:16896
v_max3_f32 v38, v38, v208, v209
v_max3_f32 v39, v39, v210, v211
v_max3_f32 v38, v38, v212, v213
v_max3_f32 v39, v39, v214, v215
v_mfma_f32_32x32x16_bf16 v[176:191], v[232:235], v[112:115], v[176:191]
s_waitcnt lgkmcnt(1)
v_max3_f32 v38, v38, v216, v217
v_max3_f32 v39, v39, v218, v219
v_max3_f32 v38, v38, v220, v221
v_max3_f32 v39, v39, v222, v223
v_mfma_f32_32x32x16_bf16 v[192:207], v[236:239], v[96:99], 0
ds_read_b128 v[224:227], v2 offset:22528
v_max3_f32 v36, v36, v160, v161
v_max3_f32 v37, v37, v162, v163
v_max3_f32 v36, v36, v164, v165
v_max3_f32 v37, v37, v166, v167
v_mfma_f32_32x32x16_bf16 v[208:223], v[240:243], v[100:103], 0
s_waitcnt lgkmcnt(1)
ds_read_b128 v[228:231], v3 offset:22528
buffer_store_dwordx4 v[144:147], v42, s[40:43], s94 offen sc1
v_max3_f32 v36, v36, v168, v169
v_max3_f32 v37, v37, v170, v171
v_max3_f32 v36, v36, v172, v173
v_max3_f32 v37, v37, v174, v175
v_mfma_f32_32x32x16_bf16 v[192:207], v[244:247], v[108:111], v[192:207]
ds_read_b128 v[232:235], v4 offset:22528
v_max3_f32 v38, v38, v176, v177
v_max3_f32 v39, v39, v178, v179
v_max3_f32 v38, v38, v180, v181
v_max3_f32 v39, v39, v182, v183
v_mfma_f32_32x32x16_bf16 v[208:223], v[244:247], v[112:115], v[208:223]
s_waitcnt lgkmcnt(1)
v_max3_f32 v38, v38, v184, v185
v_max3_f32 v39, v39, v186, v187
v_max3_f32 v38, v38, v188, v189
v_max3_f32 v39, v39, v190, v191
v_mfma_f32_32x32x16_bf16 v[160:175], v[224:227], v[96:99], 0
ds_read_b128 v[236:239], v2 offset:28160
v_max3_f32 v36, v36, v192, v193
v_max3_f32 v37, v37, v194, v195
v_max3_f32 v36, v36, v196, v197
v_max3_f32 v37, v37, v198, v199
v_mfma_f32_32x32x16_bf16 v[176:191], v[228:231], v[100:103], 0
s_waitcnt lgkmcnt(1)
ds_read_b128 v[240:243], v3 offset:28160
v_max3_f32 v36, v36, v200, v201
v_max3_f32 v37, v37, v202, v203
v_max3_f32 v36, v36, v204, v205
v_max3_f32 v37, v37, v206, v207
v_mfma_f32_32x32x16_bf16 v[160:175], v[232:235], v[108:111], v[160:175]
ds_read_b128 v[244:247], v4 offset:28160
v_max3_f32 v38, v38, v208, v209
v_max3_f32 v39, v39, v210, v211
v_max3_f32 v38, v38, v212, v213
v_max3_f32 v39, v39, v214, v215
v_mfma_f32_32x32x16_bf16 v[176:191], v[232:235], v[112:115], v[176:191]
s_waitcnt lgkmcnt(1)
buffer_store_dwordx4 v[148:151], v61, s[40:43], s94 offen sc1
buffer_load_dwordx4 a[0:3], v57, s[48:51], s12 offen offset:0 sc1
v_max3_f32 v38, v38, v216, v217
v_max3_f32 v39, v39, v218, v219
v_max3_f32 v38, v38, v220, v221
v_max3_f32 v39, v39, v222, v223
v_mfma_f32_32x32x16_bf16 v[192:207], v[236:239], v[96:99], 0
ds_read_b128 v[224:227], v2 offset:33792
v_max3_f32 v36, v36, v160, v161
v_max3_f32 v37, v37, v162, v163
v_max3_f32 v36, v36, v164, v165
v_max3_f32 v37, v37, v166, v167
v_mfma_f32_32x32x16_bf16 v[208:223], v[240:243], v[100:103], 0
s_waitcnt lgkmcnt(1)
ds_read_b128 v[228:231], v3 offset:33792
buffer_load_dwordx4 a[4:7], v57, s[48:51], s12 offen offset:1024 sc1
v_max3_f32 v36, v36, v168, v169
v_max3_f32 v37, v37, v170, v171
v_max3_f32 v36, v36, v172, v173
v_max3_f32 v37, v37, v174, v175
v_mfma_f32_32x32x16_bf16 v[192:207], v[244:247], v[108:111], v[192:207]
ds_read_b128 v[232:235], v4 offset:33792
v_max3_f32 v38, v38, v176, v177
v_max3_f32 v39, v39, v178, v179
v_max3_f32 v38, v38, v180, v181
v_max3_f32 v39, v39, v182, v183
v_mfma_f32_32x32x16_bf16 v[208:223], v[244:247], v[112:115], v[208:223]
s_waitcnt lgkmcnt(1)
buffer_load_dwordx4 a[8:11], v57, s[48:51], s12 offen offset:2048 sc1
v_max3_f32 v38, v38, v184, v185
v_max3_f32 v39, v39, v186, v187
v_max3_f32 v38, v38, v188, v189
v_max3_f32 v39, v39, v190, v191
v_mfma_f32_32x32x16_bf16 v[160:175], v[224:227], v[96:99], 0
ds_read_b128 v[236:239], v2 offset:39424
v_max3_f32 v36, v36, v192, v193
v_max3_f32 v37, v37, v194, v195
v_max3_f32 v36, v36, v196, v197
v_max3_f32 v37, v37, v198, v199
v_mfma_f32_32x32x16_bf16 v[176:191], v[228:231], v[100:103], 0
s_waitcnt lgkmcnt(1)
ds_read_b128 v[240:243], v3 offset:39424
buffer_store_dwordx4 v[152:155], v42, s[40:43], s95 offen sc1
buffer_load_dwordx4 a[12:15], v57, s[48:51], s12 offen offset:3072 sc1
v_max3_f32 v36, v36, v200, v201
v_max3_f32 v37, v37, v202, v203
v_max3_f32 v36, v36, v204, v205
v_max3_f32 v37, v37, v206, v207
v_mfma_f32_32x32x16_bf16 v[160:175], v[232:235], v[108:111], v[160:175]
ds_read_b128 v[244:247], v4 offset:39424
v_max3_f32 v38, v38, v208, v209
v_max3_f32 v39, v39, v210, v211
v_max3_f32 v38, v38, v212, v213
v_max3_f32 v39, v39, v214, v215
v_mfma_f32_32x32x16_bf16 v[176:191], v[232:235], v[112:115], v[176:191]
s_waitcnt lgkmcnt(1)
buffer_load_dwordx4 a[16:19], v19, s[48:51], s12 offen sc1
s_add_u32 s12, s12, 20480
v_max3_f32 v38, v38, v216, v217
v_max3_f32 v39, v39, v218, v219
v_max3_f32 v38, v38, v220, v221
v_max3_f32 v39, v39, v222, v223
v_mfma_f32_32x32x16_bf16 v[192:207], v[236:239], v[96:99], 0
ds_read_b128 v[224:227], v2 offset:45056
v_max3_f32 v36, v36, v160, v161
v_max3_f32 v37, v37, v162, v163
v_max3_f32 v36, v36, v164, v165
v_max3_f32 v37, v37, v166, v167
v_mfma_f32_32x32x16_bf16 v[208:223], v[240:243], v[100:103], 0
s_waitcnt lgkmcnt(1)
ds_read_b128 v[228:231], v3 offset:45056
buffer_load_dwordx4 a[20:23], v57, s[48:51], s12 offen offset:0 sc1
v_max3_f32 v36, v36, v168, v169
v_max3_f32 v37, v37, v170, v171
v_max3_f32 v36, v36, v172, v173
v_max3_f32 v37, v37, v174, v175
v_mfma_f32_32x32x16_bf16 v[192:207], v[244:247], v[108:111], v[192:207]
ds_read_b128 v[232:235], v4 offset:45056
v_max3_f32 v38, v38, v176, v177
v_max3_f32 v39, v39, v178, v179
v_max3_f32 v38, v38, v180, v181
v_max3_f32 v39, v39, v182, v183
v_mfma_f32_32x32x16_bf16 v[208:223], v[244:247], v[112:115], v[208:223]
s_waitcnt lgkmcnt(1)
buffer_store_dwordx4 v[156:159], v61, s[40:43], s95 offen sc1
v_max3_f32 v38, v38, v184, v185
v_max3_f32 v39, v39, v186, v187
v_max3_f32 v38, v38, v188, v189
v_max3_f32 v39, v39, v190, v191
v_mfma_f32_32x32x16_bf16 v[160:175], v[224:227], v[96:99], v[80:95]
v_max3_f32 v36, v36, v192, v193
v_max3_f32 v37, v37, v194, v195
v_max3_f32 v36, v36, v196, v197
v_max3_f32 v37, v37, v198, v199
v_mfma_f32_32x32x16_bf16 v[176:191], v[228:231], v[100:103], v[80:95]
s_waitcnt lgkmcnt(0)
buffer_load_dwordx4 a[24:27], v57, s[48:51], s12 offen offset:1024 sc1
v_max3_f32 v36, v36, v200, v201
v_max3_f32 v37, v37, v202, v203
v_max3_f32 v36, v36, v204, v205
v_max3_f32 v37, v37, v206, v207
v_mfma_f32_32x32x16_bf16 v[160:175], v[232:235], v[108:111], v[160:175]
v_max3_f32 v38, v38, v208, v209
v_max3_f32 v39, v39, v210, v211
v_max3_f32 v38, v38, v212, v213
v_max3_f32 v39, v39, v214, v215
v_mfma_f32_32x32x16_bf16 v[176:191], v[232:235], v[112:115], v[176:191]
buffer_load_dwordx4 a[28:31], v57, s[48:51], s12 offen offset:2048 sc1
v_max3_f32 v38, v38, v216, v217
v_max3_f32 v39, v39, v218, v219
v_max3_f32 v38, v38, v220, v221
v_max3_f32 v39, v39, v222, v223
ds_read_b128 v[224:227], v2 offset:0
ds_read_b128 v[232:235], v4 offset:0
ds_read_b128 v[228:231], v3 offset:0
v_max3_f32 v36, v36, v160, v161
v_max3_f32 v37, v37, v162, v163
v_max3_f32 v36, v36, v164, v165
v_max3_f32 v37, v37, v166, v167
v_max3_f32 v36, v36, v168, v169
v_max3_f32 v37, v37, v170, v171
v_max3_f32 v36, v36, v172, v173
v_max3_f32 v37, v37, v174, v175
s_waitcnt lgkmcnt(2)
v_mfma_f32_32x32x16_bf16 v[160:175], v[224:227], v[96:99], v[64:79]
ds_read_b128 v[224:227], v2 offset:5632
ds_read_b128 v[236:239], v4 offset:5632
v_max_f32 v36, v36, v37
v_mov_b32 v37, v36
s_nop 1
v_permlane32_swap_b32 v36, v37
v_max_f32 v36, v36, v37
v_cvt_pk_bf16_f32 v40, 1.0, -v36
v_and_b32 v41, 0xffff0000, v40
v_add_f32 v36, v36, v41
v_cvt_pk_bf16_f32 v41, -v36, 0
v_cndmask_b32 v108, v108, v40, s[4:5]
v_cndmask_b32 v109, v109, v41, s[4:5]
s_waitcnt lgkmcnt(3)
s_nop 0
v_mfma_f32_32x32x16_bf16 v[160:175], v[232:235], v[108:111], v[160:175]
s_waitcnt vmcnt(14)
s_barrier
ds_read_b64_tr_b16 v[116:117], v5 offset:0
ds_read_b64_tr_b16 v[118:119], v6 offset:0
ds_read_b64_tr_b16 v[120:121], v5 offset:256
ds_read_b64_tr_b16 v[122:123], v6 offset:256
v_max3_f32 v38, v38, v176, v177
v_max3_f32 v39, v39, v178, v179
v_max3_f32 v38, v38, v180, v181
v_max3_f32 v39, v39, v182, v183
v_max3_f32 v38, v38, v184, v185
v_max3_f32 v39, v39, v186, v187
v_max3_f32 v38, v38, v188, v189
v_max3_f32 v39, v39, v190, v191
v_max_f32 v38, v38, v39
v_mov_b32 v39, v38
s_nop 1
v_permlane32_swap_b32 v38, v39
v_max_f32 v38, v38, v39
v_cvt_pk_bf16_f32 v40, 1.0, -v38
v_and_b32 v41, 0xffff0000, v40
v_add_f32 v38, v38, v41
v_cvt_pk_bf16_f32 v41, -v38, 0
v_cndmask_b32 v112, v112, v40, s[4:5]
v_cndmask_b32 v113, v113, v41, s[4:5]
s_waitcnt lgkmcnt(6)
v_mfma_f32_32x32x16_bf16 v[176:191], v[228:231], v[100:103], v[64:79]
buffer_load_dwordx4 a[32:35], v57, s[48:51], s12 offen offset:3072 sc1
v_exp_f32 v160, v160
v_exp_f32 v161, v161
v_exp_f32 v162, v162
v_exp_f32 v163, v163
buffer_load_dwordx4 a[36:39], v19, s[48:51], s12 offen sc1
s_add_u32 s12, s12, 20480
v_exp_f32 v164, v164
v_exp_f32 v165, v165
v_exp_f32 v166, v166
v_exp_f32 v167, v167
v_cvt_pk_bf16_f32 v248, v160, v161
v_cvt_pk_bf16_f32 v249, v162, v163
v_mfma_f32_32x32x16_bf16 v[176:191], v[232:235], v[112:115], v[176:191]
ds_read_b128 v[228:231], v3 offset:5632
v_exp_f32 v168, v168
v_exp_f32 v169, v169
v_exp_f32 v170, v170
v_cvt_pk_bf16_f32 v250, v164, v165
v_cvt_pk_bf16_f32 v251, v166, v167
v_exp_f32 v171, v171
v_exp_f32 v172, v172
s_waitcnt lgkmcnt(3)
v_mfma_f32_32x32x16_bf16 v[192:207], v[116:119], v[248:251], 0
ds_read_b64_tr_b16 v[116:117], v7 offset:0
ds_read_b64_tr_b16 v[118:119], v8 offset:0
buffer_load_dwordx4 a[40:43], v57, s[48:51], s12 offen offset:0 sc1
v_exp_f32 v173, v173
v_exp_f32 v174, v174
v_exp_f32 v175, v175
v_cvt_pk_bf16_f32 v252, v168, v169
v_cvt_pk_bf16_f32 v253, v170, v171
v_cvt_pk_bf16_f32 v254, v172, v173
v_cvt_pk_bf16_f32 v255, v174, v175
v_mfma_f32_32x32x16_bf16 v[160:175], v[224:227], v[96:99], 0
s_waitcnt lgkmcnt(2)
buffer_load_dwordx4 a[44:47], v57, s[48:51], s12 offen offset:1024 sc1
v_exp_f32 v176, v176
v_exp_f32 v177, v177
v_exp_f32 v178, v178
v_exp_f32 v179, v179
v_mfma_f32_32x32x16_bf16 v[192:207], v[120:123], v[252:255], v[192:207]
ds_read_b64_tr_b16 v[120:121], v7 offset:256
ds_read_b64_tr_b16 v[122:123], v8 offset:256
buffer_load_dwordx4 a[48:51], v57, s[48:51], s12 offen offset:2048 sc1
v_exp_f32 v180, v180
v_exp_f32 v181, v181
v_exp_f32 v182, v182
v_exp_f32 v183, v183
v_cvt_pk_bf16_f32 v248, v176, v177
v_cvt_pk_bf16_f32 v249, v178, v179
v_mfma_f32_32x32x16_bf16 v[160:175], v[236:239], v[108:111], v[160:175]
s_waitcnt lgkmcnt(2)
ds_read_b128 v[224:227], v2 offset:11264
ds_read_b128 v[232:235], v4 offset:11264
buffer_load_dwordx4 a[52:55], v57, s[48:51], s12 offen offset:3072 sc1
v_exp_f32 v184, v184
v_exp_f32 v185, v185
v_exp_f32 v186, v186
v_cvt_pk_bf16_f32 v250, v180, v181
v_cvt_pk_bf16_f32 v251, v182, v183
v_exp_f32 v187, v187
v_exp_f32 v188, v188
v_mfma_f32_32x32x16_bf16 v[208:223], v[116:119], v[248:251], 0
ds_read_b64_tr_b16 v[116:117], v5 offset:5632
ds_read_b64_tr_b16 v[118:119], v6 offset:5632
v_exp_f32 v189, v189
v_exp_f32 v190, v190
v_exp_f32 v191, v191
v_cvt_pk_bf16_f32 v252, v184, v185
v_cvt_pk_bf16_f32 v253, v186, v187
v_cvt_pk_bf16_f32 v254, v188, v189
v_cvt_pk_bf16_f32 v255, v190, v191
v_mfma_f32_32x32x16_bf16 v[176:191], v[228:231], v[100:103], 0
s_waitcnt lgkmcnt(2)
buffer_load_dwordx4 a[56:59], v19, s[48:51], s12 offen sc1
s_add_u32 s12, s12, 20480
v_exp_f32 v160, v160
v_exp_f32 v161, v161
v_exp_f32 v162, v162
v_exp_f32 v163, v163
v_mfma_f32_32x32x16_bf16 v[208:223], v[120:123], v[252:255], v[208:223]
ds_read_b64_tr_b16 v[120:121], v5 offset:5888
ds_read_b64_tr_b16 v[122:123], v6 offset:5888
buffer_load_dwordx4 a[60:63], v57, s[48:51], s12 offen offset:0 sc1
v_exp_f32 v164, v164
v_exp_f32 v165, v165
v_exp_f32 v166, v166
v_exp_f32 v167, v167
v_cvt_pk_bf16_f32 v248, v160, v161
v_cvt_pk_bf16_f32 v249, v162, v163
v_mfma_f32_32x32x16_bf16 v[176:191], v[236:239], v[112:115], v[176:191]
s_waitcnt lgkmcnt(2)
ds_read_b128 v[228:231], v3 offset:11264
buffer_load_dwordx4 a[64:67], v57, s[48:51], s12 offen offset:1024 sc1
v_exp_f32 v168, v168
v_exp_f32 v169, v169
v_exp_f32 v170, v170
v_cvt_pk_bf16_f32 v250, v164, v165
v_cvt_pk_bf16_f32 v251, v166, v167
v_exp_f32 v171, v171
v_exp_f32 v172, v172
v_mfma_f32_32x32x16_bf16 v[192:207], v[116:119], v[248:251], v[192:207]
ds_read_b64_tr_b16 v[116:117], v7 offset:5632
ds_read_b64_tr_b16 v[118:119], v8 offset:5632
buffer_load_dwordx4 a[68:71], v57, s[48:51], s12 offen offset:2048 sc1
v_exp_f32 v173, v173
v_exp_f32 v174, v174
v_exp_f32 v175, v175
v_cvt_pk_bf16_f32 v252, v168, v169
v_cvt_pk_bf16_f32 v253, v170, v171
v_cvt_pk_bf16_f32 v254, v172, v173
v_cvt_pk_bf16_f32 v255, v174, v175
v_mfma_f32_32x32x16_bf16 v[160:175], v[224:227], v[96:99], 0
s_waitcnt lgkmcnt(2)
v_exp_f32 v176, v176
v_exp_f32 v177, v177
v_exp_f32 v178, v178
v_exp_f32 v179, v179
v_mfma_f32_32x32x16_bf16 v[192:207], v[120:123], v[252:255], v[192:207]
ds_read_b64_tr_b16 v[120:121], v7 offset:5888
ds_read_b64_tr_b16 v[122:123], v8 offset:5888
buffer_load_dwordx4 a[72:75], v57, s[48:51], s12 offen offset:3072 sc1
v_exp_f32 v180, v180
v_exp_f32 v181, v181
v_exp_f32 v182, v182
v_exp_f32 v183, v183
v_cvt_pk_bf16_f32 v248, v176, v177
v_cvt_pk_bf16_f32 v249, v178, v179
v_mfma_f32_32x32x16_bf16 v[160:175], v[232:235], v[108:111], v[160:175]
s_waitcnt lgkmcnt(2)
ds_read_b128 v[224:227], v2 offset:16896
ds_read_b128 v[236:239], v4 offset:16896
buffer_load_dwordx4 a[76:79], v19, s[48:51], s12 offen sc1
s_add_u32 s12, s12, 20480
v_exp_f32 v184, v184
v_exp_f32 v185, v185
v_exp_f32 v186, v186
v_cvt_pk_bf16_f32 v250, v180, v181
v_cvt_pk_bf16_f32 v251, v182, v183
v_exp_f32 v187, v187
v_exp_f32 v188, v188
v_mfma_f32_32x32x16_bf16 v[208:223], v[116:119], v[248:251], v[208:223]
ds_read_b64_tr_b16 v[116:117], v5 offset:11264
ds_read_b64_tr_b16 v[118:119], v6 offset:11264
buffer_load_dwordx4 a[80:83], v57, s[48:51], s12 offen offset:0 sc1
v_exp_f32 v189, v189
v_exp_f32 v190, v190
v_exp_f32 v191, v191
v_cvt_pk_bf16_f32 v252, v184, v185
v_cvt_pk_bf16_f32 v253, v186, v187
v_cvt_pk_bf16_f32 v254, v188, v189
v_cvt_pk_bf16_f32 v255, v190, v191
v_mfma_f32_32x32x16_bf16 v[176:191], v[228:231], v[100:103], 0
s_waitcnt lgkmcnt(2)
buffer_load_dwordx4 a[84:87], v57, s[48:51], s12 offen offset:1024 sc1
v_exp_f32 v160, v160
v_exp_f32 v161, v161
v_exp_f32 v162, v162
v_exp_f32 v163, v163
v_mfma_f32_32x32x16_bf16 v[208:223], v[120:123], v[252:255], v[208:223]
ds_read_b64_tr_b16 v[120:121], v5 offset:11520
ds_read_b64_tr_b16 v[122:123], v6 offset:11520
v_exp_f32 v164, v164
v_exp_f32 v165, v165
v_exp_f32 v166, v166
v_exp_f32 v167, v167
v_cvt_pk_bf16_f32 v248, v160, v161
v_cvt_pk_bf16_f32 v249, v162, v163
v_mfma_f32_32x32x16_bf16 v[176:191], v[232:235], v[112:115], v[176:191]
s_waitcnt lgkmcnt(2)
ds_read_b128 v[228:231], v3 offset:16896
buffer_load_dwordx4 a[88:91], v57, s[48:51], s12 offen offset:2048 sc1
v_exp_f32 v168, v168
v_exp_f32 v169, v169
v_exp_f32 v170, v170
v_cvt_pk_bf16_f32 v250, v164, v165
v_cvt_pk_bf16_f32 v251, v166, v167
v_exp_f32 v171, v171
v_exp_f32 v172, v172
v_mfma_f32_32x32x16_bf16 v[192:207], v[116:119], v[248:251], v[192:207]
ds_read_b64_tr_b16 v[116:117], v7 offset:11264
ds_read_b64_tr_b16 v[118:119], v8 offset:11264
buffer_load_dwordx4 a[92:95], v57, s[48:51], s12 offen offset:3072 sc1
v_exp_f32 v173, v173
v_exp_f32 v174, v174
v_exp_f32 v175, v175
v_cvt_pk_bf16_f32 v252, v168, v169
v_cvt_pk_bf16_f32 v253, v170, v171
v_cvt_pk_bf16_f32 v254, v172, v173
v_cvt_pk_bf16_f32 v255, v174, v175
v_mfma_f32_32x32x16_bf16 v[160:175], v[224:227], v[96:99], 0
s_waitcnt lgkmcnt(2)
buffer_load_dwordx4 a[96:99], v19, s[48:51], s12 offen sc1
s_add_u32 s12, s12, 20480
v_exp_f32 v176, v176
v_exp_f32 v177, v177
v_exp_f32 v178, v178
v_exp_f32 v179, v179
v_mfma_f32_32x32x16_bf16 v[192:207], v[120:123], v[252:255], v[192:207]
ds_read_b64_tr_b16 v[120:121], v7 offset:11520
ds_read_b64_tr_b16 v[122:123], v8 offset:11520
buffer_load_dwordx4 a[100:103], v57, s[48:51], s12 offen offset:0 sc1
v_exp_f32 v180, v180
v_exp_f32 v181, v181
v_exp_f32 v182, v182
v_exp_f32 v183, v183
v_cvt_pk_bf16_f32 v248, v176, v177
v_cvt_pk_bf16_f32 v249, v178, v179
v_mfma_f32_32x32x16_bf16 v[160:175], v[236:239], v[108:111], v[160:175]
s_waitcnt lgkmcnt(2)
ds_read_b128 v[224:227], v2 offset:22528
ds_read_b128 v[232:235], v4 offset:22528
v_exp_f32 v184, v184
v_exp_f32 v185, v185
v_exp_f32 v186, v186
v_cvt_pk_bf16_f32 v250, v180, v181
v_cvt_pk_bf16_f32 v251, v182, v183
v_exp_f32 v187, v187
v_exp_f32 v188, v188
v_mfma_f32_32x32x16_bf16 v[208:223], v[116:119], v[248:251], v[208:223]
ds_read_b64_tr_b16 v[116:117], v5 offset:16896
ds_read_b64_tr_b16 v[118:119], v6 offset:16896
buffer_load_dwordx4 a[104:107], v57, s[48:51], s12 offen offset:1024 sc1
v_exp_f32 v189, v189
v_exp_f32 v190, v190
v_exp_f32 v191, v191
v_cvt_pk_bf16_f32 v252, v184, v185
v_cvt_pk_bf16_f32 v253, v186, v187
v_cvt_pk_bf16_f32 v254, v188, v189
v_cvt_pk_bf16_f32 v255, v190, v191
v_mfma_f32_32x32x16_bf16 v[176:191], v[228:231], v[100:103], 0
s_waitcnt lgkmcnt(2)
buffer_load_dwordx4 a[108:111], v57, s[48:51], s12 offen offset:2048 sc1
v_exp_f32 v160, v160
v_exp_f32 v161, v161
v_exp_f32 v162, v162
v_exp_f32 v163, v163
v_mfma_f32_32x32x16_bf16 v[208:223], v[120:123], v[252:255], v[208:223]
ds_read_b64_tr_b16 v[120:121], v5 offset:17152
ds_read_b64_tr_b16 v[122:123], v6 offset:17152
buffer_load_dwordx4 a[112:115], v57, s[48:51], s12 offen offset:3072 sc1
v_exp_f32 v164, v164
v_exp_f32 v165, v165
v_exp_f32 v166, v166
v_exp_f32 v167, v167
v_cvt_pk_bf16_f32 v248, v160, v161
v_cvt_pk_bf16_f32 v249, v162, v163
v_mfma_f32_32x32x16_bf16 v[176:191], v[236:239], v[112:115], v[176:191]
s_waitcnt lgkmcnt(2)
ds_read_b128 v[228:231], v3 offset:22528
buffer_load_dwordx4 a[116:119], v19, s[48:51], s12 offen sc1
s_add_u32 s12, s12, 20480
v_exp_f32 v168, v168
v_exp_f32 v169, v169
v_exp_f32 v170, v170
v_cvt_pk_bf16_f32 v250, v164, v165
v_cvt_pk_bf16_f32 v251, v166, v167
v_exp_f32 v171, v171
v_exp_f32 v172, v172
v_mfma_f32_32x32x16_bf16 v[192:207], v[116:119], v[248:251], v[192:207]
ds_read_b64_tr_b16 v[116:117], v7 offset:16896
ds_read_b64_tr_b16 v[118:119], v8 offset:16896
v_exp_f32 v173, v173
v_exp_f32 v174, v174
v_exp_f32 v175, v175
v_cvt_pk_bf16_f32 v252, v168, v169
v_cvt_pk_bf16_f32 v253, v170, v171
v_cvt_pk_bf16_f32 v254, v172, v173
v_cvt_pk_bf16_f32 v255, v174, v175
v_mfma_f32_32x32x16_bf16 v[160:175], v[224:227], v[96:99], 0
s_waitcnt lgkmcnt(2)
buffer_load_dwordx4 a[120:123], v57, s[48:51], s12 offen offset:0 sc1
v_exp_f32 v176, v176
v_exp_f32 v177, v177
v_exp_f32 v178, v178
v_exp_f32 v179, v179
v_mfma_f32_32x32x16_bf16 v[192:207], v[120:123], v[252:255], v[192:207]
ds_read_b64_tr_b16 v[120:121], v7 offset:17152
ds_read_b64_tr_b16 v[122:123], v8 offset:17152
s_waitcnt vmcnt(25)
v_mov_b32 v43, s72
s_mov_b64 exec, 1
buffer_store_dword v43, off, s[52:55], s19 sc1
s_mov_b64 exec, -1
buffer_load_dwordx4 a[124:127], v57, s[48:51], s12 offen offset:1024 sc1
v_exp_f32 v180, v180
v_exp_f32 v181, v181
v_exp_f32 v182, v182
v_exp_f32 v183, v183
v_cvt_pk_bf16_f32 v248, v176, v177
v_cvt_pk_bf16_f32 v249, v178, v179
v_mfma_f32_32x32x16_bf16 v[160:175], v[232:235], v[108:111], v[160:175]
s_waitcnt lgkmcnt(2)
ds_read_b128 v[224:227], v2 offset:28160
ds_read_b128 v[236:239], v4 offset:28160
buffer_load_dwordx4 a[128:131], v57, s[48:51], s12 offen offset:2048 sc1
v_exp_f32 v184, v184
v_exp_f32 v185, v185
v_exp_f32 v186, v186
v_cvt_pk_bf16_f32 v250, v180, v181
v_cvt_pk_bf16_f32 v251, v182, v183
v_exp_f32 v187, v187
v_exp_f32 v188, v188
v_mfma_f32_32x32x16_bf16 v[208:223], v[116:119], v[248:251], v[208:223]
ds_read_b64_tr_b16 v[116:117], v5 offset:22528
ds_read_b64_tr_b16 v[118:119], v6 offset:22528
buffer_load_dwordx4 a[132:135], v57, s[48:51], s12 offen offset:3072 sc1
v_exp_f32 v189, v189
v_exp_f32 v190, v190
v_exp_f32 v191, v191
v_cvt_pk_bf16_f32 v252, v184, v185
v_cvt_pk_bf16_f32 v253, v186, v187
v_cvt_pk_bf16_f32 v254, v188, v189
v_cvt_pk_bf16_f32 v255, v190, v191
v_mfma_f32_32x32x16_bf16 v[176:191], v[228:231], v[100:103], 0
s_waitcnt lgkmcnt(2)
v_exp_f32 v160, v160
v_exp_f32 v161, v161
v_exp_f32 v162, v162
v_exp_f32 v163, v163
v_mfma_f32_32x32x16_bf16 v[208:223], v[120:123], v[252:255], v[208:223]
ds_read_b64_tr_b16 v[120:121], v5 offset:22784
ds_read_b64_tr_b16 v[122:123], v6 offset:22784
buffer_load_dwordx4 a[136:139], v19, s[48:51], s12 offen sc1
s_add_u32 s12, s12, 20480
v_exp_f32 v164, v164
v_exp_f32 v165, v165
v_exp_f32 v166, v166
v_exp_f32 v167, v167
v_cvt_pk_bf16_f32 v248, v160, v161
v_cvt_pk_bf16_f32 v249, v162, v163
v_mfma_f32_32x32x16_bf16 v[176:191], v[232:235], v[112:115], v[176:191]
s_waitcnt lgkmcnt(2)
ds_read_b128 v[228:231], v3 offset:28160
buffer_load_dwordx4 a[140:143], v57, s[48:51], s12 offen offset:0 sc1
v_exp_f32 v168, v168
v_exp_f32 v169, v169
v_exp_f32 v170, v170
v_cvt_pk_bf16_f32 v250, v164, v165
v_cvt_pk_bf16_f32 v251, v166, v167
v_exp_f32 v171, v171
v_exp_f32 v172, v172
v_mfma_f32_32x32x16_bf16 v[192:207], v[116:119], v[248:251], v[192:207]
ds_read_b64_tr_b16 v[116:117], v7 offset:22528
ds_read_b64_tr_b16 v[118:119], v8 offset:22528
buffer_load_dwordx4 a[144:147], v57, s[48:51], s12 offen offset:1024 sc1
v_exp_f32 v173, v173
v_exp_f32 v174, v174
v_exp_f32 v175, v175
v_cvt_pk_bf16_f32 v252, v168, v169
v_cvt_pk_bf16_f32 v253, v170, v171
v_cvt_pk_bf16_f32 v254, v172, v173
v_cvt_pk_bf16_f32 v255, v174, v175
v_mfma_f32_32x32x16_bf16 v[160:175], v[224:227], v[96:99], 0
s_waitcnt lgkmcnt(2)
v_exp_f32 v176, v176
v_exp_f32 v177, v177
v_exp_f32 v178, v178
v_exp_f32 v179, v179
v_mfma_f32_32x32x16_bf16 v[192:207], v[120:123], v[252:255], v[192:207]
ds_read_b64_tr_b16 v[120:121], v7 offset:22784
ds_read_b64_tr_b16 v[122:123], v8 offset:22784
buffer_load_dwordx4 a[148:151], v57, s[48:51], s12 offen offset:2048 sc1
v_exp_f32 v180, v180
v_exp_f32 v181, v181
v_exp_f32 v182, v182
v_exp_f32 v183, v183
v_cvt_pk_bf16_f32 v248, v176, v177
v_cvt_pk_bf16_f32 v249, v178, v179
v_mfma_f32_32x32x16_bf16 v[160:175], v[236:239], v[108:111], v[160:175]
s_waitcnt lgkmcnt(2)
ds_read_b128 v[224:227], v2 offset:33792
ds_read_b128 v[232:235], v4 offset:33792
buffer_load_dwordx4 a[152:155], v57, s[48:51], s12 offen offset:3072 sc1
v_exp_f32 v184, v184
v_exp_f32 v185, v185
v_exp_f32 v186, v186
v_cvt_pk_bf16_f32 v250, v180, v181
v_cvt_pk_bf16_f32 v251, v182, v183
v_exp_f32 v187, v187
v_exp_f32 v188, v188
v_mfma_f32_32x32x16_bf16 v[208:223], v[116:119], v[248:251], v[208:223]
ds_read_b64_tr_b16 v[116:117], v5 offset:28160
ds_read_b64_tr_b16 v[118:119], v6 offset:28160
buffer_load_dwordx4 a[156:159], v19, s[48:51], s12 offen sc1
s_add_u32 s12, s12, 20480
v_exp_f32 v189, v189
v_exp_f32 v190, v190
v_exp_f32 v191, v191
v_cvt_pk_bf16_f32 v252, v184, v185
v_cvt_pk_bf16_f32 v253, v186, v187
v_cvt_pk_bf16_f32 v254, v188, v189
v_cvt_pk_bf16_f32 v255, v190, v191
v_mfma_f32_32x32x16_bf16 v[176:191], v[228:231], v[100:103], 0
s_waitcnt lgkmcnt(2)
buffer_load_dwordx4 a[252:255], v57, s[48:51], s11 offen offset:3072 sc1
v_exp_f32 v160, v160
v_exp_f32 v161, v161
v_exp_f32 v162, v162
v_exp_f32 v163, v163
v_mfma_f32_32x32x16_bf16 v[208:223], v[120:123], v[252:255], v[208:223]
ds_read_b64_tr_b16 v[120:121], v5 offset:28416
ds_read_b64_tr_b16 v[122:123], v6 offset:28416
v_exp_f32 v164, v164
v_exp_f32 v165, v165
v_exp_f32 v166, v166
v_exp_f32 v167, v167
v_cvt_pk_bf16_f32 v248, v160, v161
v_cvt_pk_bf16_f32 v249, v162, v163
v_mfma_f32_32x32x16_bf16 v[176:191], v[236:239], v[112:115], v[176:191]
s_waitcnt lgkmcnt(2)
ds_read_b128 v[228:231], v3 offset:33792
s_lshl_b32 s7, s68, 10
s_add_u32 m0, s7, 0
s_add_u32 s16, s16, 4096
buffer_load_dwordx4 v22, s[48:51], s16 offen sc1 lds
v_exp_f32 v168, v168
v_exp_f32 v169, v169
v_exp_f32 v170, v170
v_cvt_pk_bf16_f32 v250, v164, v165
v_cvt_pk_bf16_f32 v251, v166, v167
v_exp_f32 v171, v171
v_exp_f32 v172, v172
v_mfma_f32_32x32x16_bf16 v[192:207], v[116:119], v[248:251], v[192:207]
s_add_u32 m0, s7, 4096
ds_read_b64_tr_b16 v[116:117], v7 offset:28160
ds_read_b64_tr_b16 v[118:119], v8 offset:28160
s_add_u32 s16, s16, 4096
buffer_load_dwordx4 v22, s[48:51], s16 offen sc1 lds
v_exp_f32 v173, v173
v_exp_f32 v174, v174
v_exp_f32 v175, v175
v_cvt_pk_bf16_f32 v252, v168, v169
v_cvt_pk_bf16_f32 v253, v170, v171
v_cvt_pk_bf16_f32 v254, v172, v173
v_cvt_pk_bf16_f32 v255, v174, v175
v_mfma_f32_32x32x16_bf16 v[160:175], v[224:227], v[96:99], 0
s_waitcnt lgkmcnt(2)
s_add_u32 m0, s7, 8192
s_add_u32 s16, s16, 4096
buffer_load_dwordx4 v22, s[48:51], s16 offen sc1 lds
v_exp_f32 v176, v176
v_exp_f32 v177, v177
v_exp_f32 v178, v178
v_exp_f32 v179, v179
v_mfma_f32_32x32x16_bf16 v[192:207], v[120:123], v[252:255], v[192:207]
s_add_u32 m0, s7, 12288
ds_read_b64_tr_b16 v[120:121], v7 offset:28416
ds_read_b64_tr_b16 v[122:123], v8 offset:28416
s_add_u32 s16, s16, 4096
buffer_load_dwordx4 v22, s[48:51], s16 offen sc1 lds
v_exp_f32 v180, v180
v_exp_f32 v181, v181
v_exp_f32 v182, v182
v_exp_f32 v183, v183
v_cvt_pk_bf16_f32 v248, v176, v177
v_cvt_pk_bf16_f32 v249, v178, v179
v_mfma_f32_32x32x16_bf16 v[160:175], v[232:235], v[108:111], v[160:175]
s_waitcnt lgkmcnt(2)
ds_read_b128 v[224:227], v2 offset:39424
ds_read_b128 v[236:239], v4 offset:39424
v_exp_f32 v184, v184
v_exp_f32 v185, v185
v_exp_f32 v186, v186
v_cvt_pk_bf16_f32 v250, v180, v181
v_cvt_pk_bf16_f32 v251, v182, v183
v_exp_f32 v187, v187
v_exp_f32 v188, v188
v_mfma_f32_32x32x16_bf16 v[208:223], v[116:119], v[248:251], v[208:223]
s_add_u32 m0, s7, 16384
ds_read_b64_tr_b16 v[116:117], v5 offset:33792
ds_read_b64_tr_b16 v[118:119], v6 offset:33792
s_add_u32 s16, s16, 4096
buffer_load_dwordx4 v22, s[48:51], s16 offen sc1 lds
v_exp_f32 v189, v189
v_exp_f32 v190, v190
v_exp_f32 v191, v191
v_cvt_pk_bf16_f32 v252, v184, v185
v_cvt_pk_bf16_f32 v253, v186, v187
v_cvt_pk_bf16_f32 v254, v188, v189
v_cvt_pk_bf16_f32 v255, v190, v191
v_mfma_f32_32x32x16_bf16 v[176:191], v[228:231], v[100:103], 0
s_waitcnt lgkmcnt(2)
s_add_u32 m0, s7, 20480
s_add_u32 s16, s16, 4096
buffer_load_dwordx4 v22, s[48:51], s16 offen sc1 lds
v_exp_f32 v160, v160
v_exp_f32 v161, v161
v_exp_f32 v162, v162
v_exp_f32 v163, v163
v_mfma_f32_32x32x16_bf16 v[208:223], v[120:123], v[252:255], v[208:223]
s_add_u32 m0, s7, 24576
ds_read_b64_tr_b16 v[120:121], v5 offset:34048
ds_read_b64_tr_b16 v[122:123], v6 offset:34048
s_add_u32 s16, s16, 4096
buffer_load_dwordx4 v22, s[48:51], s16 offen sc1 lds
v_exp_f32 v164, v164
v_exp_f32 v165, v165
v_exp_f32 v166, v166
v_exp_f32 v167, v167
v_cvt_pk_bf16_f32 v248, v160, v161
v_cvt_pk_bf16_f32 v249, v162, v163
v_mfma_f32_32x32x16_bf16 v[176:191], v[232:235], v[112:115], v[176:191]
s_waitcnt lgkmcnt(2)
ds_read_b128 v[228:231], v3 offset:39424
s_add_u32 m0, s7, 28672
s_add_u32 s16, s16, 4096
buffer_load_dwordx4 v22, s[48:51], s16 offen sc1 lds
v_exp_f32 v168, v168
v_exp_f32 v169, v169
v_exp_f32 v170, v170
v_cvt_pk_bf16_f32 v250, v164, v165
v_cvt_pk_bf16_f32 v251, v166, v167
v_exp_f32 v171, v171
v_exp_f32 v172, v172
v_mfma_f32_32x32x16_bf16 v[192:207], v[116:119], v[248:251], v[192:207]
ds_read_b64_tr_b16 v[116:117], v7 offset:33792
ds_read_b64_tr_b16 v[118:119], v8 offset:33792
v_exp_f32 v173, v173
v_exp_f32 v174, v174
v_exp_f32 v175, v175
v_cvt_pk_bf16_f32 v252, v168, v169
v_cvt_pk_bf16_f32 v253, v170, v171
v_cvt_pk_bf16_f32 v254, v172, v173
v_cvt_pk_bf16_f32 v255, v174, v175
v_mfma_f32_32x32x16_bf16 v[160:175], v[224:227], v[96:99], 0
s_waitcnt lgkmcnt(2)
s_add_u32 m0, s7, 32768
s_add_u32 s16, s16, 4096
buffer_load_dwordx4 v22, s[48:51], s16 offen sc1 lds
v_exp_f32 v176, v176
v_exp_f32 v177, v177
v_exp_f32 v178, v178
v_exp_f32 v179, v179
v_mfma_f32_32x32x16_bf16 v[192:207], v[120:123], v[252:255], v[192:207]
s_add_u32 m0, s7, 36864
ds_read_b64_tr_b16 v[120:121], v7 offset:34048
ds_read_b64_tr_b16 v[122:123], v8 offset:34048
s_add_u32 s16, s16, 4096
buffer_load_dwordx4 v22, s[48:51], s16 offen sc1 lds
v_exp_f32 v180, v180
v_exp_f32 v181, v181
v_exp_f32 v182, v182
v_exp_f32 v183, v183
v_cvt_pk_bf16_f32 v248, v176, v177
v_cvt_pk_bf16_f32 v249, v178, v179
v_mfma_f32_32x32x16_bf16 v[160:175], v[236:239], v[108:111], v[160:175]
s_waitcnt lgkmcnt(2)
ds_read_b128 v[224:227], v2 offset:45056
ds_read_b128 v[232:235], v4 offset:45056
s_add_u32 m0, s7, 40960
s_add_u32 s16, s16, 4096
buffer_load_dwordx4 v22, s[48:51], s16 offen sc1 lds
v_exp_f32 v184, v184
v_exp_f32 v185, v185
v_exp_f32 v186, v186
v_cvt_pk_bf16_f32 v250, v180, v181
v_cvt_pk_bf16_f32 v251, v182, v183
v_exp_f32 v187, v187
v_exp_f32 v188, v188
v_mfma_f32_32x32x16_bf16 v[208:223], v[116:119], v[248:251], v[208:223]
s_add_u32 m0, s7, 45056
ds_read_b64_tr_b16 v[116:117], v5 offset:39424
ds_read_b64_tr_b16 v[118:119], v6 offset:39424
s_add_u32 s16, s16, 4096
buffer_load_dwordx4 v22, s[48:51], s16 offen sc1 lds
v_exp_f32 v189, v189
v_exp_f32 v190, v190
v_exp_f32 v191, v191
v_cvt_pk_bf16_f32 v252, v184, v185
v_cvt_pk_bf16_f32 v253, v186, v187
v_cvt_pk_bf16_f32 v254, v188, v189
v_cvt_pk_bf16_f32 v255, v190, v191
v_mfma_f32_32x32x16_bf16 v[176:191], v[228:231], v[100:103], 0
s_waitcnt lgkmcnt(2)
v_exp_f32 v160, v160
v_exp_f32 v161, v161
v_exp_f32 v162, v162
v_exp_f32 v163, v163
v_mfma_f32_32x32x16_bf16 v[208:223], v[120:123], v[252:255], v[208:223]
s_add_u32 m0, s7, 49152
ds_read_b64_tr_b16 v[120:121], v5 offset:39680
ds_read_b64_tr_b16 v[122:123], v6 offset:39680
s_add_u32 s16, s16, 4096
buffer_load_dwordx4 v22, s[48:51], s16 offen sc1 lds
v_exp_f32 v164, v164
v_exp_f32 v165, v165
v_exp_f32 v166, v166
v_exp_f32 v167, v167
v_cvt_pk_bf16_f32 v248, v160, v161
v_cvt_pk_bf16_f32 v249, v162, v163
v_mfma_f32_32x32x16_bf16 v[176:191], v[236:239], v[112:115], v[176:191]
s_waitcnt lgkmcnt(2)
ds_read_b128 v[228:231], v3 offset:45056
s_add_u32 m0, s7, 53248
s_add_u32 s16, s16, 4096
buffer_load_dwordx4 v22, s[48:51], s16 offen sc1 lds
v_exp_f32 v168, v168
v_exp_f32 v169, v169
v_exp_f32 v170, v170
v_cvt_pk_bf16_f32 v250, v164, v165
v_cvt_pk_bf16_f32 v251, v166, v167
v_exp_f32 v171, v171
v_exp_f32 v172, v172
v_mfma_f32_32x32x16_bf16 v[192:207], v[116:119], v[248:251], v[192:207]
s_add_u32 m0, s7, 57344
ds_read_b64_tr_b16 v[116:117], v7 offset:39424
ds_read_b64_tr_b16 v[118:119], v8 offset:39424
s_add_u32 s16, s16, 4096
buffer_load_dwordx4 v22, s[48:51], s16 offen sc1 lds
v_exp_f32 v173, v173
v_exp_f32 v174, v174
v_exp_f32 v175, v175
v_cvt_pk_bf16_f32 v252, v168, v169
v_cvt_pk_bf16_f32 v253, v170, v171
v_cvt_pk_bf16_f32 v254, v172, v173
v_cvt_pk_bf16_f32 v255, v174, v175
v_mfma_f32_32x32x16_bf16 v[160:175], v[224:227], v[96:99], v[80:95]
s_waitcnt lgkmcnt(2)
s_add_u32 m0, s7, 61440
s_add_u32 s16, s16, 4096
buffer_load_dwordx4 v22, s[48:51], s16 offen sc1 lds
v_exp_f32 v176, v176
v_exp_f32 v177, v177
v_exp_f32 v178, v178
v_exp_f32 v179, v179
v_mfma_f32_32x32x16_bf16 v[192:207], v[120:123], v[252:255], v[192:207]
s_mov_b32 s85, 720896
ds_read_b64_tr_b16 v[120:121], v7 offset:39680
ds_read_b64_tr_b16 v[122:123], v8 offset:39680
buffer_load_dword v63, v59, s[52:55], s85 offen sc1
v_exp_f32 v180, v180
v_exp_f32 v181, v181
v_exp_f32 v182, v182
v_exp_f32 v183, v183
v_cvt_pk_bf16_f32 v248, v176, v177
v_cvt_pk_bf16_f32 v249, v178, v179
v_mfma_f32_32x32x16_bf16 v[160:175], v[232:235], v[108:111], v[160:175]
s_waitcnt lgkmcnt(2)
s_add_u32 m0, s7, 65536
s_add_u32 s16, s16, 4096
buffer_load_dwordx4 v22, s[48:51], s16 offen sc1 lds
v_exp_f32 v184, v184
v_exp_f32 v185, v185
v_exp_f32 v186, v186
v_cvt_pk_bf16_f32 v250, v180, v181
v_cvt_pk_bf16_f32 v251, v182, v183
v_exp_f32 v187, v187
v_exp_f32 v188, v188
v_mfma_f32_32x32x16_bf16 v[208:223], v[116:119], v[248:251], v[208:223]
s_add_u32 m0, s7, 69632
ds_read_b64_tr_b16 v[116:117], v5 offset:45056
ds_read_b64_tr_b16 v[118:119], v6 offset:45056
s_add_u32 s16, s16, 4096
buffer_load_dwordx4 v22, s[48:51], s16 offen sc1 lds
v_exp_f32 v189, v189
v_exp_f32 v190, v190
v_exp_f32 v191, v191
v_cvt_pk_bf16_f32 v252, v184, v185
v_cvt_pk_bf16_f32 v253, v186, v187
v_cvt_pk_bf16_f32 v254, v188, v189
v_cvt_pk_bf16_f32 v255, v190, v191
v_mfma_f32_32x32x16_bf16 v[176:191], v[228:231], v[100:103], v[80:95]
s_waitcnt lgkmcnt(2)
s_add_u32 m0, s7, 73728
s_add_u32 s16, s16, 4096
buffer_load_dwordx4 v22, s[48:51], s16 offen sc1 lds
v_exp_f32 v160, v160
v_exp_f32 v161, v161
v_exp_f32 v162, v162
v_exp_f32 v163, v163
v_mfma_f32_32x32x16_bf16 v[208:223], v[120:123], v[252:255], v[208:223]
s_add_u32 m0, s7, 77824
ds_read_b64_tr_b16 v[120:121], v5 offset:45312
ds_read_b64_tr_b16 v[122:123], v6 offset:45312
s_add_u32 s16, s16, 4096
buffer_load_dwordx4 v22, s[48:51], s16 offen sc1 lds
v_exp_f32 v164, v164
v_exp_f32 v165, v165
v_exp_f32 v166, v166
v_exp_f32 v167, v167
v_cvt_pk_bf16_f32 v248, v160, v161
v_cvt_pk_bf16_f32 v249, v162, v163
v_mfma_f32_32x32x16_bf16 v[176:191], v[232:235], v[112:115], v[176:191]
s_waitcnt lgkmcnt(2)
v_exp_f32 v168, v168
v_exp_f32 v169, v169
v_exp_f32 v170, v170
v_cvt_pk_bf16_f32 v250, v164, v165
v_cvt_pk_bf16_f32 v251, v166, v167
v_exp_f32 v171, v171
v_exp_f32 v172, v172
v_mfma_f32_32x32x16_bf16 v[192:207], v[116:119], v[248:251], v[192:207]
ds_read_b64_tr_b16 v[116:117], v7 offset:45056
ds_read_b64_tr_b16 v[118:119], v8 offset:45056
v_exp_f32 v173, v173
v_exp_f32 v174, v174
v_exp_f32 v175, v175
v_cvt_pk_bf16_f32 v252, v168, v169
v_cvt_pk_bf16_f32 v253, v170, v171
v_cvt_pk_bf16_f32 v254, v172, v173
v_cvt_pk_bf16_f32 v255, v174, v175
s_waitcnt lgkmcnt(2)
v_exp_f32 v176, v176
v_exp_f32 v177, v177
v_exp_f32 v178, v178
v_exp_f32 v179, v179
v_mfma_f32_32x32x16_bf16 v[192:207], v[120:123], v[252:255], v[192:207]
ds_read_b64_tr_b16 v[120:121], v7 offset:45312
ds_read_b64_tr_b16 v[122:123], v8 offset:45312
v_exp_f32 v180, v180
v_exp_f32 v181, v181
v_exp_f32 v182, v182
v_exp_f32 v183, v183
v_cvt_pk_bf16_f32 v248, v176, v177
v_cvt_pk_bf16_f32 v249, v178, v179
s_waitcnt lgkmcnt(2)
v_exp_f32 v184, v184
v_exp_f32 v185, v185
v_exp_f32 v186, v186
v_cvt_pk_bf16_f32 v250, v180, v181
v_cvt_pk_bf16_f32 v251, v182, v183
v_exp_f32 v187, v187
v_exp_f32 v188, v188
v_mfma_f32_32x32x16_bf16 v[208:223], v[116:119], v[248:251], v[208:223]
v_exp_f32 v189, v189
v_exp_f32 v190, v190
v_exp_f32 v191, v191
v_cvt_pk_bf16_f32 v252, v184, v185
v_cvt_pk_bf16_f32 v253, v186, v187
v_cvt_pk_bf16_f32 v254, v188, v189
v_cvt_pk_bf16_f32 v255, v190, v191
s_waitcnt lgkmcnt(0)
s_nop 0
v_mfma_f32_32x32x16_bf16 v[208:223], v[120:123], v[252:255], v[208:223]
s_waitcnt vmcnt(4)
v_cmp_ne_u32 vcc, s72, v63
s_nop 0
s_and_b64 vcc, vcc, s[96:97]
s_cbranch_vccnz L_retry_15
L_back_16:
buffer_load_dwordx4 v[128:131], v14, s[40:43], s15 offen sc1
buffer_load_dwordx4 v[132:135], v15, s[40:43], s15 offen sc1
buffer_load_dwordx4 v[136:139], v16, s[40:43], s15 offen sc1
buffer_load_dwordx4 v[140:143], v17, s[40:43], s15 offen sc1
s_add_u32 s15, s15, 524288
buffer_load_dwordx4 v[144:147], v14, s[40:43], s15 offen sc1
buffer_load_dwordx4 v[148:151], v15, s[40:43], s15 offen sc1
buffer_load_dwordx4 v[152:155], v16, s[40:43], s15 offen sc1
buffer_load_dwordx4 v[156:159], v17, s[40:43], s15 offen sc1
s_add_u32 s15, s15, 524288
v_mov_b32 v36, v200
v_mov_b32 v37, v200
v_mov_b32 v38, v216
v_mov_b32 v39, v216
v_permlane32_swap_b32 v36, v37
s_nop 0
v_permlane32_swap_b32 v38, v39
v_rcp_f32 v36, v37
v_rcp_f32 v38, v39
v_lshl_or_b32 v40, v21, 31, v9
v_pk_mul_f32 v[192:193], v[192:193], v[36:37] op_sel_hi:[1,0]
v_pk_mul_f32 v[194:195], v[194:195], v[36:37] op_sel_hi:[1,0]
v_pk_mul_f32 v[196:197], v[196:197], v[36:37] op_sel_hi:[1,0]
v_pk_mul_f32 v[198:199], v[198:199], v[36:37] op_sel_hi:[1,0]
v_pk_mul_f32 v[200:201], v[200:201], v[36:37] op_sel_hi:[1,0]
v_pk_mul_f32 v[202:203], v[202:203], v[36:37] op_sel_hi:[1,0]
v_cvt_pk_bf16_f32 v24, v192, v193
v_cvt_pk_bf16_f32 v25, v194, v195
v_cvt_pk_bf16_f32 v26, v196, v197
v_cvt_pk_bf16_f32 v27, v198, v199
v_cvt_pk_bf16_f32 v32, v200, v201
v_cvt_pk_bf16_f32 v33, v202, v203
v_permlane32_swap_b32 v24, v26
v_permlane32_swap_b32 v25, v27
buffer_store_dwordx4 v[24:27], v9, s[44:47], s6 offen sc1
s_add_u32 s6, s6, 65536
v_pk_mul_f32 v[208:209], v[208:209], v[38:39] op_sel_hi:[1,0]
v_pk_mul_f32 v[210:211], v[210:211], v[38:39] op_sel_hi:[1,0]
v_pk_mul_f32 v[212:213], v[212:213], v[38:39] op_sel_hi:[1,0]
v_pk_mul_f32 v[214:215], v[214:215], v[38:39] op_sel_hi:[1,0]
v_pk_mul_f32 v[216:217], v[216:217], v[38:39] op_sel_hi:[1,0]
v_pk_mul_f32 v[218:219], v[218:219], v[38:39] op_sel_hi:[1,0]
v_cvt_pk_bf16_f32 v28, v208, v209
v_cvt_pk_bf16_f32 v29, v210, v211
v_cvt_pk_bf16_f32 v30, v212, v213
v_cvt_pk_bf16_f32 v31, v214, v215
v_cvt_pk_bf16_f32 v34, v216, v217
v_cvt_pk_bf16_f32 v35, v218, v219
v_permlane32_swap_b32 v28, v30
v_permlane32_swap_b32 v29, v31
buffer_store_dwordx4 v[28:31], v9, s[44:47], s6 offen sc1
s_add_u32 s6, s6, 65536
buffer_store_dwordx4 v[32:35], v40, s[44:47], s6 offen sc1
buffer_load_dwordx4 v[64:67], v14, s[40:43], s15 offen sc1
buffer_load_dwordx4 v[68:71], v15, s[40:43], s15 offen sc1
buffer_load_dwordx4 v[72:75], v16, s[40:43], s15 offen sc1
buffer_load_dwordx4 v[76:79], v17, s[40:43], s15 offen sc1
s_add_u32 s15, s15, 524288
s_waitcnt vmcnt(14)
v_mfma_f32_16x16x32_bf16 v[160:163], a[0:3], v[128:131], 0
buffer_load_dwordx4 v[80:83], v14, s[40:43], s15 offen sc1
s_lshl_b32 s88, s77, 6
v_mfma_f32_16x16x32_bf16 v[164:167], a[4:7], v[128:131], 0
v_mfma_f32_16x16x32_bf16 v[168:171], a[8:11], v[128:131], 0
s_lshl_b32 s89, s68, 4
v_mfma_f32_16x16x32_bf16 v[172:175], a[12:15], v[128:131], 0
v_mfma_f32_16x16x32_bf16 v[176:179], a[16:19], v[128:131], 0
s_waitcnt vmcnt(14)
buffer_load_dwordx4 v[84:87], v15, s[40:43], s15 offen sc1
s_add_u32 s88, s88, s89
v_mfma_f32_16x16x32_bf16 v[180:183], a[0:3], v[132:135], 0
v_mfma_f32_16x16x32_bf16 v[184:187], a[4:7], v[132:135], 0
s_mul_i32 s88, s88, 1280
v_mfma_f32_16x16x32_bf16 v[188:191], a[8:11], v[132:135], 0
v_mfma_f32_16x16x32_bf16 v[192:195], a[12:15], v[132:135], 0
buffer_load_dwordx4 v[88:91], v16, s[40:43], s15 offen sc1
v_mfma_f32_16x16x32_bf16 v[196:199], a[16:19], v[132:135], 0
s_waitcnt vmcnt(15)
s_mul_i32 s89, s78, 160
v_mfma_f32_16x16x32_bf16 v[200:203], a[0:3], v[136:139], 0
v_add_u32 v51, 0x10000, v58
v_mfma_f32_16x16x32_bf16 v[204:207], a[4:7], v[136:139], 0
s_add_u32 s88, s88, s89
v_add_u32 v60, 143360, v58
v_mfma_f32_16x16x32_bf16 v[208:211], a[8:11], v[136:139], 0
buffer_load_dwordx4 v[92:95], v17, s[40:43], s15 offen sc1
s_add_u32 s15, s15, 524288
v_mfma_f32_16x16x32_bf16 v[212:215], a[12:15], v[136:139], 0
v_add_u32 v38, 0, v0
v_mfma_f32_16x16x32_bf16 v[216:219], a[16:19], v[136:139], 0
s_waitcnt vmcnt(15)
v_mfma_f32_16x16x32_bf16 v[220:223], a[0:3], v[140:143], 0
v_mfma_f32_16x16x32_bf16 v[224:227], a[4:7], v[140:143], 0
buffer_load_dwordx4 v[128:131], v14, s[40:43], s15 offen sc1
v_mul_u32_u24 v39, 0xcd, v38
v_mfma_f32_16x16x32_bf16 v[228:231], a[8:11], v[140:143], 0
v_mfma_f32_16x16x32_bf16 v[232:235], a[12:15], v[140:143], 0
v_lshrrev_b32 v39, 11, v39
v_mfma_f32_16x16x32_bf16 v[236:239], a[16:19], v[140:143], 0
s_waitcnt vmcnt(15)
v_mfma_f32_16x16x32_bf16 v[160:163], a[20:23], v[144:147], v[160:163]
buffer_load_dwordx4 v[132:135], v15, s[40:43], s15 offen sc1
v_mul_u32_u24 v40, 1120, v39
v_mfma_f32_16x16x32_bf16 v[164:167], a[24:27], v[144:147], v[164:167]
v_mfma_f32_16x16x32_bf16 v[168:171], a[28:31], v[144:147], v[168:171]
v_mfma_f32_16x16x32_bf16 v[172:175], a[32:35], v[144:147], v[172:175]
v_lshl_add_u32 v40, v38, 4, v40
v_mfma_f32_16x16x32_bf16 v[176:179], a[36:39], v[144:147], v[176:179]
s_waitcnt vmcnt(15)
buffer_load_dwordx4 v[136:139], v16, s[40:43], s15 offen sc1
v_mfma_f32_16x16x32_bf16 v[180:183], a[20:23], v[148:151], v[180:183]
v_add_u32 v44, s88, v40
v_mfma_f32_16x16x32_bf16 v[184:187], a[24:27], v[148:151], v[184:187]
v_mfma_f32_16x16x32_bf16 v[188:191], a[28:31], v[148:151], v[188:191]
v_add_u32 v38, 64, v0
v_mfma_f32_16x16x32_bf16 v[192:195], a[32:35], v[148:151], v[192:195]
buffer_load_dwordx4 v[140:143], v17, s[40:43], s15 offen sc1
s_add_u32 s15, s15, 524288
v_mfma_f32_16x16x32_bf16 v[196:199], a[36:39], v[148:151], v[196:199]
s_waitcnt vmcnt(16)
v_mfma_f32_16x16x32_bf16 v[200:203], a[20:23], v[152:155], v[200:203]
v_mul_u32_u24 v39, 0xcd, v38
v_mfma_f32_16x16x32_bf16 v[204:207], a[24:27], v[152:155], v[204:207]
v_mfma_f32_16x16x32_bf16 v[208:211], a[28:31], v[152:155], v[208:211]
buffer_load_dwordx4 v[144:147], v14, s[40:43], s15 offen sc1
v_lshrrev_b32 v39, 11, v39
v_mfma_f32_16x16x32_bf16 v[212:215], a[32:35], v[152:155], v[212:215]
v_mfma_f32_16x16x32_bf16 v[216:219], a[36:39], v[152:155], v[216:219]
s_waitcnt vmcnt(16)
v_mul_u32_u24 v40, 1120, v39
v_mfma_f32_16x16x32_bf16 v[220:223], a[20:23], v[156:159], v[220:223]
v_mfma_f32_16x16x32_bf16 v[224:227], a[24:27], v[156:159], v[224:227]
buffer_load_dwordx4 v[148:151], v15, s[40:43], s15 offen sc1
v_mfma_f32_16x16x32_bf16 v[228:231], a[28:31], v[156:159], v[228:231]
v_lshl_add_u32 v40, v38, 4, v40
v_mfma_f32_16x16x32_bf16 v[232:235], a[32:35], v[156:159], v[232:235]
v_mfma_f32_16x16x32_bf16 v[236:239], a[36:39], v[156:159], v[236:239]
s_waitcnt vmcnt(13)
v_add_u32 v45, s88, v40
s_barrier
v_mfma_f32_16x16x32_bf16 v[160:163], a[40:43], v[64:67], v[160:163]
buffer_load_dwordx4 v[152:155], v16, s[40:43], s15 offen sc1
ds_read_b128 a[24:27], v58 offset:0
v_mfma_f32_16x16x32_bf16 v[164:167], a[44:47], v[64:67], v[164:167]
v_add_u32 v38, 128, v0
v_mfma_f32_16x16x32_bf16 v[168:171], a[48:51], v[64:67], v[168:171]
v_mfma_f32_16x16x32_bf16 v[172:175], a[52:55], v[64:67], v[172:175]
v_mfma_f32_16x16x32_bf16 v[176:179], a[56:59], v[64:67], v[176:179]
s_waitcnt vmcnt(13)
buffer_load_dwordx4 v[156:159], v17, s[40:43], s15 offen sc1
s_add_u32 s15, s15, 524288
v_mfma_f32_16x16x32_bf16 v[180:183], a[40:43], v[68:71], v[180:183]
ds_read_b128 a[28:31], v58 offset:1024
v_mul_u32_u24 v39, 0xcd, v38
v_mfma_f32_16x16x32_bf16 v[184:187], a[44:47], v[68:71], v[184:187]
v_lshrrev_b32 v39, 11, v39
v_mfma_f32_16x16x32_bf16 v[188:191], a[48:51], v[68:71], v[188:191]
v_mfma_f32_16x16x32_bf16 v[192:195], a[52:55], v[68:71], v[192:195]
buffer_load_dwordx4 v[64:67], v14, s[40:43], s15 offen sc1
v_mul_u32_u24 v40, 1120, v39
v_mfma_f32_16x16x32_bf16 v[196:199], a[56:59], v[68:71], v[196:199]
s_waitcnt vmcnt(14)
v_mfma_f32_16x16x32_bf16 v[200:203], a[40:43], v[72:75], v[200:203]
ds_read_b128 a[32:35], v58 offset:2048
v_mfma_f32_16x16x32_bf16 v[204:207], a[44:47], v[72:75], v[204:207]
v_lshl_add_u32 v40, v38, 4, v40
v_mfma_f32_16x16x32_bf16 v[208:211], a[48:51], v[72:75], v[208:211]
buffer_load_dwordx4 v[68:71], v15, s[40:43], s15 offen sc1
v_mfma_f32_16x16x32_bf16 v[212:215], a[52:55], v[72:75], v[212:215]
v_add_u32 v46, s88, v40
v_mfma_f32_16x16x32_bf16 v[216:219], a[56:59], v[72:75], v[216:219]
s_waitcnt vmcnt(14)
v_mfma_f32_16x16x32_bf16 v[220:223], a[40:43], v[76:79], v[220:223]
ds_read_b128 a[36:39], v58 offset:3072
v_lshl_or_b32 v46, v21, 31, v46
v_mfma_f32_16x16x32_bf16 v[224:227], a[44:47], v[76:79], v[224:227]
buffer_load_dwordx4 v[72:75], v16, s[40:43], s15 offen sc1
v_mfma_f32_16x16x32_bf16 v[228:231], a[48:51], v[76:79], v[228:231]
v_mfma_f32_16x16x32_bf16 v[232:235], a[52:55], v[76:79], v[232:235]
s_add_u32 s88, s68, 1
v_mfma_f32_16x16x32_bf16 v[236:239], a[56:59], v[76:79], v[236:239]
s_waitcnt vmcnt(14)
v_mfma_f32_16x16x32_bf16 v[160:163], a[60:63], v[80:83], v[160:163]
buffer_load_dwordx4 v[76:79], v17, s[40:43], s15 offen sc1
s_add_u32 s15, s15, 524288
v_mfma_f32_16x16x32_bf16 v[164:167], a[64:67], v[80:83], v[164:167]
s_and_b32 s88, s88, 3
ds_read_b128 a[40:43], v58 offset:4096
v_mfma_f32_16x16x32_bf16 v[168:171], a[68:71], v[80:83], v[168:171]
s_mul_i32 s88, s88, 15360
v_mfma_f32_16x16x32_bf16 v[172:175], a[72:75], v[80:83], v[172:175]
v_mfma_f32_16x16x32_bf16 v[176:179], a[76:79], v[80:83], v[176:179]
s_waitcnt vmcnt(14)
buffer_load_dwordx4 a[0:3], v19, s[48:51], s11 offen sc1
s_add_u32 s11, s11, 20480
v_mfma_f32_16x16x32_bf16 v[180:183], a[60:63], v[84:87], v[180:183]
buffer_load_dwordx4 v[80:83], v14, s[40:43], s15 offen sc1
s_and_b32 s91, s68, 2
s_mul_i32 s91, s91, 5120
s_sub_u32 s11, s11, s91
v_mfma_f32_16x16x32_bf16 v[184:187], a[64:67], v[84:87], v[184:187]
s_add_u32 s88, s88, 92160
v_mfma_f32_16x16x32_bf16 v[188:191], a[68:71], v[84:87], v[188:191]
ds_read_b128 a[44:47], v58 offset:5120
v_add_u32 v47, s88, v58
v_mfma_f32_16x16x32_bf16 v[192:195], a[72:75], v[84:87], v[192:195]
ds_read_b128 a[48:51], v58 offset:6144
v_mfma_f32_16x16x32_bf16 v[196:199], a[76:79], v[84:87], v[196:199]
s_waitcnt vmcnt(15)
s_add_u32 s88, s68, 2
v_mfma_f32_16x16x32_bf16 v[200:203], a[60:63], v[88:91], v[200:203]
buffer_load_dwordx4 v[84:87], v15, s[40:43], s15 offen sc1
v_mfma_f32_16x16x32_bf16 v[204:207], a[64:67], v[88:91], v[204:207]
v_mfma_f32_16x16x32_bf16 v[208:211], a[68:71], v[88:91], v[208:211]
s_and_b32 s88, s88, 3
ds_read_b128 a[52:55], v58 offset:7168
v_mfma_f32_16x16x32_bf16 v[212:215], a[72:75], v[88:91], v[212:215]
v_mfma_f32_16x16x32_bf16 v[216:219], a[76:79], v[88:91], v[216:219]
s_waitcnt vmcnt(15)
s_mul_i32 s88, s88, 15360
v_mfma_f32_16x16x32_bf16 v[220:223], a[60:63], v[92:95], v[220:223]
buffer_load_dwordx4 v[88:91], v16, s[40:43], s15 offen sc1
v_mfma_f32_16x16x32_bf16 v[224:227], a[64:67], v[92:95], v[224:227]
s_add_u32 s88, s88, 87040
ds_read_b128 a[56:59], v58 offset:8192
v_mfma_f32_16x16x32_bf16 v[228:231], a[68:71], v[92:95], v[228:231]
v_mfma_f32_16x16x32_bf16 v[232:235], a[72:75], v[92:95], v[232:235]
v_mfma_f32_16x16x32_bf16 v[236:239], a[76:79], v[92:95], v[236:239]
s_waitcnt vmcnt(15)
v_add_u32 v48, s88, v58
v_mfma_f32_16x16x32_bf16 v[160:163], a[80:83], v[128:131], v[160:163]
buffer_load_dwordx4 v[92:95], v17, s[40:43], s15 offen sc1
s_add_u32 s15, s15, 524288
v_mfma_f32_16x16x32_bf16 v[164:167], a[84:87], v[128:131], v[164:167]
s_add_u32 s88, s68, 3
ds_read_b128 a[60:63], v58 offset:9216
v_mfma_f32_16x16x32_bf16 v[168:171], a[88:91], v[128:131], v[168:171]
v_mfma_f32_16x16x32_bf16 v[172:175], a[92:95], v[128:131], v[172:175]
s_and_b32 s88, s88, 3
v_mov_b32 v43, s72
v_mfma_f32_16x16x32_bf16 v[176:179], a[96:99], v[128:131], v[176:179]
s_waitcnt vmcnt(15)
buffer_load_dwordx4 a[4:7], v57, s[48:51], s11 offen offset:0 sc1
ds_read_b128 a[64:67], v58 offset:10240
v_mfma_f32_16x16x32_bf16 v[180:183], a[80:83], v[132:135], v[180:183]
buffer_load_dwordx4 v[128:131], v14, s[40:43], s15 offen sc1
v_mfma_f32_16x16x32_bf16 v[184:187], a[84:87], v[132:135], v[184:187]
s_mul_i32 s88, s88, 15360
v_mfma_f32_16x16x32_bf16 v[188:191], a[88:91], v[132:135], v[188:191]
v_mfma_f32_16x16x32_bf16 v[192:195], a[92:95], v[132:135], v[192:195]
s_add_u32 s88, s88, 81920
ds_read_b128 a[68:71], v58 offset:11264
v_mfma_f32_16x16x32_bf16 v[196:199], a[96:99], v[132:135], v[196:199]
s_waitcnt vmcnt(16)
s_mov_b64 exec, 1
buffer_store_dword v43, off, s[52:55], s20 sc1
s_mov_b64 exec, -1
v_mfma_f32_16x16x32_bf16 v[200:203], a[80:83], v[136:139], v[200:203]
buffer_load_dwordx4 v[132:135], v15, s[40:43], s15 offen sc1
v_add_u32 v49, s88, v58
v_mfma_f32_16x16x32_bf16 v[204:207], a[84:87], v[136:139], v[204:207]
v_mfma_f32_16x16x32_bf16 v[208:211], a[88:91], v[136:139], v[208:211]
ds_read_b128 a[72:75], v58 offset:12288
v_mfma_f32_16x16x32_bf16 v[212:215], a[92:95], v[136:139], v[212:215]
s_mul_i32 s88, s68, 15360
v_mfma_f32_16x16x32_bf16 v[216:219], a[96:99], v[136:139], v[216:219]
s_waitcnt vmcnt(17)
v_mfma_f32_16x16x32_bf16 v[220:223], a[80:83], v[140:143], v[220:223]
buffer_load_dwordx4 v[136:139], v16, s[40:43], s15 offen sc1
s_add_u32 s88, s88, 81920
v_mfma_f32_16x16x32_bf16 v[224:227], a[84:87], v[140:143], v[224:227]
ds_read_b128 a[76:79], v58 offset:13312
v_mfma_f32_16x16x32_bf16 v[228:231], a[88:91], v[140:143], v[228:231]
v_add_u32 v50, s88, v58
v_mfma_f32_16x16x32_bf16 v[232:235], a[92:95], v[140:143], v[232:235]
v_mfma_f32_16x16x32_bf16 v[236:239], a[96:99], v[140:143], v[236:239]
s_waitcnt vmcnt(17)
v_mfma_f32_16x16x32_bf16 v[160:163], a[100:103], v[144:147], v[160:163]
buffer_load_dwordx4 v[140:143], v17, s[40:43], s15 offen sc1
s_add_u32 s15, s15, 524288
v_mfma_f32_16x16x32_bf16 v[164:167], a[104:107], v[144:147], v[164:167]
ds_read_b128 a[80:83], v58 offset:14336
v_mfma_f32_16x16x32_bf16 v[168:171], a[108:111], v[144:147], v[168:171]
v_mfma_f32_16x16x32_bf16 v[172:175], a[112:115], v[144:147], v[172:175]
v_mfma_f32_16x16x32_bf16 v[176:179], a[116:119], v[144:147], v[176:179]
s_waitcnt vmcnt(17)
buffer_load_dwordx4 a[8:11], v57, s[48:51], s11 offen offset:1024 sc1
ds_read_b128 a[84:87], v58 offset:15360
v_mfma_f32_16x16x32_bf16 v[180:183], a[100:103], v[148:151], v[180:183]
buffer_load_dwordx4 v[144:147], v14, s[40:43], s15 offen sc1
v_mfma_f32_16x16x32_bf16 v[184:187], a[104:107], v[148:151], v[184:187]
v_mfma_f32_16x16x32_bf16 v[188:191], a[108:111], v[148:151], v[188:191]
v_mfma_f32_16x16x32_bf16 v[192:195], a[112:115], v[148:151], v[192:195]
ds_read_b128 a[88:91], v58 offset:16384
v_mfma_f32_16x16x32_bf16 v[196:199], a[116:119], v[148:151], v[196:199]
s_waitcnt vmcnt(18)
v_mfma_f32_16x16x32_bf16 v[200:203], a[100:103], v[152:155], v[200:203]
buffer_load_dwordx4 v[148:151], v15, s[40:43], s15 offen sc1
v_mfma_f32_16x16x32_bf16 v[204:207], a[104:107], v[152:155], v[204:207]
v_mfma_f32_16x16x32_bf16 v[208:211], a[108:111], v[152:155], v[208:211]
ds_read_b128 a[92:95], v58 offset:17408
v_mfma_f32_16x16x32_bf16 v[212:215], a[112:115], v[152:155], v[212:215]
v_mfma_f32_16x16x32_bf16 v[216:219], a[116:119], v[152:155], v[216:219]
s_waitcnt vmcnt(18)
v_mfma_f32_16x16x32_bf16 v[220:223], a[100:103], v[156:159], v[220:223]
buffer_load_dwordx4 v[152:155], v16, s[40:43], s15 offen sc1
v_mfma_f32_16x16x32_bf16 v[224:227], a[104:107], v[156:159], v[224:227]
ds_read_b128 a[96:99], v58 offset:18432
v_mfma_f32_16x16x32_bf16 v[228:231], a[108:111], v[156:159], v[228:231]
v_mfma_f32_16x16x32_bf16 v[232:235], a[112:115], v[156:159], v[232:235]
v_mfma_f32_16x16x32_bf16 v[236:239], a[116:119], v[156:159], v[236:239]
s_waitcnt vmcnt(18)
v_mfma_f32_16x16x32_bf16 v[160:163], a[120:123], v[64:67], v[160:163]
buffer_load_dwordx4 v[156:159], v17, s[40:43], s15 offen sc1
s_add_u32 s15, s15, 524288
v_mfma_f32_16x16x32_bf16 v[164:167], a[124:127], v[64:67], v[164:167]
ds_read_b128 a[100:103], v58 offset:19456
v_mfma_f32_16x16x32_bf16 v[168:171], a[128:131], v[64:67], v[168:171]
v_mfma_f32_16x16x32_bf16 v[172:175], a[132:135], v[64:67], v[172:175]
v_mfma_f32_16x16x32_bf16 v[176:179], a[136:139], v[64:67], v[176:179]
s_waitcnt vmcnt(18)
buffer_load_dwordx4 a[12:15], v57, s[48:51], s11 offen offset:2048 sc1
ds_read_b128 a[104:107], v58 offset:20480
v_mfma_f32_16x16x32_bf16 v[180:183], a[120:123], v[68:71], v[180:183]
buffer_load_dwordx4 v[64:67], v14, s[40:43], s15 offen sc1
v_mfma_f32_16x16x32_bf16 v[184:187], a[124:127], v[68:71], v[184:187]
v_mfma_f32_16x16x32_bf16 v[188:191], a[128:131], v[68:71], v[188:191]
v_mfma_f32_16x16x32_bf16 v[192:195], a[132:135], v[68:71], v[192:195]
ds_read_b128 a[108:111], v58 offset:21504
v_mfma_f32_16x16x32_bf16 v[196:199], a[136:139], v[68:71], v[196:199]
s_waitcnt vmcnt(19)
v_mfma_f32_16x16x32_bf16 v[200:203], a[120:123], v[72:75], v[200:203]
buffer_load_dwordx4 v[68:71], v15, s[40:43], s15 offen sc1
v_mfma_f32_16x16x32_bf16 v[204:207], a[124:127], v[72:75], v[204:207]
v_mfma_f32_16x16x32_bf16 v[208:211], a[128:131], v[72:75], v[208:211]
ds_read_b128 a[112:115], v58 offset:22528
v_mfma_f32_16x16x32_bf16 v[212:215], a[132:135], v[72:75], v[212:215]
v_mfma_f32_16x16x32_bf16 v[216:219], a[136:139], v[72:75], v[216:219]
s_waitcnt vmcnt(19)
v_mfma_f32_16x16x32_bf16 v[220:223], a[120:123], v[76:79], v[220:223]
buffer_load_dwordx4 v[72:75], v16, s[40:43], s15 offen sc1
v_mfma_f32_16x16x32_bf16 v[224:227], a[124:127], v[76:79], v[224:227]
ds_read_b128 a[116:119], v58 offset:23552
v_mfma_f32_16x16x32_bf16 v[228:231], a[128:131], v[76:79], v[228:231]
v_mfma_f32_16x16x32_bf16 v[232:235], a[132:135], v[76:79], v[232:235]
v_mfma_f32_16x16x32_bf16 v[236:239], a[136:139], v[76:79], v[236:239]
s_waitcnt vmcnt(18)
v_mfma_f32_16x16x32_bf16 v[160:163], a[140:143], v[80:83], v[160:163]
buffer_load_dwordx4 v[76:79], v17, s[40:43], s15 offen sc1
s_add_u32 s15, s15, 524288
v_mfma_f32_16x16x32_bf16 v[164:167], a[144:147], v[80:83], v[164:167]
ds_read_b128 a[120:123], v58 offset:24576
v_mfma_f32_16x16x32_bf16 v[168:171], a[148:151], v[80:83], v[168:171]
v_mfma_f32_16x16x32_bf16 v[172:175], a[152:155], v[80:83], v[172:175]
v_mfma_f32_16x16x32_bf16 v[176:179], a[156:159], v[80:83], v[176:179]
s_waitcnt vmcnt(18)
buffer_load_dwordx4 a[16:19], v57, s[48:51], s11 offen offset:3072 sc1
ds_read_b128 a[124:127], v58 offset:25600
v_mfma_f32_16x16x32_bf16 v[180:183], a[140:143], v[84:87], v[180:183]
buffer_load_dwordx4 v[80:83], v14, s[40:43], s15 offen sc1
v_mfma_f32_16x16x32_bf16 v[184:187], a[144:147], v[84:87], v[184:187]
v_mfma_f32_16x16x32_bf16 v[188:191], a[148:151], v[84:87], v[188:191]
v_mfma_f32_16x16x32_bf16 v[192:195], a[152:155], v[84:87], v[192:195]
ds_read_b128 a[128:131], v58 offset:26624
v_mfma_f32_16x16x32_bf16 v[196:199], a[156:159], v[84:87], v[196:199]
s_waitcnt vmcnt(19)
v_mfma_f32_16x16x32_bf16 v[200:203], a[140:143], v[88:91], v[200:203]
buffer_load_dwordx4 v[84:87], v15, s[40:43], s15 offen sc1
v_mfma_f32_16x16x32_bf16 v[204:207], a[144:147], v[88:91], v[204:207]
v_mfma_f32_16x16x32_bf16 v[208:211], a[148:151], v[88:91], v[208:211]
ds_read_b128 a[132:135], v58 offset:27648
v_mfma_f32_16x16x32_bf16 v[212:215], a[152:155], v[88:91], v[212:215]
v_mfma_f32_16x16x32_bf16 v[216:219], a[156:159], v[88:91], v[216:219]
s_waitcnt vmcnt(19)
v_mfma_f32_16x16x32_bf16 v[220:223], a[140:143], v[92:95], v[220:223]
buffer_load_dwordx4 v[88:91], v16, s[40:43], s15 offen sc1
v_mfma_f32_16x16x32_bf16 v[224:227], a[144:147], v[92:95], v[224:227]
ds_read_b128 a[136:139], v58 offset:28672
v_mfma_f32_16x16x32_bf16 v[228:231], a[148:151], v[92:95], v[228:231]
v_mfma_f32_16x16x32_bf16 v[232:235], a[152:155], v[92:95], v[232:235]
v_mfma_f32_16x16x32_bf16 v[236:239], a[156:159], v[92:95], v[236:239]
s_waitcnt vmcnt(18)
v_mfma_f32_16x16x32_bf16 v[160:163], a[160:163], v[128:131], v[160:163]
buffer_load_dwordx4 v[92:95], v17, s[40:43], s15 offen sc1
buffer_load_dwordx4 a[20:23], v19, s[48:51], s11 offen sc1
s_add_u32 s11, s11, 20480
s_add_u32 s15, s15, 524288
v_mfma_f32_16x16x32_bf16 v[164:167], a[164:167], v[128:131], v[164:167]
ds_read_b128 a[140:143], v58 offset:29696
v_mfma_f32_16x16x32_bf16 v[168:171], a[168:171], v[128:131], v[168:171]
v_mfma_f32_16x16x32_bf16 v[172:175], a[172:175], v[128:131], v[172:175]
v_mfma_f32_16x16x32_bf16 v[176:179], a[176:179], v[128:131], v[176:179]
s_waitcnt vmcnt(18)
ds_read_b128 a[144:147], v58 offset:30720
v_mfma_f32_16x16x32_bf16 v[180:183], a[160:163], v[132:135], v[180:183]
buffer_load_dwordx4 v[128:131], v14, s[40:43], s15 offen sc1
v_mfma_f32_16x16x32_bf16 v[184:187], a[164:167], v[132:135], v[184:187]
v_mfma_f32_16x16x32_bf16 v[188:191], a[168:171], v[132:135], v[188:191]
v_mfma_f32_16x16x32_bf16 v[192:195], a[172:175], v[132:135], v[192:195]
ds_read_b128 a[148:151], v58 offset:31744
v_mfma_f32_16x16x32_bf16 v[196:199], a[176:179], v[132:135], v[196:199]
s_waitcnt vmcnt(18)
v_mfma_f32_16x16x32_bf16 v[200:203], a[160:163], v[136:139], v[200:203]
buffer_load_dwordx4 v[132:135], v15, s[40:43], s15 offen sc1
v_mfma_f32_16x16x32_bf16 v[204:207], a[164:167], v[136:139], v[204:207]
v_mfma_f32_16x16x32_bf16 v[208:211], a[168:171], v[136:139], v[208:211]
ds_read_b128 a[152:155], v58 offset:32768
v_mfma_f32_16x16x32_bf16 v[212:215], a[172:175], v[136:139], v[212:215]
v_mfma_f32_16x16x32_bf16 v[216:219], a[176:179], v[136:139], v[216:219]
s_waitcnt vmcnt(18)
v_mfma_f32_16x16x32_bf16 v[220:223], a[160:163], v[140:143], v[220:223]
buffer_load_dwordx4 v[136:139], v16, s[40:43], s15 offen sc1
v_mfma_f32_16x16x32_bf16 v[224:227], a[164:167], v[140:143], v[224:227]
ds_read_b128 a[156:159], v58 offset:33792
v_mfma_f32_16x16x32_bf16 v[228:231], a[168:171], v[140:143], v[228:231]
v_mfma_f32_16x16x32_bf16 v[232:235], a[172:175], v[140:143], v[232:235]
v_mfma_f32_16x16x32_bf16 v[236:239], a[176:179], v[140:143], v[236:239]
s_waitcnt vmcnt(17)
v_mfma_f32_16x16x32_bf16 v[160:163], a[180:183], v[144:147], v[160:163]
buffer_load_dwordx4 v[140:143], v17, s[40:43], s15 offen sc1
s_add_u32 s15, s15, 524288
v_mfma_f32_16x16x32_bf16 v[164:167], a[184:187], v[144:147], v[164:167]
ds_read_b128 a[160:163], v58 offset:34816
v_mfma_f32_16x16x32_bf16 v[168:171], a[188:191], v[144:147], v[168:171]
v_mfma_f32_16x16x32_bf16 v[172:175], a[192:195], v[144:147], v[172:175]
v_mfma_f32_16x16x32_bf16 v[176:179], a[196:199], v[144:147], v[176:179]
s_waitcnt vmcnt(17)
ds_read_b128 a[164:167], v58 offset:35840
v_mfma_f32_16x16x32_bf16 v[180:183], a[180:183], v[148:151], v[180:183]
v_mfma_f32_16x16x32_bf16 v[184:187], a[184:187], v[148:151], v[184:187]
s_and_b32 s91, s68, 2
v_mfma_f32_16x16x32_bf16 v[188:191], a[188:191], v[148:151], v[188:191]
v_mfma_f32_16x16x32_bf16 v[192:195], a[192:195], v[148:151], v[192:195]
s_lshl_b32 s91, s91, 17
ds_read_b128 a[168:171], v58 offset:36864
v_mfma_f32_16x16x32_bf16 v[196:199], a[196:199], v[148:151], v[196:199]
s_waitcnt vmcnt(16)
v_mfma_f32_16x16x32_bf16 v[200:203], a[180:183], v[152:155], v[200:203]
v_mfma_f32_16x16x32_bf16 v[204:207], a[184:187], v[152:155], v[204:207]
s_sub_u32 s15, s15, s91
v_mfma_f32_16x16x32_bf16 v[208:211], a[188:191], v[152:155], v[208:211]
ds_read_b128 a[172:175], v58 offset:37888
v_mfma_f32_16x16x32_bf16 v[212:215], a[192:195], v[152:155], v[212:215]
v_mfma_f32_16x16x32_bf16 v[216:219], a[196:199], v[152:155], v[216:219]
s_waitcnt vmcnt(15)
v_mfma_f32_16x16x32_bf16 v[220:223], a[180:183], v[156:159], v[220:223]
buffer_load_dwordx4 v[152:155], v16, s[40:43], s15 offen sc1
v_mfma_f32_16x16x32_bf16 v[224:227], a[184:187], v[156:159], v[224:227]
ds_read_b128 a[176:179], v58 offset:38912
v_mfma_f32_16x16x32_bf16 v[228:231], a[188:191], v[156:159], v[228:231]
v_mfma_f32_16x16x32_bf16 v[232:235], a[192:195], v[156:159], v[232:235]
v_mfma_f32_16x16x32_bf16 v[236:239], a[196:199], v[156:159], v[236:239]
s_waitcnt vmcnt(14)
v_mfma_f32_16x16x32_bf16 v[160:163], a[200:203], v[64:67], v[160:163]
buffer_load_dwordx4 v[156:159], v17, s[40:43], s15 offen sc1
s_add_u32 s15, s15, 524288
v_mfma_f32_16x16x32_bf16 v[164:167], a[204:207], v[64:67], v[164:167]
ds_read_b128 a[180:183], v58 offset:39936
v_mfma_f32_16x16x32_bf16 v[168:171], a[208:211], v[64:67], v[168:171]
v_mfma_f32_16x16x32_bf16 v[172:175], a[212:215], v[64:67], v[172:175]
v_mfma_f32_16x16x32_bf16 v[176:179], a[216:219], v[64:67], v[176:179]
s_waitcnt vmcnt(14)
ds_read_b128 a[184:187], v58 offset:40960
v_mfma_f32_16x16x32_bf16 v[180:183], a[200:203], v[68:71], v[180:183]
s_add_u32 m0, s7, 143360
s_add_u32 s16, s16, 4096
buffer_load_dwordx4 v22, s[48:51], s16 offen sc1 lds
v_mfma_f32_16x16x32_bf16 v[184:187], a[204:207], v[68:71], v[184:187]
v_mfma_f32_16x16x32_bf16 v[188:191], a[208:211], v[68:71], v[188:191]
v_mfma_f32_16x16x32_bf16 v[192:195], a[212:215], v[68:71], v[192:195]
ds_read_b128 a[188:191], v58 offset:41984
v_mfma_f32_16x16x32_bf16 v[196:199], a[216:219], v[68:71], v[196:199]
s_waitcnt vmcnt(14)
v_mfma_f32_16x16x32_bf16 v[200:203], a[200:203], v[72:75], v[200:203]
s_add_u32 m0, s7, 147456
s_add_u32 s16, s16, 4096
buffer_load_dwordx4 v22, s[48:51], s16 offen sc1 lds
v_mfma_f32_16x16x32_bf16 v[204:207], a[204:207], v[72:75], v[204:207]
v_mfma_f32_16x16x32_bf16 v[208:211], a[208:211], v[72:75], v[208:211]
ds_read_b128 a[192:195], v58 offset:43008
v_mfma_f32_16x16x32_bf16 v[212:215], a[212:215], v[72:75], v[212:215]
v_mfma_f32_16x16x32_bf16 v[216:219], a[216:219], v[72:75], v[216:219]
s_waitcnt vmcnt(14)
v_mfma_f32_16x16x32_bf16 v[220:223], a[200:203], v[76:79], v[220:223]
v_mfma_f32_16x16x32_bf16 v[224:227], a[204:207], v[76:79], v[224:227]
s_add_u32 m0, s7, 151552
s_add_u32 s16, s16, 4096
buffer_load_dwordx4 v22, s[48:51], s16 offen sc1 lds
v_mfma_f32_16x16x32_bf16 v[228:231], a[208:211], v[76:79], v[228:231]
ds_read_b128 a[196:199], v58 offset:44032
v_mfma_f32_16x16x32_bf16 v[232:235], a[212:215], v[76:79], v[232:235]
v_mfma_f32_16x16x32_bf16 v[236:239], a[216:219], v[76:79], v[236:239]
s_waitcnt vmcnt(13)
v_mfma_f32_16x16x32_bf16 v[160:163], a[220:223], v[80:83], v[160:163]
s_mov_b32 s85, 724992
ds_read_b128 a[200:203], v58 offset:45056
v_mfma_f32_16x16x32_bf16 v[164:167], a[224:227], v[80:83], v[164:167]
buffer_load_dword v63, v59, s[52:55], s85 offen sc1
v_mfma_f32_16x16x32_bf16 v[168:171], a[228:231], v[80:83], v[168:171]
v_mfma_f32_16x16x32_bf16 v[172:175], a[232:235], v[80:83], v[172:175]
v_mfma_f32_16x16x32_bf16 v[176:179], a[236:239], v[80:83], v[176:179]
s_waitcnt vmcnt(13)
ds_read_b128 a[204:207], v58 offset:46080
v_mfma_f32_16x16x32_bf16 v[180:183], a[220:223], v[84:87], v[180:183]
s_add_u32 m0, s7, 155648
s_add_u32 s16, s16, 4096
buffer_load_dwordx4 v22, s[48:51], s16 offen sc1 lds
v_mfma_f32_16x16x32_bf16 v[184:187], a[224:227], v[84:87], v[184:187]
v_mfma_f32_16x16x32_bf16 v[188:191], a[228:231], v[84:87], v[188:191]
v_mfma_f32_16x16x32_bf16 v[192:195], a[232:235], v[84:87], v[192:195]
ds_read_b128 a[208:211], v58 offset:47104
v_mfma_f32_16x16x32_bf16 v[196:199], a[236:239], v[84:87], v[196:199]
s_waitcnt vmcnt(13)
v_mfma_f32_16x16x32_bf16 v[200:203], a[220:223], v[88:91], v[200:203]
buffer_load_dwordx4 v[96:99], v44, s[24:27], 0 offen
v_mfma_f32_16x16x32_bf16 v[204:207], a[224:227], v[88:91], v[204:207]
v_mfma_f32_16x16x32_bf16 v[208:211], a[228:231], v[88:91], v[208:211]
s_add_u32 m0, s7, 159744
s_add_u32 s16, s16, 4096
buffer_load_dwordx4 v22, s[48:51], s16 offen sc1 lds
v_mfma_f32_16x16x32_bf16 v[212:215], a[232:235], v[88:91], v[212:215]
buffer_load_dwordx4 v[100:103], v45, s[24:27], 0 offen
ds_read_b128 a[212:215], v58 offset:48128
v_mfma_f32_16x16x32_bf16 v[216:219], a[236:239], v[88:91], v[216:219]
s_waitcnt vmcnt(15)
v_mfma_f32_16x16x32_bf16 v[220:223], a[220:223], v[92:95], v[220:223]
v_mfma_f32_16x16x32_bf16 v[224:227], a[224:227], v[92:95], v[224:227]
buffer_load_dwordx4 v[104:107], v46, s[24:27], 0 offen
ds_read_b128 a[216:219], v58 offset:49152
v_mfma_f32_16x16x32_bf16 v[228:231], a[228:231], v[92:95], v[228:231]
v_mfma_f32_16x16x32_bf16 v[232:235], a[232:235], v[92:95], v[232:235]
v_mfma_f32_16x16x32_bf16 v[236:239], a[236:239], v[92:95], v[236:239]
s_waitcnt vmcnt(14)
v_mfma_f32_16x16x32_bf16 v[160:163], a[240:243], v[128:131], v[160:163]
s_waitcnt vmcnt(5)
v_cmp_ne_u32 vcc, s72, v63
s_nop 0
s_and_b64 vcc, vcc, s[98:99]
s_cbranch_vccnz L_retry_17
L_back_18:
s_mov_b32 s90, 4294836224
v_mfma_f32_16x16x32_bf16 v[164:167], a[244:247], v[128:131], v[164:167]
s_add_u32 s90, s90, 131072
buffer_load_dwordx4 v[240:243], v23, s[44:47], s90 offen sc1
ds_read_b128 a[220:223], v58 offset:50176
v_mfma_f32_16x16x32_bf16 v[168:171], a[248:251], v[128:131], v[168:171]
v_mfma_f32_16x16x32_bf16 v[172:175], a[252:255], v[128:131], v[172:175]
s_add_u32 s90, s90, 131072
buffer_load_dwordx4 v[244:247], v23, s[44:47], s90 offen sc1
v_mfma_f32_16x16x32_bf16 v[176:179], a[0:3], v[128:131], v[176:179]
ds_read_b128 a[224:227], v58 offset:51200
v_mfma_f32_16x16x32_bf16 v[180:183], a[240:243], v[132:135], v[180:183]
s_add_u32 s90, s90, 131072
buffer_load_dwordx4 v[248:251], v23, s[44:47], s90 offen sc1
v_mfma_f32_16x16x32_bf16 v[184:187], a[244:247], v[132:135], v[184:187]
ds_write_b128 v47, v[160:163] offset:0
v_mfma_f32_16x16x32_bf16 v[188:191], a[248:251], v[132:135], v[188:191]
v_mfma_f32_16x16x32_bf16 v[192:195], a[252:255], v[132:135], v[192:195]
s_add_u32 s90, s90, 131072
buffer_load_dwordx4 v[252:255], v23, s[44:47], s90 offen sc1
ds_read_b128 a[228:231], v58 offset:52224
ds_write_b128 v47, v[164:167] offset:1024
v_mfma_f32_16x16x32_bf16 v[196:199], a[0:3], v[132:135], v[196:199]
v_mfma_f32_16x16x32_bf16 v[200:203], a[240:243], v[136:139], v[200:203]
s_add_u32 s90, s90, 131072
buffer_load_dwordx4 v[64:67], v23, s[44:47], s90 offen sc1
ds_write_b128 v47, v[168:171] offset:2048
v_mfma_f32_16x16x32_bf16 v[204:207], a[244:247], v[136:139], v[204:207]
v_mfma_f32_16x16x32_bf16 v[208:211], a[248:251], v[136:139], v[208:211]
ds_read_b128 a[232:235], v58 offset:53248
ds_write_b128 v47, v[172:175] offset:3072
v_mfma_f32_16x16x32_bf16 v[212:215], a[252:255], v[136:139], v[212:215]
s_add_u32 s90, s90, 131072
buffer_load_dwordx4 v[68:71], v23, s[44:47], s90 offen sc1
v_mfma_f32_16x16x32_bf16 v[216:219], a[0:3], v[136:139], v[216:219]
ds_write_b128 v47, v[176:179] offset:4096
v_mfma_f32_16x16x32_bf16 v[200:203], a[4:7], v[152:155], v[200:203]
s_add_u32 s90, s90, 131072
buffer_load_dwordx4 v[72:75], v23, s[44:47], s90 offen sc1
v_mfma_f32_16x16x32_bf16 v[204:207], a[8:11], v[152:155], v[204:207]
ds_read_b128 a[236:239], v58 offset:54272
ds_write_b128 v48, v[180:183] offset:0
v_mfma_f32_16x16x32_bf16 v[208:211], a[12:15], v[152:155], v[208:211]
s_add_u32 s90, s90, 131072
buffer_load_dwordx4 v[76:79], v23, s[44:47], s90 offen sc1
v_mfma_f32_16x16x32_bf16 v[212:215], a[16:19], v[152:155], v[212:215]
ds_write_b128 v48, v[184:187] offset:1024
v_mfma_f32_16x16x32_bf16 v[216:219], a[20:23], v[152:155], v[216:219]
v_mfma_f32_16x16x32_bf16 v[220:223], a[240:243], v[140:143], v[220:223]
s_add_u32 s90, s90, 131072
buffer_load_dwordx4 v[80:83], v23, s[44:47], s90 offen sc1
ds_write_b128 v48, v[188:191] offset:2048
v_mfma_f32_16x16x32_bf16 v[224:227], a[244:247], v[140:143], v[224:227]
v_mfma_f32_16x16x32_bf16 v[228:231], a[248:251], v[140:143], v[228:231]
s_add_u32 s90, s90, 131072
buffer_load_dwordx4 v[84:87], v23, s[44:47], s90 offen sc1
ds_write_b128 v48, v[192:195] offset:3072
v_mfma_f32_16x16x32_bf16 v[232:235], a[252:255], v[140:143], v[232:235]
v_mfma_f32_16x16x32_bf16 v[236:239], a[0:3], v[140:143], v[236:239]
ds_write_b128 v48, v[196:199] offset:4096
v_mfma_f32_16x16x32_bf16 v[220:223], a[4:7], v[156:159], v[220:223]
s_add_u32 s90, s90, 131072
buffer_load_dwordx4 v[88:91], v23, s[44:47], s90 offen sc1
ds_read_b128 a[240:243], v58 offset:55296
v_mfma_f32_16x16x32_bf16 v[224:227], a[8:11], v[156:159], v[224:227]
ds_read_b128 a[244:247], v58 offset:56320
ds_write_b128 v49, v[200:203] offset:0
v_mfma_f32_16x16x32_bf16 v[228:231], a[12:15], v[156:159], v[228:231]
s_add_u32 s90, s90, 131072
buffer_load_dwordx4 v[92:95], v23, s[44:47], s90 offen sc1
ds_read_b128 a[248:251], v58 offset:57344
v_mfma_f32_16x16x32_bf16 v[232:235], a[16:19], v[156:159], v[232:235]
ds_read_b128 a[252:255], v58 offset:58368
ds_write_b128 v49, v[204:207] offset:1024
v_mfma_f32_16x16x32_bf16 v[236:239], a[20:23], v[156:159], v[236:239]
ds_write_b128 v49, v[208:211] offset:2048
ds_write_b128 v49, v[212:215] offset:3072
ds_write_b128 v49, v[216:219] offset:4096
s_waitcnt vmcnt(14) lgkmcnt(0)
s_barrier
ds_read_b128 v[160:163], v50 offset:0
ds_read_b128 v[164:167], v50 offset:1024
ds_read_b128 v[168:171], v50 offset:2048
ds_read_b128 v[172:175], v50 offset:3072
ds_read_b128 v[176:179], v50 offset:4096
ds_read_b128 v[180:183], v50 offset:5120
ds_read_b128 v[184:187], v50 offset:6144
ds_read_b128 v[188:191], v50 offset:7168
ds_read_b128 v[192:195], v50 offset:8192
ds_read_b128 v[196:199], v50 offset:9216
ds_read_b128 v[200:203], v50 offset:10240
ds_read_b128 v[204:207], v50 offset:11264
ds_read_b128 v[208:211], v50 offset:12288
ds_read_b128 v[212:215], v50 offset:13312
ds_read_b128 v[216:219], v50 offset:14336
s_waitcnt vmcnt(11)
v_mfma_f32_16x16x32_bf16 v[108:111], a[24:27], v[240:243], 0
s_add_u32 s90, s90, 131072
buffer_load_dwordx4 v[128:131], v23, s[44:47], s90 offen sc1
v_lshlrev_b32 v24, 16, v96
v_mfma_f32_16x16x32_bf16 v[112:115], a[28:31], v[240:243], 0
v_and_b32 v25, 0xffff0000, v96
v_lshlrev_b32 v26, 16, v97
v_mfma_f32_16x16x32_bf16 v[116:119], a[32:35], v[240:243], 0
v_and_b32 v27, 0xffff0000, v97
v_lshlrev_b32 v28, 16, v98
v_mfma_f32_16x16x32_bf16 v[120:123], a[36:39], v[240:243], 0
v_and_b32 v29, 0xffff0000, v98
v_lshlrev_b32 v30, 16, v99
v_mfma_f32_16x16x32_bf16 v[124:127], a[40:43], v[240:243], 0
s_waitcnt vmcnt(11)
v_and_b32 v31, 0xffff0000, v99
v_mfma_f32_16x16x32_bf16 v[108:111], a[44:47], v[244:247], v[108:111]
s_add_u32 s90, s90, 131072
buffer_load_dwordx4 v[132:135], v23, s[44:47], s90 offen sc1
v_lshlrev_b32 v32, 16, v100
v_mfma_f32_16x16x32_bf16 v[112:115], a[48:51], v[244:247], v[112:115]
v_and_b32 v33, 0xffff0000, v100
v_lshlrev_b32 v34, 16, v101
v_mfma_f32_16x16x32_bf16 v[116:119], a[52:55], v[244:247], v[116:119]
v_and_b32 v35, 0xffff0000, v101
v_lshlrev_b32 v36, 16, v102
v_mfma_f32_16x16x32_bf16 v[120:123], a[56:59], v[244:247], v[120:123]
v_and_b32 v37, 0xffff0000, v102
v_lshlrev_b32 v40, 16, v103
v_mfma_f32_16x16x32_bf16 v[124:127], a[60:63], v[244:247], v[124:127]
s_waitcnt vmcnt(11)
v_and_b32 v41, 0xffff0000, v103
v_mfma_f32_16x16x32_bf16 v[108:111], a[64:67], v[248:251], v[108:111]
s_add_u32 s90, s90, 131072
buffer_load_dwordx4 v[136:139], v23, s[44:47], s90 offen sc1
v_lshlrev_b32 v42, 16, v104
v_mfma_f32_16x16x32_bf16 v[112:115], a[68:71], v[248:251], v[112:115]
v_and_b32 v43, 0xffff0000, v104
v_lshlrev_b32 v52, 16, v105
v_mfma_f32_16x16x32_bf16 v[116:119], a[72:75], v[248:251], v[116:119]
v_and_b32 v53, 0xffff0000, v105
v_lshlrev_b32 v54, 16, v106
v_mfma_f32_16x16x32_bf16 v[120:123], a[76:79], v[248:251], v[120:123]
v_and_b32 v55, 0xffff0000, v106
v_lshlrev_b32 v56, 16, v107
v_mfma_f32_16x16x32_bf16 v[124:127], a[80:83], v[248:251], v[124:127]
s_waitcnt vmcnt(11)
v_and_b32 v57, 0xffff0000, v107
v_mov_b32 v38, 0xbfb8aa3b
s_waitcnt lgkmcnt(10)
v_pk_add_f32 v[220:221], v[220:221], v[160:161]
v_pk_add_f32 v[222:223], v[222:223], v[162:163]
v_pk_add_f32 v[224:225], v[224:225], v[164:165]
v_pk_add_f32 v[226:227], v[226:227], v[166:167]
v_pk_add_f32 v[228:229], v[228:229], v[168:169]
v_pk_add_f32 v[230:231], v[230:231], v[170:171]
v_pk_add_f32 v[232:233], v[232:233], v[172:173]
v_pk_add_f32 v[234:235], v[234:235], v[174:175]
v_pk_add_f32 v[236:237], v[236:237], v[176:177]
v_pk_add_f32 v[238:239], v[238:239], v[178:179]
s_waitcnt lgkmcnt(5)
v_pk_add_f32 v[220:221], v[220:221], v[180:181]
v_pk_add_f32 v[222:223], v[222:223], v[182:183]
v_pk_add_f32 v[224:225], v[224:225], v[184:185]
v_pk_add_f32 v[226:227], v[226:227], v[186:187]
v_pk_add_f32 v[228:229], v[228:229], v[188:189]
v_pk_add_f32 v[230:231], v[230:231], v[190:191]
v_pk_add_f32 v[232:233], v[232:233], v[192:193]
v_pk_add_f32 v[234:235], v[234:235], v[194:195]
v_pk_add_f32 v[236:237], v[236:237], v[196:197]
v_pk_add_f32 v[238:239], v[238:239], v[198:199]
s_waitcnt lgkmcnt(0)
v_pk_add_f32 v[220:221], v[220:221], v[200:201]
v_pk_add_f32 v[222:223], v[222:223], v[202:203]
v_pk_add_f32 v[224:225], v[224:225], v[204:205]
v_pk_add_f32 v[226:227], v[226:227], v[206:207]
v_pk_add_f32 v[228:229], v[228:229], v[208:209]
v_pk_add_f32 v[230:231], v[230:231], v[210:211]
v_pk_add_f32 v[232:233], v[232:233], v[212:213]
v_pk_add_f32 v[234:235], v[234:235], v[214:215]
v_pk_add_f32 v[236:237], v[236:237], v[216:217]
v_pk_add_f32 v[238:239], v[238:239], v[218:219]
v_pk_mul_f32 v[160:161], v[220:221], v[38:39] op_sel_hi:[1,0]
v_pk_mul_f32 v[162:163], v[222:223], v[38:39] op_sel_hi:[1,0]
v_pk_mul_f32 v[164:165], v[224:225], v[38:39] op_sel_hi:[1,0]
v_pk_mul_f32 v[166:167], v[226:227], v[38:39] op_sel_hi:[1,0]
v_pk_mul_f32 v[168:169], v[228:229], v[38:39] op_sel_hi:[1,0]
v_pk_mul_f32 v[170:171], v[230:231], v[38:39] op_sel_hi:[1,0]
v_pk_mul_f32 v[172:173], v[232:233], v[38:39] op_sel_hi:[1,0]
v_pk_mul_f32 v[174:175], v[234:235], v[38:39] op_sel_hi:[1,0]
v_pk_mul_f32 v[176:177], v[236:237], v[38:39] op_sel_hi:[1,0]
v_pk_mul_f32 v[178:179], v[238:239], v[38:39] op_sel_hi:[1,0]
v_mfma_f32_16x16x32_bf16 v[108:111], a[84:87], v[252:255], v[108:111]
s_add_u32 s90, s90, 131072
ds_read_b128 a[0:3], v58 offset:59392
buffer_load_dwordx4 v[140:143], v23, s[44:47], s90 offen sc1
v_mfma_f32_16x16x32_bf16 v[112:115], a[88:91], v[252:255], v[112:115]
ds_read_b128 a[4:7], v58 offset:60416
v_exp_f32 v160, v160
v_mfma_f32_16x16x32_bf16 v[116:119], a[92:95], v[252:255], v[116:119]
ds_read_b128 a[8:11], v58 offset:61440
v_mfma_f32_16x16x32_bf16 v[120:123], a[96:99], v[252:255], v[120:123]
ds_read_b128 a[12:15], v58 offset:62464
v_exp_f32 v161, v161
v_mfma_f32_16x16x32_bf16 v[124:127], a[100:103], v[252:255], v[124:127]
s_waitcnt vmcnt(11)
ds_read_b128 a[16:19], v58 offset:63488
v_mfma_f32_16x16x32_bf16 v[108:111], a[104:107], v[64:67], v[108:111]
s_add_u32 s90, s90, 131072
ds_read_b128 a[20:23], v58 offset:64512
buffer_load_dwordx4 v[144:147], v23, s[44:47], s90 offen sc1
v_mfma_f32_16x16x32_bf16 v[112:115], a[108:111], v[64:67], v[112:115]
ds_read_b128 a[24:27], v51 offset:0
v_exp_f32 v162, v162
v_mfma_f32_16x16x32_bf16 v[116:119], a[112:115], v[64:67], v[116:119]
ds_read_b128 a[28:31], v51 offset:1024
v_mfma_f32_16x16x32_bf16 v[120:123], a[116:119], v[64:67], v[120:123]
ds_read_b128 a[32:35], v51 offset:2048
v_exp_f32 v163, v163
v_mfma_f32_16x16x32_bf16 v[124:127], a[120:123], v[64:67], v[124:127]
s_waitcnt vmcnt(11)
ds_read_b128 a[36:39], v51 offset:3072
v_mfma_f32_16x16x32_bf16 v[108:111], a[124:127], v[68:71], v[108:111]
s_add_u32 s90, s90, 131072
ds_read_b128 a[40:43], v51 offset:4096
buffer_load_dwordx4 v[148:151], v23, s[44:47], s90 offen sc1
v_mfma_f32_16x16x32_bf16 v[112:115], a[128:131], v[68:71], v[112:115]
ds_read_b128 a[44:47], v51 offset:5120
v_exp_f32 v164, v164
v_mfma_f32_16x16x32_bf16 v[116:119], a[132:135], v[68:71], v[116:119]
ds_read_b128 a[48:51], v51 offset:6144
v_mfma_f32_16x16x32_bf16 v[120:123], a[136:139], v[68:71], v[120:123]
ds_read_b128 a[52:55], v51 offset:7168
v_exp_f32 v165, v165
v_mfma_f32_16x16x32_bf16 v[124:127], a[140:143], v[68:71], v[124:127]
s_waitcnt vmcnt(11)
ds_read_b128 a[56:59], v51 offset:8192
v_mfma_f32_16x16x32_bf16 v[108:111], a[144:147], v[72:75], v[108:111]
s_add_u32 s90, s90, 131072
ds_read_b128 a[60:63], v51 offset:9216
buffer_load_dwordx4 v[152:155], v23, s[44:47], s90 offen sc1
v_mfma_f32_16x16x32_bf16 v[112:115], a[148:151], v[72:75], v[112:115]
ds_read_b128 a[64:67], v51 offset:10240
v_exp_f32 v166, v166
v_mfma_f32_16x16x32_bf16 v[116:119], a[152:155], v[72:75], v[116:119]
ds_read_b128 a[68:71], v51 offset:11264
v_mfma_f32_16x16x32_bf16 v[120:123], a[156:159], v[72:75], v[120:123]
ds_read_b128 a[72:75], v51 offset:12288
v_exp_f32 v167, v167
v_mfma_f32_16x16x32_bf16 v[124:127], a[160:163], v[72:75], v[124:127]
s_waitcnt vmcnt(11)
ds_read_b128 a[76:79], v51 offset:13312
v_mfma_f32_16x16x32_bf16 v[108:111], a[164:167], v[76:79], v[108:111]
s_add_u32 s90, s90, 131072
ds_read_b128 a[80:83], v51 offset:14336
buffer_load_dwordx4 v[156:159], v23, s[44:47], s90 offen sc1
v_mfma_f32_16x16x32_bf16 v[112:115], a[168:171], v[76:79], v[112:115]
ds_read_b128 a[84:87], v51 offset:15360
v_exp_f32 v168, v168
v_mfma_f32_16x16x32_bf16 v[116:119], a[172:175], v[76:79], v[116:119]
ds_read_b128 a[88:91], v60 offset:0
v_mfma_f32_16x16x32_bf16 v[120:123], a[176:179], v[76:79], v[120:123]
ds_read_b128 a[92:95], v60 offset:1024
v_exp_f32 v169, v169
v_mfma_f32_16x16x32_bf16 v[124:127], a[180:183], v[76:79], v[124:127]
s_waitcnt vmcnt(11)
ds_read_b128 a[96:99], v60 offset:2048
v_mfma_f32_16x16x32_bf16 v[108:111], a[184:187], v[80:83], v[108:111]
ds_read_b128 a[100:103], v60 offset:3072
v_exp_f32 v170, v170
v_mfma_f32_16x16x32_bf16 v[112:115], a[188:191], v[80:83], v[112:115]
ds_read_b128 a[104:107], v60 offset:4096
v_mfma_f32_16x16x32_bf16 v[116:119], a[192:195], v[80:83], v[116:119]
ds_read_b128 a[108:111], v60 offset:5120
v_exp_f32 v171, v171
v_mfma_f32_16x16x32_bf16 v[120:123], a[196:199], v[80:83], v[120:123]
ds_read_b128 a[112:115], v60 offset:6144
v_mfma_f32_16x16x32_bf16 v[124:127], a[200:203], v[80:83], v[124:127]
s_waitcnt vmcnt(10)
ds_read_b128 a[116:119], v60 offset:7168
v_exp_f32 v172, v172
v_mfma_f32_16x16x32_bf16 v[108:111], a[204:207], v[84:87], v[108:111]
ds_read_b128 a[120:123], v60 offset:8192
v_mfma_f32_16x16x32_bf16 v[112:115], a[208:211], v[84:87], v[112:115]
ds_read_b128 a[124:127], v60 offset:9216
v_exp_f32 v173, v173
v_mfma_f32_16x16x32_bf16 v[116:119], a[212:215], v[84:87], v[116:119]
ds_read_b128 a[128:131], v60 offset:10240
v_mfma_f32_16x16x32_bf16 v[120:123], a[216:219], v[84:87], v[120:123]
ds_read_b128 a[132:135], v60 offset:11264
v_exp_f32 v174, v174
v_mfma_f32_16x16x32_bf16 v[124:127], a[220:223], v[84:87], v[124:127]
s_waitcnt vmcnt(9)
ds_read_b128 a[136:139], v60 offset:12288
v_mfma_f32_16x16x32_bf16 v[108:111], a[224:227], v[88:91], v[108:111]
ds_read_b128 a[140:143], v60 offset:13312
v_exp_f32 v175, v175
v_mfma_f32_16x16x32_bf16 v[112:115], a[228:231], v[88:91], v[112:115]
ds_read_b128 a[144:147], v60 offset:14336
v_mfma_f32_16x16x32_bf16 v[116:119], a[232:235], v[88:91], v[116:119]
ds_read_b128 a[148:151], v60 offset:15360
v_exp_f32 v176, v176
v_mfma_f32_16x16x32_bf16 v[120:123], a[236:239], v[88:91], v[120:123]
ds_read_b128 a[152:155], v60 offset:16384
v_mfma_f32_16x16x32_bf16 v[124:127], a[240:243], v[88:91], v[124:127]
s_waitcnt vmcnt(8) lgkmcnt(15)
ds_read_b128 a[156:159], v60 offset:17408
v_mfma_f32_16x16x32_bf16 v[108:111], a[244:247], v[92:95], v[108:111]
ds_read_b128 a[160:163], v60 offset:18432
v_mfma_f32_16x16x32_bf16 v[112:115], a[248:251], v[92:95], v[112:115]
ds_read_b128 a[164:167], v60 offset:19456
v_mfma_f32_16x16x32_bf16 v[116:119], a[252:255], v[92:95], v[116:119]
v_exp_f32 v177, v177
v_mfma_f32_16x16x32_bf16 v[120:123], a[0:3], v[92:95], v[120:123]
v_exp_f32 v178, v178
v_mfma_f32_16x16x32_bf16 v[124:127], a[4:7], v[92:95], v[124:127]
s_waitcnt vmcnt(7)
v_exp_f32 v179, v179
v_mfma_f32_16x16x32_bf16 v[108:111], a[8:11], v[128:131], v[108:111]
v_add_f32 v160, 1.0, v160
v_add_f32 v161, 1.0, v161
v_mfma_f32_16x16x32_bf16 v[112:115], a[12:15], v[128:131], v[112:115]
v_add_f32 v162, 1.0, v162
v_add_f32 v163, 1.0, v163
v_mfma_f32_16x16x32_bf16 v[116:119], a[16:19], v[128:131], v[116:119]
v_add_f32 v164, 1.0, v164
v_add_f32 v165, 1.0, v165
v_mfma_f32_16x16x32_bf16 v[120:123], a[20:23], v[128:131], v[120:123]
v_add_f32 v166, 1.0, v166
v_add_f32 v167, 1.0, v167
v_mfma_f32_16x16x32_bf16 v[124:127], a[24:27], v[128:131], v[124:127]
s_waitcnt vmcnt(6)
v_add_f32 v168, 1.0, v168
v_add_f32 v169, 1.0, v169
v_mfma_f32_16x16x32_bf16 v[108:111], a[28:31], v[132:135], v[108:111]
v_add_f32 v170, 1.0, v170
v_add_f32 v171, 1.0, v171
v_mfma_f32_16x16x32_bf16 v[112:115], a[32:35], v[132:135], v[112:115]
v_add_f32 v172, 1.0, v172
v_add_f32 v173, 1.0, v173
v_mfma_f32_16x16x32_bf16 v[116:119], a[36:39], v[132:135], v[116:119]
v_add_f32 v174, 1.0, v174
v_add_f32 v175, 1.0, v175
v_mfma_f32_16x16x32_bf16 v[120:123], a[40:43], v[132:135], v[120:123]
v_add_f32 v176, 1.0, v176
v_add_f32 v177, 1.0, v177
v_mfma_f32_16x16x32_bf16 v[124:127], a[44:47], v[132:135], v[124:127]
s_waitcnt vmcnt(5)
v_add_f32 v178, 1.0, v178
v_add_f32 v179, 1.0, v179
v_mfma_f32_16x16x32_bf16 v[108:111], a[48:51], v[136:139], v[108:111]
v_rcp_f32 v160, v160
v_mfma_f32_16x16x32_bf16 v[112:115], a[52:55], v[136:139], v[112:115]
v_rcp_f32 v161, v161
v_mfma_f32_16x16x32_bf16 v[116:119], a[56:59], v[136:139], v[116:119]
v_rcp_f32 v162, v162
v_mfma_f32_16x16x32_bf16 v[120:123], a[60:63], v[136:139], v[120:123]
v_rcp_f32 v163, v163
v_mfma_f32_16x16x32_bf16 v[124:127], a[64:67], v[136:139], v[124:127]
s_waitcnt vmcnt(4)
v_rcp_f32 v164, v164
v_mfma_f32_16x16x32_bf16 v[108:111], a[68:71], v[140:143], v[108:111]
v_rcp_f32 v165, v165
v_mfma_f32_16x16x32_bf16 v[112:115], a[72:75], v[140:143], v[112:115]
v_rcp_f32 v166, v166
v_mfma_f32_16x16x32_bf16 v[116:119], a[76:79], v[140:143], v[116:119]
v_rcp_f32 v167, v167
v_mfma_f32_16x16x32_bf16 v[120:123], a[80:83], v[140:143], v[120:123]
v_rcp_f32 v168, v168
v_mfma_f32_16x16x32_bf16 v[124:127], a[84:87], v[140:143], v[124:127]
s_waitcnt vmcnt(3) lgkmcnt(15)
v_rcp_f32 v169, v169
v_mfma_f32_16x16x32_bf16 v[108:111], a[88:91], v[144:147], v[108:111]
v_rcp_f32 v170, v170
v_mfma_f32_16x16x32_bf16 v[112:115], a[92:95], v[144:147], v[112:115]
v_rcp_f32 v171, v171
v_mfma_f32_16x16x32_bf16 v[116:119], a[96:99], v[144:147], v[116:119]
v_rcp_f32 v172, v172
v_mfma_f32_16x16x32_bf16 v[120:123], a[100:103], v[144:147], v[120:123]
v_rcp_f32 v173, v173
v_mfma_f32_16x16x32_bf16 v[124:127], a[104:107], v[144:147], v[124:127]
s_waitcnt vmcnt(2) lgkmcnt(10)
v_rcp_f32 v174, v174
v_mfma_f32_16x16x32_bf16 v[108:111], a[108:111], v[148:151], v[108:111]
v_rcp_f32 v175, v175
v_mfma_f32_16x16x32_bf16 v[112:115], a[112:115], v[148:151], v[112:115]
v_rcp_f32 v176, v176
v_mfma_f32_16x16x32_bf16 v[116:119], a[116:119], v[148:151], v[116:119]
v_rcp_f32 v177, v177
v_mfma_f32_16x16x32_bf16 v[120:123], a[120:123], v[148:151], v[120:123]
v_rcp_f32 v178, v178
v_mfma_f32_16x16x32_bf16 v[124:127], a[124:127], v[148:151], v[124:127]
s_waitcnt vmcnt(1) lgkmcnt(5)
v_rcp_f32 v179, v179
v_mfma_f32_16x16x32_bf16 v[108:111], a[128:131], v[152:155], v[108:111]
v_mfma_f32_16x16x32_bf16 v[112:115], a[132:135], v[152:155], v[112:115]
v_and_b32 v61, 15, v0
v_mfma_f32_16x16x32_bf16 v[116:119], a[136:139], v[152:155], v[116:119]
v_mul_u32_u24 v61, 0xa0, v61
v_mfma_f32_16x16x32_bf16 v[120:123], a[140:143], v[152:155], v[120:123]
v_lshrrev_b32 v62, 4, v0
v_mfma_f32_16x16x32_bf16 v[124:127], a[144:147], v[152:155], v[124:127]
s_waitcnt vmcnt(0) lgkmcnt(0)
v_lshl_add_u32 v61, v62, 3, v61
v_mfma_f32_16x16x32_bf16 v[108:111], a[148:151], v[156:159], v[108:111]
v_mfma_f32_16x16x32_bf16 v[112:115], a[152:155], v[156:159], v[112:115]
s_mul_i32 s88, s68, 15360
v_mfma_f32_16x16x32_bf16 v[116:119], a[156:159], v[156:159], v[116:119]
s_add_u32 s88, s88, 81920
v_mfma_f32_16x16x32_bf16 v[120:123], a[160:163], v[156:159], v[120:123]
v_add_u32 v49, s88, v61
v_mfma_f32_16x16x32_bf16 v[124:127], a[164:167], v[156:159], v[124:127]
v_pk_mul_f32 v[220:221], v[220:221], v[160:161]
v_pk_mul_f32 v[222:223], v[222:223], v[162:163]
v_pk_mul_f32 v[224:225], v[224:225], v[164:165]
v_pk_mul_f32 v[226:227], v[226:227], v[166:167]
v_pk_mul_f32 v[228:229], v[228:229], v[168:169]
v_pk_mul_f32 v[230:231], v[230:231], v[170:171]
v_pk_mul_f32 v[232:233], v[232:233], v[172:173]
v_pk_mul_f32 v[234:235], v[234:235], v[174:175]
v_pk_mul_f32 v[236:237], v[236:237], v[176:177]
v_pk_mul_f32 v[238:239], v[238:239], v[178:179]
v_pk_mul_f32 v[108:109], v[108:109], v[220:221]
v_pk_mul_f32 v[110:111], v[110:111], v[222:223]
v_cvt_pk_bf16_f32 v180, v108, v109
v_cvt_pk_bf16_f32 v181, v110, v111
v_pk_mul_f32 v[112:113], v[112:113], v[224:225]
v_pk_mul_f32 v[114:115], v[114:115], v[226:227]
v_cvt_pk_bf16_f32 v182, v112, v113
v_cvt_pk_bf16_f32 v183, v114, v115
v_pk_mul_f32 v[116:117], v[116:117], v[228:229]
v_pk_mul_f32 v[118:119], v[118:119], v[230:231]
v_cvt_pk_bf16_f32 v184, v116, v117
v_cvt_pk_bf16_f32 v185, v118, v119
v_pk_mul_f32 v[120:121], v[120:121], v[232:233]
v_pk_mul_f32 v[122:123], v[122:123], v[234:235]
v_cvt_pk_bf16_f32 v186, v120, v121
v_cvt_pk_bf16_f32 v187, v122, v123
v_pk_mul_f32 v[124:125], v[124:125], v[236:237]
v_pk_mul_f32 v[126:127], v[126:127], v[238:239]
v_cvt_pk_bf16_f32 v188, v124, v125
v_cvt_pk_bf16_f32 v189, v126, v127
ds_write_b64 v49, v[180:181] offset:0
ds_write_b64 v49, v[182:183] offset:32
ds_write_b64 v49, v[184:185] offset:64
ds_write_b64 v49, v[186:187] offset:96
ds_write_b64 v49, v[188:189] offset:128
ds_read_b128 v[108:111], v50 offset:0
ds_read_b128 v[112:115], v50 offset:1024
ds_read_b128 v[116:119], v50 offset:2048
s_waitcnt lgkmcnt(2)
v_lshlrev_b32 v192, 16, v108
v_and_b32 v193, 0xffff0000, v108
v_lshlrev_b32 v194, 16, v109
v_and_b32 v195, 0xffff0000, v109
v_lshlrev_b32 v196, 16, v110
v_and_b32 v197, 0xffff0000, v110
v_lshlrev_b32 v198, 16, v111
v_and_b32 v199, 0xffff0000, v111
v_pk_add_f32 v[192:193], v[192:193], v[24:25]
v_pk_add_f32 v[194:195], v[194:195], v[26:27]
v_pk_add_f32 v[196:197], v[196:197], v[28:29]
v_pk_add_f32 v[198:199], v[198:199], v[30:31]
v_cvt_pk_bf16_f32 v108, v192, v193
v_cvt_pk_bf16_f32 v109, v194, v195
v_cvt_pk_bf16_f32 v110, v196, v197
v_cvt_pk_bf16_f32 v111, v198, v199
buffer_store_dwordx4 v[108:111], v44, s[56:59], 0 offen
s_waitcnt lgkmcnt(1)
v_lshlrev_b32 v200, 16, v112
v_and_b32 v201, 0xffff0000, v112
v_lshlrev_b32 v202, 16, v113
v_and_b32 v203, 0xffff0000, v113
v_lshlrev_b32 v204, 16, v114
v_and_b32 v205, 0xffff0000, v114
v_lshlrev_b32 v206, 16, v115
v_and_b32 v207, 0xffff0000, v115
v_pk_add_f32 v[200:201], v[200:201], v[32:33]
v_pk_add_f32 v[202:203], v[202:203], v[34:35]
v_pk_add_f32 v[204:205], v[204:205], v[36:37]
v_pk_add_f32 v[206:207], v[206:207], v[40:41]
v_cvt_pk_bf16_f32 v112, v200, v201
v_cvt_pk_bf16_f32 v113, v202, v203
v_cvt_pk_bf16_f32 v114, v204, v205
v_cvt_pk_bf16_f32 v115, v206, v207
buffer_store_dwordx4 v[112:115], v45, s[56:59], 0 offen
s_waitcnt lgkmcnt(0)
v_lshlrev_b32 v208, 16, v116
v_and_b32 v209, 0xffff0000, v116
v_lshlrev_b32 v210, 16, v117
v_and_b32 v211, 0xffff0000, v117
v_lshlrev_b32 v212, 16, v118
v_and_b32 v213, 0xffff0000, v118
v_lshlrev_b32 v214, 16, v119
v_and_b32 v215, 0xffff0000, v119
v_pk_add_f32 v[208:209], v[208:209], v[42:43]
v_pk_add_f32 v[210:211], v[210:211], v[52:53]
v_pk_add_f32 v[212:213], v[212:213], v[54:55]
v_pk_add_f32 v[214:215], v[214:215], v[56:57]
v_cvt_pk_bf16_f32 v116, v208, v209
v_cvt_pk_bf16_f32 v117, v210, v211
v_cvt_pk_bf16_f32 v118, v212, v213
v_cvt_pk_bf16_f32 v119, v214, v215
buffer_store_dwordx4 v[116:119], v46, s[56:59], 0 offen
L_end:
s_endpgm
L_h0:
s_add_u32 m0, s3, 0
s_nop 0
buffer_load_dwordx4 v2, s[24:27], s74 offen lds
s_add_u32 m0, s3, 1024
s_nop 0
buffer_load_dwordx4 v3, s[24:27], s74 offen lds
s_add_u32 m0, s3, 2048
s_nop 0
buffer_load_dwordx4 v4, s[24:27], s74 offen lds
s_add_u32 m0, s3, 3072
s_nop 0
buffer_load_dwordx4 v5, s[24:27], s74 offen lds
s_add_u32 s74, s74, 128
s_cmp_eq_u32 s74, 1280
s_cselect_b32 s74, 0, s74
s_add_u32 m0, s3, 4096
s_nop 0
buffer_load_dwordx4 v2, s[24:27], s74 offen lds
s_add_u32 m0, s3, 5120
s_nop 0
buffer_load_dwordx4 v3, s[24:27], s74 offen lds
s_add_u32 m0, s3, 6144
s_nop 0
buffer_load_dwordx4 v4, s[24:27], s74 offen lds
s_add_u32 m0, s3, 7168
s_nop 0
buffer_load_dwordx4 v5, s[24:27], s74 offen lds
s_add_u32 s74, s74, 128
s_cmp_eq_u32 s74, 1280
s_cselect_b32 s74, 0, s74
s_add_u32 m0, s3, 8192
s_nop 0
buffer_load_dwordx4 v2, s[24:27], s74 offen lds
s_add_u32 m0, s3, 9216
s_nop 0
buffer_load_dwordx4 v3, s[24:27], s74 offen lds
s_add_u32 m0, s3, 10240
s_nop 0
buffer_load_dwordx4 v4, s[24:27], s74 offen lds
s_add_u32 m0, s3, 11264
s_nop 0
buffer_load_dwordx4 v5, s[24:27], s74 offen lds
s_add_u32 s74, s74, 128
s_cmp_eq_u32 s74, 1280
s_cselect_b32 s74, 0, s74
s_branch L_h0b
L_helper:
s_add_u32 m0, s3, 12288
s_nop 0
buffer_load_dwordx4 v2, s[24:27], s74 offen lds
s_add_u32 m0, s3, 13312
s_nop 0
buffer_load_dwordx4 v3, s[24:27], s74 offen lds
s_add_u32 m0, s3, 14336
s_nop 0
buffer_load_dwordx4 v4, s[24:27], s74 offen lds
s_add_u32 m0, s3, 15360
s_nop 0
buffer_load_dwordx4 v5, s[24:27], s74 offen lds
s_add_u32 s74, s74, 128
s_cmp_eq_u32 s74, 1280
s_cselect_b32 s74, 0, s74
s_add_u32 m0, s3, 16384
s_nop 0
buffer_load_dwordx4 v2, s[24:27], s74 offen lds
s_add_u32 m0, s3, 17408
s_nop 0
buffer_load_dwordx4 v3, s[24:27], s74 offen lds
s_add_u32 m0, s3, 18432
s_nop 0
buffer_load_dwordx4 v4, s[24:27], s74 offen lds
s_add_u32 m0, s3, 19456
s_nop 0
buffer_load_dwordx4 v5, s[24:27], s74 offen lds
s_add_u32 s74, s74, 128
s_cmp_eq_u32 s74, 1280
s_cselect_b32 s74, 0, s74
s_add_u32 m0, s3, 20480
s_nop 0
buffer_load_dwordx4 v2, s[24:27], s74 offen lds
s_add_u32 m0, s3, 21504
s_nop 0
buffer_load_dwordx4 v3, s[24:27], s74 offen lds
s_add_u32 m0, s3, 22528
s_nop 0
buffer_load_dwordx4 v4, s[24:27], s74 offen lds
s_add_u32 m0, s3, 23552
s_nop 0
buffer_load_dwordx4 v5, s[24:27], s74 offen lds
s_add_u32 s74, s74, 128
s_cmp_eq_u32 s74, 1280
s_cselect_b32 s74, 0, s74
s_add_u32 m0, s3, 24576
s_nop 0
buffer_load_dwordx4 v2, s[24:27], s74 offen lds
s_add_u32 m0, s3, 25600
s_nop 0
buffer_load_dwordx4 v3, s[24:27], s74 offen lds
s_add_u32 m0, s3, 26624
s_nop 0
buffer_load_dwordx4 v4, s[24:27], s74 offen lds
s_add_u32 m0, s3, 27648
s_nop 0
buffer_load_dwordx4 v5, s[24:27], s74 offen lds
s_add_u32 s74, s74, 128
s_cmp_eq_u32 s74, 1280
s_cselect_b32 s74, 0, s74
s_add_u32 m0, s3, 28672
s_nop 0
buffer_load_dwordx4 v2, s[24:27], s74 offen lds
s_add_u32 m0, s3, 29696
s_nop 0
buffer_load_dwordx4 v3, s[24:27], s74 offen lds
s_add_u32 m0, s3, 30720
s_nop 0
buffer_load_dwordx4 v4, s[24:27], s74 offen lds
s_add_u32 m0, s3, 31744
s_nop 0
buffer_load_dwordx4 v5, s[24:27], s74 offen lds
s_add_u32 s74, s74, 128
s_cmp_eq_u32 s74, 1280
s_cselect_b32 s74, 0, s74
s_add_u32 m0, s3, 32768
s_nop 0
buffer_load_dwordx4 v2, s[24:27], s74 offen lds
s_add_u32 m0, s3, 33792
s_nop 0
buffer_load_dwordx4 v3, s[24:27], s74 offen lds
s_add_u32 m0, s3, 34816
s_nop 0
buffer_load_dwordx4 v4, s[24:27], s74 offen lds
s_add_u32 m0, s3, 35840
s_nop 0
buffer_load_dwordx4 v5, s[24:27], s74 offen lds
s_add_u32 s74, s74, 128
s_cmp_eq_u32 s74, 1280
s_cselect_b32 s74, 0, s74
s_add_u32 m0, s3, 36864
s_nop 0
buffer_load_dwordx4 v2, s[24:27], s74 offen lds
s_add_u32 m0, s3, 37888
s_nop 0
buffer_load_dwordx4 v3, s[24:27], s74 offen lds
s_add_u32 m0, s3, 38912
s_nop 0
buffer_load_dwordx4 v4, s[24:27], s74 offen lds
s_add_u32 m0, s3, 39936
s_nop 0
buffer_load_dwordx4 v5, s[24:27], s74 offen lds
s_add_u32 s74, s74, 128
s_cmp_eq_u32 s74, 1280
s_cselect_b32 s74, 0, s74
s_add_u32 s88, s76, 81920
s_sub_u32 s88, s3, s88
v_add_u32 v64, s88, v6
v_add_u32 v65, s88, v7
v_mov_b32 v66, 0
v_mov_b32 v68, 0
v_mov_b32 v70, 0
v_mov_b32 v72, 0
s_waitcnt vmcnt(36)
ds_read_b128 v[80:83], v64 offset:0
ds_read_b128 v[84:87], v64 offset:2048
ds_read_b128 v[88:91], v65 offset:0
ds_read_b128 v[92:95], v65 offset:2048
s_waitcnt lgkmcnt(3)
v_dot2c_f32_bf16 v66, v80, v36
v_dot2c_f32_bf16 v70, v80, v80
s_waitcnt lgkmcnt(2)
v_dot2c_f32_bf16 v68, v84, v36
v_dot2c_f32_bf16 v72, v84, v84
v_dot2c_f32_bf16 v66, v81, v36
v_dot2c_f32_bf16 v70, v81, v81
v_dot2c_f32_bf16 v68, v85, v36
v_dot2c_f32_bf16 v72, v85, v85
v_dot2c_f32_bf16 v66, v82, v36
v_dot2c_f32_bf16 v70, v82, v82
v_dot2c_f32_bf16 v68, v86, v36
v_dot2c_f32_bf16 v72, v86, v86
v_dot2c_f32_bf16 v66, v83, v36
v_dot2c_f32_bf16 v70, v83, v83
v_dot2c_f32_bf16 v68, v87, v36
v_dot2c_f32_bf16 v72, v87, v87
s_waitcnt lgkmcnt(1)
v_dot2c_f32_bf16 v66, v88, v36
v_dot2c_f32_bf16 v70, v88, v88
s_waitcnt lgkmcnt(0)
v_dot2c_f32_bf16 v68, v92, v36
v_dot2c_f32_bf16 v72, v92, v92
v_dot2c_f32_bf16 v66, v89, v36
v_dot2c_f32_bf16 v70, v89, v89
v_dot2c_f32_bf16 v68, v93, v36
v_dot2c_f32_bf16 v72, v93, v93
v_dot2c_f32_bf16 v66, v90, v36
v_dot2c_f32_bf16 v70, v90, v90
v_dot2c_f32_bf16 v68, v94, v36
v_dot2c_f32_bf16 v72, v94, v94
v_dot2c_f32_bf16 v66, v91, v36
v_dot2c_f32_bf16 v70, v91, v91
v_dot2c_f32_bf16 v68, v95, v36
v_dot2c_f32_bf16 v72, v95, v95
s_waitcnt vmcnt(32)
ds_read_b128 v[96:99], v64 offset:4096
ds_read_b128 v[100:103], v64 offset:6144
ds_read_b128 v[104:107], v65 offset:4096
ds_read_b128 v[108:111], v65 offset:6144
s_waitcnt lgkmcnt(3)
v_dot2c_f32_bf16 v66, v96, v36
v_dot2c_f32_bf16 v70, v96, v96
s_waitcnt lgkmcnt(2)
v_dot2c_f32_bf16 v68, v100, v36
v_dot2c_f32_bf16 v72, v100, v100
v_dot2c_f32_bf16 v66, v97, v36
v_dot2c_f32_bf16 v70, v97, v97
v_dot2c_f32_bf16 v68, v101, v36
v_dot2c_f32_bf16 v72, v101, v101
v_dot2c_f32_bf16 v66, v98, v36
v_dot2c_f32_bf16 v70, v98, v98
v_dot2c_f32_bf16 v68, v102, v36
v_dot2c_f32_bf16 v72, v102, v102
v_dot2c_f32_bf16 v66, v99, v36
v_dot2c_f32_bf16 v70, v99, v99
v_dot2c_f32_bf16 v68, v103, v36
v_dot2c_f32_bf16 v72, v103, v103
s_waitcnt lgkmcnt(1)
v_dot2c_f32_bf16 v66, v104, v36
v_dot2c_f32_bf16 v70, v104, v104
s_waitcnt lgkmcnt(0)
v_dot2c_f32_bf16 v68, v108, v36
v_dot2c_f32_bf16 v72, v108, v108
v_dot2c_f32_bf16 v66, v105, v36
v_dot2c_f32_bf16 v70, v105, v105
v_dot2c_f32_bf16 v68, v109, v36
v_dot2c_f32_bf16 v72, v109, v109
v_dot2c_f32_bf16 v66, v106, v36
v_dot2c_f32_bf16 v70, v106, v106
v_dot2c_f32_bf16 v68, v110, v36
v_dot2c_f32_bf16 v72, v110, v110
v_dot2c_f32_bf16 v66, v107, v36
v_dot2c_f32_bf16 v70, v107, v107
v_dot2c_f32_bf16 v68, v111, v36
v_dot2c_f32_bf16 v72, v111, v111
s_waitcnt vmcnt(28)
ds_read_b128 v[80:83], v64 offset:8192
ds_read_b128 v[84:87], v64 offset:10240
ds_read_b128 v[88:91], v65 offset:8192
ds_read_b128 v[92:95], v65 offset:10240
s_waitcnt lgkmcnt(3)
v_dot2c_f32_bf16 v66, v80, v36
v_dot2c_f32_bf16 v70, v80, v80
s_waitcnt lgkmcnt(2)
v_dot2c_f32_bf16 v68, v84, v36
v_dot2c_f32_bf16 v72, v84, v84
v_dot2c_f32_bf16 v66, v81, v36
v_dot2c_f32_bf16 v70, v81, v81
v_dot2c_f32_bf16 v68, v85, v36
v_dot2c_f32_bf16 v72, v85, v85
v_dot2c_f32_bf16 v66, v82, v36
v_dot2c_f32_bf16 v70, v82, v82
v_dot2c_f32_bf16 v68, v86, v36
v_dot2c_f32_bf16 v72, v86, v86
v_dot2c_f32_bf16 v66, v83, v36
v_dot2c_f32_bf16 v70, v83, v83
v_dot2c_f32_bf16 v68, v87, v36
v_dot2c_f32_bf16 v72, v87, v87
s_waitcnt lgkmcnt(1)
v_dot2c_f32_bf16 v66, v88, v36
v_dot2c_f32_bf16 v70, v88, v88
s_waitcnt lgkmcnt(0)
v_dot2c_f32_bf16 v68, v92, v36
v_dot2c_f32_bf16 v72, v92, v92
v_dot2c_f32_bf16 v66, v89, v36
v_dot2c_f32_bf16 v70, v89, v89
v_dot2c_f32_bf16 v68, v93, v36
v_dot2c_f32_bf16 v72, v93, v93
v_dot2c_f32_bf16 v66, v90, v36
v_dot2c_f32_bf16 v70, v90, v90
v_dot2c_f32_bf16 v68, v94, v36
v_dot2c_f32_bf16 v72, v94, v94
v_dot2c_f32_bf16 v66, v91, v36
v_dot2c_f32_bf16 v70, v91, v91
v_dot2c_f32_bf16 v68, v95, v36
v_dot2c_f32_bf16 v72, v95, v95
s_waitcnt vmcnt(24)
ds_read_b128 v[96:99], v64 offset:12288
ds_read_b128 v[100:103], v64 offset:14336
ds_read_b128 v[104:107], v65 offset:12288
ds_read_b128 v[108:111], v65 offset:14336
s_waitcnt lgkmcnt(3)
v_dot2c_f32_bf16 v66, v96, v36
v_dot2c_f32_bf16 v70, v96, v96
s_waitcnt lgkmcnt(2)
v_dot2c_f32_bf16 v68, v100, v36
v_dot2c_f32_bf16 v72, v100, v100
v_dot2c_f32_bf16 v66, v97, v36
v_dot2c_f32_bf16 v70, v97, v97
v_dot2c_f32_bf16 v68, v101, v36
v_dot2c_f32_bf16 v72, v101, v101
v_dot2c_f32_bf16 v66, v98, v36
v_dot2c_f32_bf16 v70, v98, v98
v_dot2c_f32_bf16 v68, v102, v36
v_dot2c_f32_bf16 v72, v102, v102
v_dot2c_f32_bf16 v66, v99, v36
v_dot2c_f32_bf16 v70, v99, v99
v_dot2c_f32_bf16 v68, v103, v36
v_dot2c_f32_bf16 v72, v103, v103
s_waitcnt lgkmcnt(1)
v_dot2c_f32_bf16 v66, v104, v36
v_dot2c_f32_bf16 v70, v104, v104
s_waitcnt lgkmcnt(0)
v_dot2c_f32_bf16 v68, v108, v36
v_dot2c_f32_bf16 v72, v108, v108
v_dot2c_f32_bf16 v66, v105, v36
v_dot2c_f32_bf16 v70, v105, v105
v_dot2c_f32_bf16 v68, v109, v36
v_dot2c_f32_bf16 v72, v109, v109
v_dot2c_f32_bf16 v66, v106, v36
v_dot2c_f32_bf16 v70, v106, v106
v_dot2c_f32_bf16 v68, v110, v36
v_dot2c_f32_bf16 v72, v110, v110
v_dot2c_f32_bf16 v66, v107, v36
v_dot2c_f32_bf16 v70, v107, v107
v_dot2c_f32_bf16 v68, v111, v36
v_dot2c_f32_bf16 v72, v111, v111
s_waitcnt vmcnt(20)
ds_read_b128 v[80:83], v64 offset:16384
ds_read_b128 v[84:87], v64 offset:18432
ds_read_b128 v[88:91], v65 offset:16384
ds_read_b128 v[92:95], v65 offset:18432
s_waitcnt lgkmcnt(3)
v_dot2c_f32_bf16 v66, v80, v36
v_dot2c_f32_bf16 v70, v80, v80
s_waitcnt lgkmcnt(2)
v_dot2c_f32_bf16 v68, v84, v36
v_dot2c_f32_bf16 v72, v84, v84
v_dot2c_f32_bf16 v66, v81, v36
v_dot2c_f32_bf16 v70, v81, v81
v_dot2c_f32_bf16 v68, v85, v36
v_dot2c_f32_bf16 v72, v85, v85
v_dot2c_f32_bf16 v66, v82, v36
v_dot2c_f32_bf16 v70, v82, v82
v_dot2c_f32_bf16 v68, v86, v36
v_dot2c_f32_bf16 v72, v86, v86
v_dot2c_f32_bf16 v66, v83, v36
v_dot2c_f32_bf16 v70, v83, v83
v_dot2c_f32_bf16 v68, v87, v36
v_dot2c_f32_bf16 v72, v87, v87
s_waitcnt lgkmcnt(1)
v_dot2c_f32_bf16 v66, v88, v36
v_dot2c_f32_bf16 v70, v88, v88
s_waitcnt lgkmcnt(0)
v_dot2c_f32_bf16 v68, v92, v36
v_dot2c_f32_bf16 v72, v92, v92
v_dot2c_f32_bf16 v66, v89, v36
v_dot2c_f32_bf16 v70, v89, v89
v_dot2c_f32_bf16 v68, v93, v36
v_dot2c_f32_bf16 v72, v93, v93
v_dot2c_f32_bf16 v66, v90, v36
v_dot2c_f32_bf16 v70, v90, v90
v_dot2c_f32_bf16 v68, v94, v36
v_dot2c_f32_bf16 v72, v94, v94
v_dot2c_f32_bf16 v66, v91, v36
v_dot2c_f32_bf16 v70, v91, v91
v_dot2c_f32_bf16 v68, v95, v36
v_dot2c_f32_bf16 v72, v95, v95
s_waitcnt vmcnt(16)
ds_read_b128 v[96:99], v64 offset:20480
ds_read_b128 v[100:103], v64 offset:22528
ds_read_b128 v[104:107], v65 offset:20480
ds_read_b128 v[108:111], v65 offset:22528
s_waitcnt lgkmcnt(3)
v_dot2c_f32_bf16 v66, v96, v36
v_dot2c_f32_bf16 v70, v96, v96
s_waitcnt lgkmcnt(2)
v_dot2c_f32_bf16 v68, v100, v36
v_dot2c_f32_bf16 v72, v100, v100
v_dot2c_f32_bf16 v66, v97, v36
v_dot2c_f32_bf16 v70, v97, v97
v_dot2c_f32_bf16 v68, v101, v36
v_dot2c_f32_bf16 v72, v101, v101
v_dot2c_f32_bf16 v66, v98, v36
v_dot2c_f32_bf16 v70, v98, v98
v_dot2c_f32_bf16 v68, v102, v36
v_dot2c_f32_bf16 v72, v102, v102
v_dot2c_f32_bf16 v66, v99, v36
v_dot2c_f32_bf16 v70, v99, v99
v_dot2c_f32_bf16 v68, v103, v36
v_dot2c_f32_bf16 v72, v103, v103
s_waitcnt lgkmcnt(1)
v_dot2c_f32_bf16 v66, v104, v36
v_dot2c_f32_bf16 v70, v104, v104
s_waitcnt lgkmcnt(0)
v_dot2c_f32_bf16 v68, v108, v36
v_dot2c_f32_bf16 v72, v108, v108
v_dot2c_f32_bf16 v66, v105, v36
v_dot2c_f32_bf16 v70, v105, v105
v_dot2c_f32_bf16 v68, v109, v36
v_dot2c_f32_bf16 v72, v109, v109
v_dot2c_f32_bf16 v66, v106, v36
v_dot2c_f32_bf16 v70, v106, v106
v_dot2c_f32_bf16 v68, v110, v36
v_dot2c_f32_bf16 v72, v110, v110
v_dot2c_f32_bf16 v66, v107, v36
v_dot2c_f32_bf16 v70, v107, v107
v_dot2c_f32_bf16 v68, v111, v36
v_dot2c_f32_bf16 v72, v111, v111
s_waitcnt vmcnt(12)
ds_read_b128 v[80:83], v64 offset:24576
ds_read_b128 v[84:87], v64 offset:26624
ds_read_b128 v[88:91], v65 offset:24576
ds_read_b128 v[92:95], v65 offset:26624
s_waitcnt lgkmcnt(3)
v_dot2c_f32_bf16 v66, v80, v36
v_dot2c_f32_bf16 v70, v80, v80
s_waitcnt lgkmcnt(2)
v_dot2c_f32_bf16 v68, v84, v36
v_dot2c_f32_bf16 v72, v84, v84
v_dot2c_f32_bf16 v66, v81, v36
v_dot2c_f32_bf16 v70, v81, v81
v_dot2c_f32_bf16 v68, v85, v36
v_dot2c_f32_bf16 v72, v85, v85
v_dot2c_f32_bf16 v66, v82, v36
v_dot2c_f32_bf16 v70, v82, v82
v_dot2c_f32_bf16 v68, v86, v36
v_dot2c_f32_bf16 v72, v86, v86
v_dot2c_f32_bf16 v66, v83, v36
v_dot2c_f32_bf16 v70, v83, v83
v_dot2c_f32_bf16 v68, v87, v36
v_dot2c_f32_bf16 v72, v87, v87
s_waitcnt lgkmcnt(1)
v_dot2c_f32_bf16 v66, v88, v36
v_dot2c_f32_bf16 v70, v88, v88
s_waitcnt lgkmcnt(0)
v_dot2c_f32_bf16 v68, v92, v36
v_dot2c_f32_bf16 v72, v92, v92
v_dot2c_f32_bf16 v66, v89, v36
v_dot2c_f32_bf16 v70, v89, v89
v_dot2c_f32_bf16 v68, v93, v36
v_dot2c_f32_bf16 v72, v93, v93
v_dot2c_f32_bf16 v66, v90, v36
v_dot2c_f32_bf16 v70, v90, v90
v_dot2c_f32_bf16 v68, v94, v36
v_dot2c_f32_bf16 v72, v94, v94
v_dot2c_f32_bf16 v66, v91, v36
v_dot2c_f32_bf16 v70, v91, v91
v_dot2c_f32_bf16 v68, v95, v36
v_dot2c_f32_bf16 v72, v95, v95
s_waitcnt vmcnt(8)
ds_read_b128 v[96:99], v64 offset:28672
ds_read_b128 v[100:103], v64 offset:30720
ds_read_b128 v[104:107], v65 offset:28672
ds_read_b128 v[108:111], v65 offset:30720
s_waitcnt lgkmcnt(3)
v_dot2c_f32_bf16 v66, v96, v36
v_dot2c_f32_bf16 v70, v96, v96
s_waitcnt lgkmcnt(2)
v_dot2c_f32_bf16 v68, v100, v36
v_dot2c_f32_bf16 v72, v100, v100
v_dot2c_f32_bf16 v66, v97, v36
v_dot2c_f32_bf16 v70, v97, v97
v_dot2c_f32_bf16 v68, v101, v36
v_dot2c_f32_bf16 v72, v101, v101
v_dot2c_f32_bf16 v66, v98, v36
v_dot2c_f32_bf16 v70, v98, v98
v_dot2c_f32_bf16 v68, v102, v36
v_dot2c_f32_bf16 v72, v102, v102
v_dot2c_f32_bf16 v66, v99, v36
v_dot2c_f32_bf16 v70, v99, v99
v_dot2c_f32_bf16 v68, v103, v36
v_dot2c_f32_bf16 v72, v103, v103
s_waitcnt lgkmcnt(1)
v_dot2c_f32_bf16 v66, v104, v36
v_dot2c_f32_bf16 v70, v104, v104
s_waitcnt lgkmcnt(0)
v_dot2c_f32_bf16 v68, v108, v36
v_dot2c_f32_bf16 v72, v108, v108
v_dot2c_f32_bf16 v66, v105, v36
v_dot2c_f32_bf16 v70, v105, v105
v_dot2c_f32_bf16 v68, v109, v36
v_dot2c_f32_bf16 v72, v109, v109
v_dot2c_f32_bf16 v66, v106, v36
v_dot2c_f32_bf16 v70, v106, v106
v_dot2c_f32_bf16 v68, v110, v36
v_dot2c_f32_bf16 v72, v110, v110
v_dot2c_f32_bf16 v66, v107, v36
v_dot2c_f32_bf16 v70, v107, v107
v_dot2c_f32_bf16 v68, v111, v36
v_dot2c_f32_bf16 v72, v111, v111
s_waitcnt vmcnt(4)
ds_read_b128 v[80:83], v64 offset:32768
ds_read_b128 v[84:87], v64 offset:34816
ds_read_b128 v[88:91], v65 offset:32768
ds_read_b128 v[92:95], v65 offset:34816
buffer_load_dword v18, off, s[60:63], 0 sc1
s_waitcnt lgkmcnt(3)
v_dot2c_f32_bf16 v66, v80, v36
v_dot2c_f32_bf16 v70, v80, v80
s_waitcnt lgkmcnt(2)
v_dot2c_f32_bf16 v68, v84, v36
v_dot2c_f32_bf16 v72, v84, v84
v_dot2c_f32_bf16 v66, v81, v36
v_dot2c_f32_bf16 v70, v81, v81
v_dot2c_f32_bf16 v68, v85, v36
v_dot2c_f32_bf16 v72, v85, v85
v_dot2c_f32_bf16 v66, v82, v36
v_dot2c_f32_bf16 v70, v82, v82
v_dot2c_f32_bf16 v68, v86, v36
v_dot2c_f32_bf16 v72, v86, v86
v_dot2c_f32_bf16 v66, v83, v36
v_dot2c_f32_bf16 v70, v83, v83
v_dot2c_f32_bf16 v68, v87, v36
v_dot2c_f32_bf16 v72, v87, v87
s_waitcnt lgkmcnt(1)
v_dot2c_f32_bf16 v66, v88, v36
v_dot2c_f32_bf16 v70, v88, v88
s_waitcnt lgkmcnt(0)
v_dot2c_f32_bf16 v68, v92, v36
v_dot2c_f32_bf16 v72, v92, v92
v_dot2c_f32_bf16 v66, v89, v36
v_dot2c_f32_bf16 v70, v89, v89
v_dot2c_f32_bf16 v68, v93, v36
v_dot2c_f32_bf16 v72, v93, v93
v_dot2c_f32_bf16 v66, v90, v36
v_dot2c_f32_bf16 v70, v90, v90
v_dot2c_f32_bf16 v68, v94, v36
v_dot2c_f32_bf16 v72, v94, v94
v_dot2c_f32_bf16 v66, v91, v36
v_dot2c_f32_bf16 v70, v91, v91
v_dot2c_f32_bf16 v68, v95, v36
v_dot2c_f32_bf16 v72, v95, v95
s_waitcnt vmcnt(1)
ds_read_b128 v[96:99], v64 offset:36864
ds_read_b128 v[100:103], v64 offset:38912
ds_read_b128 v[104:107], v65 offset:36864
ds_read_b128 v[108:111], v65 offset:38912
s_waitcnt lgkmcnt(3)
v_dot2c_f32_bf16 v66, v96, v36
v_dot2c_f32_bf16 v70, v96, v96
s_waitcnt lgkmcnt(2)
v_dot2c_f32_bf16 v68, v100, v36
v_dot2c_f32_bf16 v72, v100, v100
v_dot2c_f32_bf16 v66, v97, v36
v_dot2c_f32_bf16 v70, v97, v97
v_dot2c_f32_bf16 v68, v101, v36
v_dot2c_f32_bf16 v72, v101, v101
v_dot2c_f32_bf16 v66, v98, v36
v_dot2c_f32_bf16 v70, v98, v98
v_dot2c_f32_bf16 v68, v102, v36
v_dot2c_f32_bf16 v72, v102, v102
v_dot2c_f32_bf16 v66, v99, v36
v_dot2c_f32_bf16 v70, v99, v99
v_dot2c_f32_bf16 v68, v103, v36
v_dot2c_f32_bf16 v72, v103, v103
s_waitcnt lgkmcnt(1)
v_dot2c_f32_bf16 v66, v104, v36
v_dot2c_f32_bf16 v70, v104, v104
s_waitcnt lgkmcnt(0)
v_dot2c_f32_bf16 v68, v108, v36
v_dot2c_f32_bf16 v72, v108, v108
v_dot2c_f32_bf16 v66, v105, v36
v_dot2c_f32_bf16 v70, v105, v105
v_dot2c_f32_bf16 v68, v109, v36
v_dot2c_f32_bf16 v72, v109, v109
v_dot2c_f32_bf16 v66, v106, v36
v_dot2c_f32_bf16 v70, v106, v106
v_dot2c_f32_bf16 v68, v110, v36
v_dot2c_f32_bf16 v72, v110, v110
v_dot2c_f32_bf16 v66, v107, v36
v_dot2c_f32_bf16 v70, v107, v107
v_dot2c_f32_bf16 v68, v111, v36
v_dot2c_f32_bf16 v72, v111, v111
s_nop 2
v_mov_b32 v67, v66
v_mov_b32 v69, v68
v_mov_b32 v71, v70
v_mov_b32 v73, v72
v_permlane16_swap_b32 v66, v67
v_permlane16_swap_b32 v68, v69
v_permlane16_swap_b32 v70, v71
v_permlane16_swap_b32 v72, v73
v_add_f32 v66, v66, v67
v_add_f32 v68, v68, v69
v_add_f32 v70, v70, v71
v_add_f32 v72, v72, v73
v_mov_b32 v67, v66
v_mov_b32 v69, v68
v_mov_b32 v71, v70
v_mov_b32 v73, v72
v_permlane32_swap_b32 v66, v67
v_permlane32_swap_b32 v68, v69
v_permlane32_swap_b32 v70, v71
v_permlane32_swap_b32 v72, v73
v_add_f32 v66, v66, v67
v_add_f32 v68, v68, v69
v_add_f32 v70, v70, v71
v_add_f32 v72, v72, v73
v_and_b32 v74, 16, v0
v_cmp_ne_u32 vcc, 0, v74
s_nop 1
v_cndmask_b32 v66, v66, v68, vcc
v_cndmask_b32 v70, v70, v72, vcc
v_mul_f32 v76, 0xbacccccd, v66
v_mul_f32 v77, 0x3acccccd, v70
v_fma_f32 v77, -v76, v76, v77
v_cvt_pk_bf16_f32 v76, v76, v76
v_max_f32 v77, 0, v77
v_cvt_pk_bf16_f32 v77, v77, v77
v_and_b32 v77, 0xffff0000, v77
v_add_f32 v77, 0x3727c5ac, v77
v_cvt_pk_bf16_f32 v77, v77, v77
v_and_b32 v77, 0xffff0000, v77
v_sqrt_f32 v77, v77
s_nop 0
v_cvt_pk_bf16_f32 v77, v77, v77
v_and_b32 v77, 0xffff0000, v77
v_rcp_f32 v77, v77
s_waitcnt vmcnt(0)
v_cmp_eq_u32 vcc, 0, v18
s_nop 0
s_cbranch_vccnz L_retry_19
L_back_20:
v_readfirstlane_b32 s72, v18
v_and_b32 v72, 0x7fff, v42
v_lshl_or_b32 v72, v21, 31, v72
v_mov_b32 v78, s72
v_mov_b32 v79, s72
buffer_store_dwordx4 v[76:79], v72, s[52:55], 0 offen sc1
s_waitcnt lgkmcnt(0)
s_barrier
s_lshr_b32 s88, s80, 1
s_lshl_b32 s88, s88, 3
s_and_b32 s91, s81, 7
s_add_u32 s77, s88, s91
s_and_b32 s88, s80, 1
s_lshl_b32 s88, s88, 2
s_lshr_b32 s91, s81, 3
s_add_u32 s78, s88, s91
s_lshr_b32 s88, s81, 4
s_lshl_b32 s80, s80, 1
s_add_u32 s80, s80, s88
s_and_b32 s81, s81, 15
s_lshl_b32 s88, s81, 4
s_add_u32 s88, s88, s80
s_lshl_b32 s88, s88, 4
s_lshl_b32 s91, s68, 2
s_add_u32 s88, s88, s91
s_add_u32 s20, s88, 724992
v_min_u32 v243, 13, v0
v_lshrrev_b32 v240, 2, v243
s_lshl_b32 s88, s81, 2
s_mul_i32 s91, s68, 3
s_add_u32 s91, s91, s88
s_sub_u32 s91, s91, 8
v_add_u32 v240, s91, v240
v_max_i32 v240, 0, v240
v_bfe_u32 v241, v243, 1, 1
v_mad_u32_u24 v241, v241, 5, 5
s_add_u32 s88, s88, s68
v_mov_b32 v242, s88
v_cmp_gt_u32 vcc, 12, v243
s_nop 1
v_cndmask_b32 v240, v242, v240, vcc
v_cndmask_b32 v241, 0, v241, vcc
v_and_b32 v242, 1, v243
s_mul_i32 s88, s80, 40
v_mad_u32_u24 v242, v242, 39, s88
v_lshrrev_b32 v242, 7, v242
v_add_u32 v241, v241, v242
v_lshrrev_b32 v242, 2, v240
v_lshl_add_u32 v241, v242, 4, v241
v_lshlrev_b32 v241, 7, v241
v_and_b32 v240, 3, v240
v_lshl_add_u32 v241, v240, 2, v241
v_add_u32 v62, 655360, v241
v_min_u32 v241, 37, v0
v_lshrrev_b32 v242, 1, v241
v_and_b32 v241, 1, v241
v_mul_u32_u24 v241, 79, v241
s_mul_i32 s88, s78, 80
v_add_u32 v241, s88, v241
v_lshrrev_b32 v241, 6, v241
v_mad_u32_u24 v241, v242, 10, v241
v_lshlrev_b32 v241, 7, v241
v_add_u32 v55, 688128, v241
v_lshlrev_b32 v240, 4, v20
v_lshl_add_u32 v243, v21, 15, v240
v_accvgpr_write_b32 a224, v243
s_mov_b32 s88, 2490368
v_mad_u32_u24 v242, v21, s88, v240
v_accvgpr_write_b32 a225, v242
v_add_u32 v241, 1, v21
v_lshlrev_b32 v241, 6, v241
v_xor_b32 v242, v243, v241
v_accvgpr_write_b32 a226, v242
v_sub_u32 v241, 1, v21
v_mul_u32_u24 v241, 0xc0, v241
v_xor_b32 v242, v243, v241
v_accvgpr_write_b32 a227, v242
s_lshl_b32 s91, s81, 11
s_lshl_b32 s88, s68, 9
s_add_u32 s91, s91, s88
v_add_u32 v242, s91, v243
v_accvgpr_write_b32 a228, v242
s_mul_i32 s88, s68, 5632
s_add_u32 s88, s88, 81920
v_add_u32 v240, s88, v240
v_lshl_add_u32 v242, v21, 9, v240
v_accvgpr_write_b32 a229, v242
v_add_u32 v242, 1536, v242
v_accvgpr_write_b32 a230, v242
v_lshl_add_u32 v242, v21, 12, v240
v_add_u32 v242, 0x400, v242
v_accvgpr_write_b32 a231, v242
v_bfe_u32 v240, v0, 4, 1
v_and_b32 v241, 3, v0
v_lshl_add_u32 v240, v240, 2, v241
v_lshlrev_b32 v240, 2, v240
v_mov_b32 v242, 0xaaa76655
v_lshrrev_b32 v241, v240, v242
v_and_b32 v241, 15, v241
v_lshlrev_b32 v243, 9, v241
v_mov_b32 v242, 0x77743210
v_lshrrev_b32 v241, v240, v242
v_and_b32 v240, 1, v241
v_lshl_add_u32 v243, v240, 3, v243
v_bfe_u32 v241, v241, 1, 2
v_xor_b32 v241, v241, v21
v_lshl_add_u32 v243, v241, 6, v243
v_bfe_u32 v241, v0, 2, 2
v_lshl_add_u32 v243, v241, 4, v243
v_xor_b32 v242, 0x80, v243
v_add_u32 v243, s88, v243
v_add_u32 v242, s88, v242
v_accvgpr_write_b32 a232, v243
v_accvgpr_write_b32 a233, v242
v_bfe_u32 v240, v0, 4, 1
v_and_b32 v241, 3, v0
v_lshl_add_u32 v240, v240, 2, v241
v_lshlrev_b32 v240, 2, v240
v_mov_b32 v242, 0xaaa99887
v_lshrrev_b32 v241, v240, v242
v_and_b32 v241, 15, v241
v_lshlrev_b32 v243, 9, v241
v_mov_b32 v242, 0x33310765
v_lshrrev_b32 v241, v240, v242
v_and_b32 v240, 1, v241
v_lshl_add_u32 v243, v240, 3, v243
v_bfe_u32 v241, v241, 1, 2
v_xor_b32 v241, v241, v21
v_lshl_add_u32 v243, v241, 6, v243
v_bfe_u32 v241, v0, 2, 2
v_lshl_add_u32 v243, v241, 4, v243
v_xor_b32 v242, 0x80, v243
v_add_u32 v243, s88, v243
v_add_u32 v242, s88, v242
v_accvgpr_write_b32 a234, v243
v_accvgpr_write_b32 a235, v242
s_lshl_b32 s88, s81, 2
s_mul_i32 s91, s68, 3
s_add_u32 s87, s88, s91
s_mul_i32 s6, s80, 163840
s_mul_i32 s7, s68, 16896
s_add_u32 s88, s87, 0
s_sub_u32 s91, s88, 8
s_lshl_b32 s91, s91, 9
s_add_u32 s91, s91, s6
s_cmp_ge_u32 s88, 8
s_cselect_b32 s8, s91, 2147483648
s_add_u32 s88, s87, 1
s_sub_u32 s91, s88, 8
s_lshl_b32 s91, s91, 9
s_add_u32 s91, s91, s6
s_cmp_ge_u32 s88, 8
s_cselect_b32 s9, s91, 2147483648
s_add_u32 s88, s87, 2
s_sub_u32 s91, s88, 8
s_lshl_b32 s91, s91, 9
s_add_u32 s91, s91, s6
s_cmp_ge_u32 s88, 8
s_cselect_b32 s10, s91, 2147483648
s_mul_i32 s13, s78, 378880
s_add_u32 s14, s13, 286720
s_add_u32 s16, s13, 272384
s_mov_b32 s90, 0
s_mul_i32 s88, s90, 20480
s_add_u32 s12, s13, s88
s_add_u32 s11, s12, 163840
s_cmp_ge_u32 s11, s14
s_cselect_b32 s88, 286720, 0
s_sub_u32 s11, s11, s88
s_lshl_b32 s15, s90, 19
s_mul_i32 s88, s68, 5120
v_add_u32 v57, s88, v58
v_add_u32 v242, 0x1000, v57
v_accvgpr_write_b32 a236, v242
s_lshl_b32 s88, s68, 10
v_add_u32 v242, s88, v58
v_accvgpr_write_b32 a237, v242
v_and_b32 v240, 15, v0
v_lshrrev_b32 v241, 4, v0
v_lshlrev_b32 v241, 15, v241
v_lshl_add_u32 v240, v240, 4, v241
s_lshl_b32 s88, s77, 10
v_add_u32 v240, s88, v240
s_lshl_b32 s91, s68, 8
v_add_u32 v242, s91, v240
v_accvgpr_write_b32 a238, v242
s_lshr_b32 s88, s77, 1
s_lshl_b32 s88, s88, 8
v_lshl_add_u32 v59, v0, 2, s88
s_add_u32 s88, s68, 1
s_and_b32 s88, s88, 3
s_lshl_b32 s88, s88, 8
s_lshl_b32 s91, s68, 17
s_add_u32 s88, s88, s91
v_add_u32 v242, s88, v240
v_accvgpr_write_b32 a252, v242
s_add_u32 s88, s68, 2
s_and_b32 s88, s88, 3
s_lshl_b32 s88, s88, 8
s_lshl_b32 s91, s68, 17
s_add_u32 s88, s88, s91
v_add_u32 v242, s88, v240
v_accvgpr_write_b32 a253, v242
s_add_u32 s88, s68, 3
s_and_b32 s88, s88, 3
s_lshl_b32 s88, s88, 8
s_lshl_b32 s91, s68, 17
s_add_u32 s88, s88, s91
v_add_u32 v242, s88, v240
v_accvgpr_write_b32 a254, v242
s_add_u32 s88, s68, 4
s_and_b32 s88, s88, 3
s_lshl_b32 s88, s88, 8
s_lshl_b32 s91, s68, 17
s_add_u32 s88, s88, s91
v_add_u32 v242, s88, v240
v_accvgpr_write_b32 a255, v242
v_accvgpr_read_b32 v10, a224
v_accvgpr_read_b32 v11, a225
v_accvgpr_read_b32 v12, a226
v_accvgpr_read_b32 v13, a227
v_accvgpr_read_b32 v9, a228
v_accvgpr_read_b32 v2, a229
v_accvgpr_read_b32 v3, a230
v_accvgpr_read_b32 v4, a231
v_accvgpr_read_b32 v5, a232
v_accvgpr_read_b32 v6, a233
v_accvgpr_read_b32 v7, a234
v_accvgpr_read_b32 v8, a235
v_accvgpr_read_b32 v19, a236
v_accvgpr_read_b32 v22, a237
v_accvgpr_read_b32 v23, a238
v_accvgpr_read_b32 v14, a252
v_accvgpr_read_b32 v15, a253
v_accvgpr_read_b32 v16, a254
v_accvgpr_read_b32 v17, a255
v_lshlrev_b32 v40, 2, v21
v_sub_u32 v40, v20, v40
v_mov_b32 v41, 0xf149f2ca
v_cmp_gt_i32 s[90:91], 0, v40
v_cmp_gt_i32 s[96:97], 1, v40
v_cmp_gt_i32 s[98:99], 2, v40
v_cndmask_b32 v64, v41, 0, s[90:91]
v_cndmask_b32 v80, 0, v41, s[90:91]
v_cmp_gt_i32 s[90:91], 3, v40
v_cndmask_b32 v65, v41, 0, s[96:97]
v_cndmask_b32 v81, 0, v41, s[96:97]
v_cmp_gt_i32 s[96:97], 8, v40
v_cndmask_b32 v66, v41, 0, s[98:99]
v_cndmask_b32 v82, 0, v41, s[98:99]
v_cmp_gt_i32 s[98:99], 9, v40
v_cndmask_b32 v67, v41, 0, s[90:91]
v_cndmask_b32 v83, 0, v41, s[90:91]
v_cmp_gt_i32 s[90:91], 10, v40
v_cndmask_b32 v68, v41, 0, s[96:97]
v_cndmask_b32 v84, 0, v41, s[96:97]
v_cmp_gt_i32 s[96:97], 11, v40
v_cndmask_b32 v69, v41, 0, s[98:99]
v_cndmask_b32 v85, 0, v41, s[98:99]
v_cmp_gt_i32 s[98:99], 16, v40
v_cndmask_b32 v70, v41, 0, s[90:91]
v_cndmask_b32 v86, 0, v41, s[90:91]
v_cmp_gt_i32 s[90:91], 17, v40
v_cndmask_b32 v71, v41, 0, s[96:97]
v_cndmask_b32 v87, 0, v41, s[96:97]
v_cmp_gt_i32 s[96:97], 18, v40
v_cndmask_b32 v72, v41, 0, s[98:99]
v_cndmask_b32 v88, 0, v41, s[98:99]
v_cmp_gt_i32 s[98:99], 19, v40
v_cndmask_b32 v73, v41, 0, s[90:91]
v_cndmask_b32 v89, 0, v41, s[90:91]
v_cmp_gt_i32 s[90:91], 24, v40
v_cndmask_b32 v74, v41, 0, s[96:97]
v_cndmask_b32 v90, 0, v41, s[96:97]
v_cmp_gt_i32 s[96:97], 25, v40
v_cndmask_b32 v75, v41, 0, s[98:99]
v_cndmask_b32 v91, 0, v41, s[98:99]
v_cmp_gt_i32 s[98:99], 26, v40
v_cndmask_b32 v76, v41, 0, s[90:91]
v_cndmask_b32 v92, 0, v41, s[90:91]
v_cmp_gt_i32 s[90:91], 27, v40
v_cndmask_b32 v77, v41, 0, s[96:97]
v_cndmask_b32 v93, 0, v41, s[96:97]
v_cndmask_b32 v78, v41, 0, s[98:99]
v_cndmask_b32 v94, 0, v41, s[98:99]
v_cndmask_b32 v79, v41, 0, s[90:91]
v_cndmask_b32 v95, 0, v41, s[90:91]
s_barrier
s_cmp_lg_u32 s68, 0
s_cbranch_scc1 L_wgf_21
v_mov_b32 v18, s72
s_mov_b64 exec, 1
buffer_store_dword v18, off, s[52:55], s17 sc1
s_mov_b64 exec, -1
L_wgf_21:
v_mov_b32 v245, 0x3f80
v_mov_b32 v246, 0x3f803f80
v_mov_b32 v247, 0x3f803f80
s_add_u32 s88, s7, 87040
v_lshl_add_u32 v25, v20, 4, s88
s_cmp_ge_u32 s87, 8
s_cselect_b32 s88, 0x3f800000, 0x3f80f149
v_mov_b32 v244, s88
ds_write_b128 v25, v[244:247] offset:0
s_cmp_ge_u32 s87, 7
s_cselect_b32 s88, 0x3f800000, 0x3f80f149
v_mov_b32 v244, s88
ds_write_b128 v25, v[244:247] offset:5632
s_cmp_ge_u32 s87, 6
s_cselect_b32 s88, 0x3f800000, 0x3f80f149
v_mov_b32 v244, s88
ds_write_b128 v25, v[244:247] offset:11264
buffer_load_dword v26, v55, s[52:55], 0 offen sc1
s_waitcnt vmcnt(0)
v_cmp_ne_u32 vcc, s72, v26
s_nop 0
s_cbranch_vccnz L_retry_22
L_back_23:
buffer_load_dwordx4 a[160:163], v57, s[48:51], s11 offen offset:0 sc1
buffer_load_dwordx4 a[164:167], v57, s[48:51], s11 offen offset:1024 sc1
buffer_load_dwordx4 a[168:171], v57, s[48:51], s11 offen offset:2048 sc1
buffer_load_dwordx4 a[172:175], v57, s[48:51], s11 offen offset:3072 sc1
buffer_load_dwordx4 a[176:179], v19, s[48:51], s11 offen sc1
s_add_u32 s11, s11, 20480
buffer_load_dwordx4 a[180:183], v57, s[48:51], s11 offen offset:0 sc1
buffer_load_dwordx4 a[184:187], v57, s[48:51], s11 offen offset:1024 sc1
buffer_load_dwordx4 a[188:191], v57, s[48:51], s11 offen offset:2048 sc1
buffer_load_dwordx4 a[192:195], v57, s[48:51], s11 offen offset:3072 sc1
buffer_load_dwordx4 a[196:199], v19, s[48:51], s11 offen sc1
s_add_u32 s11, s11, 20480
buffer_load_dwordx4 a[200:203], v57, s[48:51], s11 offen offset:0 sc1
buffer_load_dwordx4 a[204:207], v57, s[48:51], s11 offen offset:1024 sc1
buffer_load_dwordx4 a[208:211], v57, s[48:51], s11 offen offset:2048 sc1
buffer_load_dwordx4 a[212:215], v57, s[48:51], s11 offen offset:3072 sc1
buffer_load_dwordx4 a[216:219], v19, s[48:51], s11 offen sc1
s_add_u32 s11, s11, 20480
buffer_load_dwordx4 a[220:223], v57, s[48:51], s11 offen offset:0 sc1
buffer_load_dwordx4 a[224:227], v57, s[48:51], s11 offen offset:1024 sc1
buffer_load_dwordx4 a[228:231], v57, s[48:51], s11 offen offset:2048 sc1
buffer_load_dwordx4 a[232:235], v57, s[48:51], s11 offen offset:3072 sc1
buffer_load_dwordx4 a[236:239], v19, s[48:51], s11 offen sc1
s_add_u32 s11, s11, 20480
buffer_load_dwordx4 a[240:243], v57, s[48:51], s11 offen offset:0 sc1
buffer_load_dwordx4 a[244:247], v57, s[48:51], s11 offen offset:1024 sc1
buffer_load_dwordx4 a[248:251], v57, s[48:51], s11 offen offset:2048 sc1
buffer_load_dword v63, v62, s[52:55], 0 offen sc1
s_waitcnt vmcnt(0)
v_cmp_ne_u32 vcc, s72, v63
s_nop 0
s_cbranch_vccnz L_retry_24
L_back_25:
s_add_u32 m0, s7, 81920
s_add_u32 s88, s8, 2621440
buffer_load_dwordx4 v10, s[36:39], s88 offen sc1 lds
s_add_u32 m0, s7, 82944
s_add_u32 s88, s8, 2686976
buffer_load_dwordx4 v10, s[36:39], s88 offen sc1 lds
s_add_u32 m0, s7, 83968
s_add_u32 s88, s8, 2752512
buffer_load_dwordx4 v11, s[36:39], s88 offen sc1 lds
s_add_u32 m0, s7, 87552
s_add_u32 s88, s9, 2621440
buffer_load_dwordx4 v10, s[36:39], s88 offen sc1 lds
s_add_u32 m0, s7, 88576
s_add_u32 s88, s9, 2686976
buffer_load_dwordx4 v10, s[36:39], s88 offen sc1 lds
s_add_u32 m0, s7, 89600
s_add_u32 s88, s9, 2752512
buffer_load_dwordx4 v11, s[36:39], s88 offen sc1 lds
s_add_u32 m0, s7, 93184
s_add_u32 s88, s10, 2621440
buffer_load_dwordx4 v10, s[36:39], s88 offen sc1 lds
s_add_u32 m0, s7, 94208
s_add_u32 s88, s10, 2686976
buffer_load_dwordx4 v10, s[36:39], s88 offen sc1 lds
s_add_u32 m0, s7, 95232
s_add_u32 s88, s10, 2752512
buffer_load_dwordx4 v11, s[36:39], s88 offen sc1 lds
buffer_load_dwordx4 v[96:99], v9, s[36:39], s6 offen sc1
s_add_u32 s88, s6, 98304
buffer_load_dwordx4 v[100:103], v9, s[36:39], s88 offen sc1
s_add_u32 s88, s6, 65536
buffer_load_dwordx4 v[104:107], v9, s[36:39], s88 offen sc1
s_waitcnt vmcnt(0) lgkmcnt(0)
s_branch L_join
L_retry_2:
s_mov_b32 s79, 0x20000
L_retry_2_loop:
s_sleep 2
buffer_load_dword v18, off, s[60:63], 0 sc1
s_waitcnt vmcnt(0)
v_cmp_eq_u32 vcc, 0, v18
s_nop 0
s_cbranch_vccz L_retry_2_done
s_sub_u32 s79, s79, 1
s_cmp_lg_u32 s79, 0
s_cbranch_scc1 L_retry_2_loop
L_retry_2_done:
s_nop 4
s_branch L_back_3
L_retry_4:
s_mov_b32 s79, 0x20000
L_retry_4_loop:
s_sleep 2
buffer_load_dword v128, v60, s[52:55], s21 offen offset:0 sc1
buffer_load_dword v129, v60, s[52:55], s21 offen offset:256 sc1
buffer_load_dword v130, v60, s[52:55], s21 offen offset:512 sc1
buffer_load_dword v131, v60, s[52:55], s21 offen offset:768 sc1
buffer_load_dword v132, v60, s[52:55], s21 offen offset:1024 sc1
buffer_load_dword v133, v60, s[52:55], s21 offen offset:1280 sc1
buffer_load_dword v134, v60, s[52:55], s21 offen offset:1536 sc1
buffer_load_dword v135, v60, s[52:55], s21 offen offset:1792 sc1
buffer_load_dword v136, v60, s[52:55], s21 offen offset:2048 sc1
buffer_load_dword v137, v60, s[52:55], s21 offen offset:2304 sc1
s_waitcnt vmcnt(0)
v_min3_u32 v250, v128, v129, s72
v_max3_u32 v251, v128, v129, s72
v_min3_u32 v250, v250, v130, v131
v_max3_u32 v251, v251, v130, v131
v_min3_u32 v250, v250, v132, v133
v_max3_u32 v251, v251, v132, v133
v_min3_u32 v250, v250, v134, v135
v_max3_u32 v251, v251, v134, v135
v_min3_u32 v250, v250, v136, v137
v_max3_u32 v251, v251, v136, v137
v_cmp_ne_u32 vcc, v250, v251
s_nop 0
s_and_b64 vcc, vcc, s[100:101]
s_cbranch_vccz L_retry_4_done
s_sub_u32 s79, s79, 1
s_cmp_lg_u32 s79, 0
s_cbranch_scc1 L_retry_4_loop
L_retry_4_done:
s_nop 4
s_branch L_back_5
L_retry_6:
s_mov_b32 s79, 0x20000
L_retry_6_loop:
s_sleep 2
buffer_load_dword v112, v60, s[52:55], s21 offen offset:0 sc1
buffer_load_dword v113, v60, s[52:55], s21 offen offset:256 sc1
buffer_load_dword v114, v60, s[52:55], s21 offen offset:512 sc1
buffer_load_dword v115, v60, s[52:55], s21 offen offset:768 sc1
buffer_load_dword v116, v60, s[52:55], s21 offen offset:1024 sc1
buffer_load_dword v117, v60, s[52:55], s21 offen offset:1280 sc1
buffer_load_dword v118, v60, s[52:55], s21 offen offset:1536 sc1
buffer_load_dword v119, v60, s[52:55], s21 offen offset:1792 sc1
buffer_load_dword v120, v60, s[52:55], s21 offen offset:2048 sc1
buffer_load_dword v121, v60, s[52:55], s21 offen offset:2304 sc1
s_waitcnt vmcnt(0)
v_min3_u32 v250, v112, v113, s72
v_max3_u32 v251, v112, v113, s72
v_min3_u32 v250, v250, v114, v115
v_max3_u32 v251, v251, v114, v115
v_min3_u32 v250, v250, v116, v117
v_max3_u32 v251, v251, v116, v117
v_min3_u32 v250, v250, v118, v119
v_max3_u32 v251, v251, v118, v119
v_min3_u32 v250, v250, v120, v121
v_max3_u32 v251, v251, v120, v121
v_cmp_ne_u32 vcc, v250, v251
s_nop 0
s_and_b64 vcc, vcc, s[100:101]
s_cbranch_vccz L_retry_6_done
s_sub_u32 s79, s79, 1
s_cmp_lg_u32 s79, 0
s_cbranch_scc1 L_retry_6_loop
L_retry_6_done:
s_nop 4
s_branch L_back_7
L_retry_8:
s_mov_b32 s79, 0x20000
L_retry_8_loop:
s_sleep 2
v_and_b32 v41, 0x7fff, v42
buffer_load_dwordx4 v[24:27], v41, s[52:55], 0 offen sc1
s_waitcnt vmcnt(0)
v_cmp_ne_u32 vcc, s72, v26
s_nop 0
s_cbranch_vccz L_retry_8_done
s_sub_u32 s79, s79, 1
s_cmp_lg_u32 s79, 0
s_cbranch_scc1 L_retry_8_loop
L_retry_8_done:
s_nop 4
s_branch L_back_9
L_retry_11:
s_mov_b32 s79, 0x20000
L_retry_11_loop:
s_sleep 2
buffer_load_dword v26, v55, s[52:55], 0 offen sc1
s_waitcnt vmcnt(0)
v_cmp_ne_u32 vcc, s72, v26
s_nop 0
s_cbranch_vccz L_retry_11_done
s_sub_u32 s79, s79, 1
s_cmp_lg_u32 s79, 0
s_cbranch_scc1 L_retry_11_loop
L_retry_11_done:
s_nop 4
s_branch L_back_12
L_retry_13:
s_mov_b32 s79, 0x20000
L_retry_13_loop:
s_sleep 2
buffer_load_dword v63, v62, s[52:55], 0 offen sc1
s_waitcnt vmcnt(0)
v_cmp_ne_u32 vcc, s72, v63
s_nop 0
s_cbranch_vccz L_retry_13_done
s_sub_u32 s79, s79, 1
s_cmp_lg_u32 s79, 0
s_cbranch_scc1 L_retry_13_loop
L_retry_13_done:
s_nop 4
s_branch L_back_14
L_retry_15:
s_mov_b32 s79, 0x20000
L_retry_15_loop:
s_sleep 2
s_mov_b32 s85, 720896
buffer_load_dword v63, v59, s[52:55], s85 offen sc1
s_waitcnt vmcnt(0)
v_cmp_ne_u32 vcc, s72, v63
s_nop 0
s_and_b64 vcc, vcc, s[96:97]
s_cbranch_vccz L_retry_15_done
s_sub_u32 s79, s79, 1
s_cmp_lg_u32 s79, 0
s_cbranch_scc1 L_retry_15_loop
L_retry_15_done:
s_nop 4
s_branch L_back_16
L_retry_17:
s_mov_b32 s79, 0x20000
L_retry_17_loop:
s_sleep 2
s_mov_b32 s85, 724992
buffer_load_dword v63, v59, s[52:55], s85 offen sc1
s_waitcnt vmcnt(0)
v_cmp_ne_u32 vcc, s72, v63
s_nop 0
s_and_b64 vcc, vcc, s[98:99]
s_cbranch_vccz L_retry_17_done
s_sub_u32 s79, s79, 1
s_cmp_lg_u32 s79, 0
s_cbranch_scc1 L_retry_17_loop
L_retry_17_done:
s_nop 4
s_branch L_back_18
L_retry_19:
s_mov_b32 s79, 0x20000
L_retry_19_loop:
s_sleep 2
buffer_load_dword v18, off, s[60:63], 0 sc1
s_waitcnt vmcnt(0)
v_cmp_eq_u32 vcc, 0, v18
s_nop 0
s_cbranch_vccz L_retry_19_done
s_sub_u32 s79, s79, 1
s_cmp_lg_u32 s79, 0
s_cbranch_scc1 L_retry_19_loop
L_retry_19_done:
s_nop 4
s_branch L_back_20
L_retry_22:
s_mov_b32 s79, 0x20000
L_retry_22_loop:
s_sleep 2
buffer_load_dword v26, v55, s[52:55], 0 offen sc1
s_waitcnt vmcnt(0)
v_cmp_ne_u32 vcc, s72, v26
s_nop 0
s_cbranch_vccz L_retry_22_done
s_sub_u32 s79, s79, 1
s_cmp_lg_u32 s79, 0
s_cbranch_scc1 L_retry_22_loop
L_retry_22_done:
s_nop 4
s_branch L_back_23
L_retry_24:
s_mov_b32 s79, 0x20000
L_retry_24_loop:
s_sleep 2
buffer_load_dword v63, v62, s[52:55], 0 offen sc1
s_waitcnt vmcnt(0)
v_cmp_ne_u32 vcc, s72, v63
s_nop 0
s_cbranch_vccz L_retry_24_done
s_sub_u32 s79, s79, 1
s_cmp_lg_u32 s79, 0
s_cbranch_scc1 L_retry_24_loop
L_retry_24_done:
s_nop 4
s_branch L_back_25
L_last:
s_endpgm

.section .rodata,"a"
.p2align 6
.amdhsa_kernel recurrent_scan__sliding_block__dense_activation_relu__prompt_kernel
  .amdhsa_next_free_vgpr 512
  .amdhsa_next_free_sgpr 102
  .amdhsa_accum_offset 256
  .amdhsa_group_segment_fixed_size 0
  .amdhsa_kernarg_size 72
  .amdhsa_user_sgpr_count 2
  .amdhsa_user_sgpr_kernarg_segment_ptr 1
  .amdhsa_system_sgpr_workgroup_id_x 1
.end_amdhsa_kernel
```
